```python
import torch

def _softmax(x, axis=-1):
    return torch.softmax(x, dim=axis)
def _gelu(x):
    return torch.nn.functional.gelu(x, approximate="tanh")
def _silu(x):
    return torch.nn.functional.silu(x)
def _sigmoid(x):
    return torch.sigmoid(x)
def _layernorm(x, axis=-1, eps=1e-5):
    m = x.mean(dim=axis, keepdim=True)
    v = x.var(dim=axis, keepdim=True, unbiased=False)
    return (x - m) / torch.sqrt(v + eps)
def _scatter_add(tgt, idx, src, axis=0):
    return tgt.clone().index_add_(axis, idx, src)
def _segment_sum(src, seg, n):
    out = torch.zeros((n,) + src.shape[1:], dtype=src.dtype)
    return out.index_add_(0, seg, src)
def _pad(x, pw):
    flat = tuple(v for pair in reversed(pw) for v in pair)
    return torch.nn.functional.pad(x, flat)

kernel_name = 'standalone__mha_softmax__near_ridge'

def setup_inputs():

    _w = (lambda a: (lambda t: t.to(torch.bfloat16) if t.is_floating_point() else t)(torch.as_tensor(a)))
    B, H, Sq, Sk, D = 8, 32, 576, 1024, 128
    return {
        "q": _w((lambda *s: torch.randn(*s, dtype=torch.bfloat16) * 0.8)(B, H, Sq, D)),
        "k": _w((lambda *s: torch.randn(*s, dtype=torch.bfloat16) * 0.8)(B, H, Sk, D)),
        "v": _w((lambda *s: torch.randn(*s, dtype=torch.bfloat16) * 0.05)(B, H, Sk, D)),
    }

def reference(q, k, v):
    scale = q.shape[-1] ** -0.5
    scores = torch.einsum("bhqd,bhkd->bhqk", q, k) * scale
    p = _softmax(scores, axis=-1)
    return torch.einsum("bhqk,bhkd->bhqd", p, v)
```

```asm
; @launch grid=(256,1,1) block=(256,1,1) lds=155648
.amdgcn_target "amdgcn-amd-amdhsa--gfx950"
.text
.globl standalone__mha_softmax__near_ridge_kernel
.p2align 8
.type standalone__mha_softmax__near_ridge_kernel,@function
standalone__mha_softmax__near_ridge_kernel:
  s_cmp_ge_u32 s2, 256
  s_cbranch_scc1 L_exit
  s_load_dwordx4 s[4:7], s[0:1], 0
  s_load_dwordx4 s[8:11], s[0:1], 16
  v_lshrrev_b32 v1, 6, v0
  v_and_b32 v0, 63, v0
  s_and_b32 s40, s2, 7
  v_readfirstlane_b32 s24, v1
  s_lshr_b32 s41, s2, 3
  s_and_b32 s82, s41, 1
  s_andn2_b32 s41, s41, 1
  s_lshl_b32 s40, s40, 5
  s_add_u32 s29, s40, s41
  v_lshrrev_b32 v116, 3, v0
  v_and_b32 v117, 7, v0
  v_lshrrev_b32 v118, 1, v116
  v_lshlrev_b32 v119, 1, v118
  s_cmp_lt_u32 s24, 2
  s_cselect_b64 vcc, -1, 0
  v_lshlrev_b32 v121, 8, v116
  v_add_u32 v120, 0, v118
  v_xor_b32 v122, v120, v117
  v_cndmask_b32 v120, v119, v120, vcc
  v_lshl_add_u32 v124, v122, 4, v121
  v_xor_b32 v120, v120, v117
  v_lshl_add_u32 v11, v120, 4, v121
  v_add_u32 v10, 896, v11
  v_add_u32 v120, 4, v118
  v_xor_b32 v122, v120, v117
  v_cndmask_b32 v120, v119, v120, vcc
  v_lshl_add_u32 v125, v122, 4, v121
  v_xor_b32 v120, v120, v117
  v_lshl_add_u32 v13, v120, 4, v121
  v_add_u32 v12, 896, v13
  v_mov_b32 v122, v124
  v_mov_b32 v123, v125
  s_mul_i32 s33, s24, 21760
  s_add_u32 s33, s33, 65536
  s_and_b32 s40, s24, 1
  s_lshl_b32 s40, s40, 12
  s_mul_i32 s25, s29, 262144
  s_add_u32 s25, s25, s40
  s_lshr_b32 s41, s24, 1
  s_mul_i32 s42, s41, 32768
  s_add_u32 s32, s40, s42
  s_mov_b32 s47, s32
  s_mul_i32 s30, s29, 147456
  s_lshl_b32 s40, s82, 12
  s_sub_u32 s40, 20480, s40
  s_mul_i32 s41, s82, 81920
  s_mul_i32 s40, s40, s24
  s_add_u32 s30, s30, s41
  s_add_u32 s30, s30, s40
  s_add_u32 s40, s29, 2
  s_mul_i32 s18, s40, 262144
  s_add_u32 s18, s18, 896
  s_mov_b32 s19, 0x00020000
  s_mov_b32 s14, 37748736
  s_mov_b32 s15, 0x00020000
  s_mov_b32 m0, s47
  s_cmp_lt_u32 s24, 2
  s_waitcnt lgkmcnt(0)
  s_cselect_b32 s16, s6, s8
  s_cselect_b32 s17, s7, s9
  s_mov_b32 s12, s4
  s_mov_b32 s13, s5
  s_sub_u32 s16, s16, 896
  s_subb_u32 s17, s17, 0
  s_cmp_lt_u32 s24, 2
  s_cbranch_scc0 L_nog0
  buffer_load_dwordx4 v10, s[16:19], s25 offen offset:0  lds
  buffer_load_dwordx4 v11, s[16:19], s25 offen offset:1024  lds
  buffer_load_dwordx4 v12, s[16:19], s25 offen offset:2048  lds
  buffer_load_dwordx4 v13, s[16:19], s25 offen offset:3072  lds
  s_add_u32 s25, s25, 8192
L_nog0:
  s_add_u32 m0, s33, 0
  s_add_u32 s42, s30, 0
  buffer_load_dwordx4 v122, s[12:15], s42 offen offset:0 nt lds
  buffer_load_dwordx4 v123, s[12:15], s42 offen offset:2048 nt lds
  s_add_u32 m0, s33, 1024
  s_add_u32 s43, s30, 128
  buffer_load_dwordx4 v122, s[12:15], s43 offen offset:0 nt lds
  buffer_load_dwordx4 v123, s[12:15], s43 offen offset:2048 nt lds
  s_add_u32 m0, s33, 4096
  s_add_u32 s42, s30, 4096
  buffer_load_dwordx4 v122, s[12:15], s42 offen offset:0 nt lds
  buffer_load_dwordx4 v123, s[12:15], s42 offen offset:2048 nt lds
  s_add_u32 m0, s33, 5120
  s_add_u32 s43, s30, 4224
  buffer_load_dwordx4 v122, s[12:15], s43 offen offset:0 nt lds
  buffer_load_dwordx4 v123, s[12:15], s43 offen offset:2048 nt lds
  s_cmp_eq_u32 s82, 0
  s_cbranch_scc0 L_role1
  s_add_u32 m0, s33, 8192
  s_add_u32 s42, s30, 8192
  s_add_u32 s43, s30, 8320
  v_and_b32 v1, 15, v0
  v_lshrrev_b32 v116, 3, v1
  v_lshlrev_b32 v116, 11, v116
  v_and_b32 v117, 7, v1
  v_lshrrev_b32 v2, 4, v0
  v_lshl_add_u32 v116, v117, 7, v116
  v_bfe_u32 v117, v1, 1, 3
  v_add_u32 v118, 0, v2
  v_xor_b32 v118, v118, v117
  v_bfe_u32 v228, v0, 2, 2
  v_and_b32 v229, 1, v2
  v_lshl_add_u32 v4, v118, 4, v116
  v_mul_u32_u24 v15, 272, v1
  v_bfe_u32 v241, v0, 2, 2
  v_lshl_add_u32 v228, v229, 2, v228
  v_add_u32 v118, 4, v2
  v_lshl_add_u32 v15, v2, 3, v15
  v_lshrrev_b32 v229, 1, v2
  v_cmp_eq_u32 vcc, v2, v241
  v_xor_b32 v118, v118, v117
  v_lshl_add_u32 v5, v118, 4, v116
  v_and_b32 v242, 1, v0
  v_lshlrev_b32 v242, 4, v242
  v_mov_b32 v244, 15875
  v_bfe_u32 v243, v0, 1, 1
  v_lshlrev_b32 v244, v242, v244
  v_sub_u32 v243, 0, v243
  v_cndmask_b32 v244, 0, v244, vcc
  v_mov_b32 v248, 47576
  v_and_b32 v245, v243, v244
  v_lshlrev_b32 v248, v242, v248
  v_xor_b32 v244, v245, v244
  v_cndmask_b32 v248, 0, v248, vcc
  v_accvgpr_write_b32 a200, 0
  v_accvgpr_write_b32 a201, 0
  v_accvgpr_write_b32 a204, 0
  v_accvgpr_write_b32 a205, 0
  v_accvgpr_write_b32 a202, v244
  v_accvgpr_write_b32 a203, v245
  v_and_b32 v249, v243, v248
  v_xor_b32 v248, v249, v248
  v_accvgpr_write_b32 a206, 0
  v_accvgpr_write_b32 a207, 0
  v_accvgpr_write_b32 a210, 0
  v_accvgpr_write_b32 a211, 0
  v_accvgpr_write_b32 a208, v248
  v_accvgpr_write_b32 a209, v249
  v_lshlrev_b32 v229, 11, v229
  v_lshl_add_u32 v229, v228, 7, v229
  v_and_b32 v230, 1, v0
  v_lshl_add_u32 v229, v230, 3, v229
  v_bfe_u32 v230, v228, 1, 2
  v_bfe_u32 v231, v0, 1, 1
  v_lshlrev_b32 v230, 1, v230
  v_add_u32 v232, 0, v231
  v_add_u32 v229, 32768, v229
  v_xor_b32 v232, v232, v230
  v_lshl_add_u32 v6, v232, 4, v229
  v_add_u32 v232, 2, v231
  v_xor_b32 v232, v232, v230
  v_lshl_add_u32 v7, v232, 4, v229
  v_add_u32 v232, 4, v231
  v_xor_b32 v232, v232, v230
  v_lshl_add_u32 v8, v232, 4, v229
  v_add_u32 v232, 6, v231
  v_and_b32 v252, 1, v0
  v_xor_b32 v232, v232, v230
  v_mov_b32 v238, 0x3f803f80
  v_cmp_eq_u32 vcc, 0, v252
  v_mov_b32 v253, 0xeeeeeeee
  v_mov_b32 v254, 0x44444444
  v_lshlrev_b32 v14, 4, v0
  v_add_u32 v15, s33, v15
  v_lshl_add_u32 v9, v232, 4, v229
  s_mov_b32 s44, 0x3e0293ee
  s_mov_b32 s45, 0x3e0293ee
  s_mov_b32 s83, 0x7ff00000
  s_mov_b32 s84, 0x5d800000
  s_mov_b32 s94, 0x35800000
  s_mov_b64 s[96:97], 0
  s_mov_b64 s[98:99], 0
  s_mov_b32 s28, 0
  s_mov_b32 s20, s10
  s_mov_b32 s21, s11
  s_mov_b32 s22, 37748736
  s_mov_b32 s23, 0x00020000
  v_accvgpr_write_b32 a164, v238
  v_accvgpr_write_b32 a165, v238
  v_accvgpr_write_b32 a166, v238
  v_accvgpr_write_b32 a167, v238
  v_cndmask_b32 v1, v253, v254, vcc
  v_add_u32 v2, s33, v4
  v_add_u32 v3, s33, v5
  v_accvgpr_write_b32 a144, 0
  v_accvgpr_write_b32 a145, 0
  v_accvgpr_write_b32 a146, 0
  v_accvgpr_write_b32 a147, 0
  v_accvgpr_write_b32 a148, 0
  v_accvgpr_write_b32 a149, 0
  v_accvgpr_write_b32 a150, 0
  v_accvgpr_write_b32 a151, 0
  v_accvgpr_write_b32 a152, 0
  v_accvgpr_write_b32 a153, 0
  v_accvgpr_write_b32 a154, 0
  v_accvgpr_write_b32 a155, 0
  v_accvgpr_write_b32 a156, 0
  v_accvgpr_write_b32 a157, 0
  v_accvgpr_write_b32 a158, 0
  v_accvgpr_write_b32 a159, 0
  v_accvgpr_write_b32 a160, 0
  v_accvgpr_write_b32 a161, 0
  v_accvgpr_write_b32 a162, 0
  v_accvgpr_write_b32 a163, 0
  s_waitcnt vmcnt(8)
  buffer_load_dwordx4 v122, s[12:15], s42 offen offset:0 nt lds
  buffer_load_dwordx4 v123, s[12:15], s42 offen offset:2048 nt lds
  s_add_u32 m0, s33, 9216
  s_add_u32 s42, s30, 12288
  buffer_load_dwordx4 v122, s[12:15], s43 offen offset:0 nt lds
  buffer_load_dwordx4 v123, s[12:15], s43 offen offset:2048 nt lds
  s_add_u32 m0, s33, 12288
  s_add_u32 s43, s30, 12416
  s_barrier
  ds_read_b128 a[80:83], v4 offset:0
  ds_read_b128 a[84:87], v5 offset:0
  ds_read_b128 a[88:91], v4 offset:1024
  ds_read_b128 a[92:95], v5 offset:1024
  ds_read_b128 a[96:99], v4 offset:4096
  ds_read_b128 a[100:103], v5 offset:4096
  ds_read_b128 a[104:107], v4 offset:5120
  ds_read_b128 a[108:111], v5 offset:5120
  s_waitcnt vmcnt(8)
  buffer_load_dwordx4 v122, s[12:15], s42 offen offset:0 nt lds
  buffer_load_dwordx4 v123, s[12:15], s42 offen offset:2048 nt lds
  s_add_u32 m0, s33, 13312
  s_add_u32 s42, s30, 16384
  buffer_load_dwordx4 v122, s[12:15], s43 offen offset:0 nt lds
  buffer_load_dwordx4 v123, s[12:15], s43 offen offset:2048 nt lds
  s_add_u32 m0, s33, 16384
  s_add_u32 s43, s30, 16512
  ds_read_b128 a[0:3], v2 offset:0
  ds_read_b128 a[4:7], v3 offset:0
  ds_read_b128 a[8:11], v2 offset:1024
  ds_read_b128 a[12:15], v3 offset:1024
  s_waitcnt lgkmcnt(3)
  v_mfma_f32_16x16x32_bf16 v[128:131], a[202:205], a[0:3], 0
  v_mfma_f32_16x16x32_bf16 v[132:135], a[200:203], a[0:3], 0
  v_mfma_f32_16x16x32_bf16 v[128:131], a[208:211], a[0:3], v[128:131]
  v_mfma_f32_16x16x32_bf16 v[132:135], a[206:209], a[0:3], v[132:135]
  s_waitcnt lgkmcnt(2)
  v_mfma_f32_16x16x32_bf16 v[136:139], a[202:205], a[4:7], 0
  s_nop 0
  v_cvt_pk_bf16_f32 v128, v128, v129
  v_mfma_f32_16x16x32_bf16 v[140:143], a[200:203], a[4:7], 0
  v_cvt_pk_bf16_f32 v130, v130, v131
  v_cvt_pk_bf16_f32 v132, v132, v133
  v_mfma_f32_16x16x32_bf16 v[136:139], a[208:211], a[4:7], v[136:139]
  v_cvt_pk_bf16_f32 v134, v134, v135
  v_accvgpr_write_b32 a0, v128
  v_mfma_f32_16x16x32_bf16 v[140:143], a[206:209], a[4:7], v[140:143]
  v_accvgpr_write_b32 a1, v130
  v_accvgpr_write_b32 a2, v132
  s_waitcnt lgkmcnt(1)
  v_mfma_f32_16x16x32_bf16 v[144:147], a[202:205], a[8:11], 0
  v_accvgpr_write_b32 a3, v134
  v_cvt_pk_bf16_f32 v136, v136, v137
  v_mfma_f32_16x16x32_bf16 v[148:151], a[200:203], a[8:11], 0
  v_cvt_pk_bf16_f32 v138, v138, v139
  v_cvt_pk_bf16_f32 v140, v140, v141
  v_mfma_f32_16x16x32_bf16 v[144:147], a[208:211], a[8:11], v[144:147]
  v_cvt_pk_bf16_f32 v142, v142, v143
  v_accvgpr_write_b32 a4, v136
  v_mfma_f32_16x16x32_bf16 v[148:151], a[206:209], a[8:11], v[148:151]
  v_accvgpr_write_b32 a5, v138
  v_accvgpr_write_b32 a6, v140
  s_waitcnt lgkmcnt(0)
  v_mfma_f32_16x16x32_bf16 v[152:155], a[202:205], a[12:15], 0
  v_accvgpr_write_b32 a7, v142
  v_cvt_pk_bf16_f32 v144, v144, v145
  v_mfma_f32_16x16x32_bf16 v[156:159], a[200:203], a[12:15], 0
  v_cvt_pk_bf16_f32 v146, v146, v147
  v_cvt_pk_bf16_f32 v148, v148, v149
  v_mfma_f32_16x16x32_bf16 v[152:155], a[208:211], a[12:15], v[152:155]
  v_cvt_pk_bf16_f32 v150, v150, v151
  v_accvgpr_write_b32 a8, v144
  v_mfma_f32_16x16x32_bf16 v[156:159], a[206:209], a[12:15], v[156:159]
  v_accvgpr_write_b32 a9, v146
  v_accvgpr_write_b32 a10, v148
  v_mfma_f32_16x16x32_bf16 v[36:39], a[80:83], a[0:3], 0
  v_accvgpr_write_b32 a11, v150
  v_cvt_pk_bf16_f32 v152, v152, v153
  v_mfma_f32_16x16x32_bf16 v[36:39], a[84:87], a[4:7], v[36:39]
  v_cvt_pk_bf16_f32 v154, v154, v155
  v_cvt_pk_bf16_f32 v156, v156, v157
  v_mfma_f32_16x16x32_bf16 v[36:39], a[88:91], a[8:11], v[36:39]
  v_cvt_pk_bf16_f32 v158, v158, v159
  v_accvgpr_write_b32 a12, v152
  v_accvgpr_write_b32 a13, v154
  v_accvgpr_write_b32 a14, v156
  v_accvgpr_write_b32 a15, v158
  s_nop 1
  v_mfma_f32_16x16x32_bf16 v[36:39], a[92:95], a[12:15], v[36:39]
  s_waitcnt vmcnt(8)
  buffer_load_dwordx4 v122, s[12:15], s42 offen offset:0 nt lds
  buffer_load_dwordx4 v123, s[12:15], s42 offen offset:2048 nt lds
  s_add_u32 m0, s33, 17408
  ds_read_b128 a[16:19], v2 offset:4096
  buffer_load_dwordx4 v122, s[12:15], s43 offen offset:0 nt lds
  buffer_load_dwordx4 v123, s[12:15], s43 offen offset:2048 nt lds
  s_add_u32 m0, s47, 8192
  ds_read_b128 a[20:23], v3 offset:4096
  ds_read_b128 a[24:27], v2 offset:5120
  ds_read_b128 a[28:31], v3 offset:5120
  v_max3_f32 v192, v36, v37, v38
  v_max_f32 v192, v192, v39
  v_mov_b32 v193, v192
  s_nop 1
  v_permlane32_swap_b32 v192, v193
  v_max_f32 v192, v192, v193
  v_mov_b32 v193, v192
  s_nop 1
  v_permlane16_swap_b32 v192, v193
  v_max_f32 v192, v192, v193
  v_sub_f32 v19, 0, v192
  v_sub_f32 v18, 0, v192
  v_sub_f32 v17, 0, v192
  v_sub_f32 v16, 0, v192
  s_nop 1
  v_mfma_f32_16x16x32_bf16 v[36:39], a[80:83], a[0:3], v[16:19]
  s_waitcnt lgkmcnt(3)
  v_mfma_f32_16x16x32_bf16 v[160:163], a[202:205], a[16:19], 0
  v_mfma_f32_16x16x32_bf16 v[164:167], a[200:203], a[16:19], 0
  v_mfma_f32_16x16x32_bf16 v[160:163], a[208:211], a[16:19], v[160:163]
  v_mfma_f32_16x16x32_bf16 v[164:167], a[206:209], a[16:19], v[164:167]
  s_waitcnt lgkmcnt(2)
  v_mfma_f32_16x16x32_bf16 v[168:171], a[202:205], a[20:23], 0
  s_nop 0
  v_cvt_pk_bf16_f32 v160, v160, v161
  v_mfma_f32_16x16x32_bf16 v[172:175], a[200:203], a[20:23], 0
  v_cvt_pk_bf16_f32 v162, v162, v163
  v_cvt_pk_bf16_f32 v164, v164, v165
  v_mfma_f32_16x16x32_bf16 v[168:171], a[208:211], a[20:23], v[168:171]
  v_cvt_pk_bf16_f32 v166, v166, v167
  v_accvgpr_write_b32 a16, v160
  v_mfma_f32_16x16x32_bf16 v[172:175], a[206:209], a[20:23], v[172:175]
  v_accvgpr_write_b32 a17, v162
  v_accvgpr_write_b32 a18, v164
  s_waitcnt lgkmcnt(1)
  v_mfma_f32_16x16x32_bf16 v[176:179], a[202:205], a[24:27], 0
  v_accvgpr_write_b32 a19, v166
  v_cvt_pk_bf16_f32 v168, v168, v169
  v_mfma_f32_16x16x32_bf16 v[180:183], a[200:203], a[24:27], 0
  v_cvt_pk_bf16_f32 v170, v170, v171
  v_cvt_pk_bf16_f32 v172, v172, v173
  v_mfma_f32_16x16x32_bf16 v[176:179], a[208:211], a[24:27], v[176:179]
  v_cvt_pk_bf16_f32 v174, v174, v175
  v_accvgpr_write_b32 a20, v168
  v_mfma_f32_16x16x32_bf16 v[180:183], a[206:209], a[24:27], v[180:183]
  v_accvgpr_write_b32 a21, v170
  v_accvgpr_write_b32 a22, v172
  s_waitcnt lgkmcnt(0)
  v_mfma_f32_16x16x32_bf16 v[184:187], a[202:205], a[28:31], 0
  v_accvgpr_write_b32 a23, v174
  v_cvt_pk_bf16_f32 v176, v176, v177
  v_mfma_f32_16x16x32_bf16 v[188:191], a[200:203], a[28:31], 0
  v_cvt_pk_bf16_f32 v178, v178, v179
  v_cvt_pk_bf16_f32 v180, v180, v181
  v_mfma_f32_16x16x32_bf16 v[184:187], a[208:211], a[28:31], v[184:187]
  v_cvt_pk_bf16_f32 v182, v182, v183
  v_accvgpr_write_b32 a24, v176
  v_mfma_f32_16x16x32_bf16 v[188:191], a[206:209], a[28:31], v[188:191]
  v_accvgpr_write_b32 a25, v178
  v_accvgpr_write_b32 a26, v180
  v_mfma_f32_16x16x32_bf16 v[44:47], a[80:83], a[16:19], 0
  v_accvgpr_write_b32 a27, v182
  v_cvt_pk_bf16_f32 v184, v184, v185
  v_mfma_f32_16x16x32_bf16 v[44:47], a[84:87], a[20:23], v[44:47]
  v_cvt_pk_bf16_f32 v186, v186, v187
  v_cvt_pk_bf16_f32 v188, v188, v189
  v_mfma_f32_16x16x32_bf16 v[44:47], a[88:91], a[24:27], v[44:47]
  v_cvt_pk_bf16_f32 v190, v190, v191
  v_accvgpr_write_b32 a28, v184
  v_mfma_f32_16x16x32_bf16 v[40:43], a[96:99], a[0:3], v[16:19]
  v_accvgpr_write_b32 a29, v186
  v_accvgpr_write_b32 a30, v188
  v_mfma_f32_16x16x32_bf16 v[36:39], a[84:87], a[4:7], v[36:39]
  v_accvgpr_write_b32 a31, v190
  v_mfma_f32_16x16x32_bf16 v[40:43], a[100:103], a[4:7], v[40:43]
  s_waitcnt vmcnt(8)
  buffer_load_dwordx4 v10, s[16:19], s25 offen offset:0  lds
  v_mfma_f32_16x16x32_bf16 v[44:47], a[92:95], a[28:31], v[44:47]
  buffer_load_dwordx4 v11, s[16:19], s25 offen offset:1024  lds
  v_mfma_f32_16x16x32_bf16 v[36:39], a[88:91], a[8:11], v[36:39]
  buffer_load_dwordx4 v12, s[16:19], s25 offen offset:2048  lds
  v_mfma_f32_16x16x32_bf16 v[40:43], a[104:107], a[8:11], v[40:43]
  buffer_load_dwordx4 v13, s[16:19], s25 offen offset:3072  lds
  v_mfma_f32_16x16x32_bf16 v[36:39], a[92:95], a[12:15], v[36:39]
  s_add_u32 m0, s47, 16384
  ds_read_b128 a[32:35], v2 offset:8192
  v_mfma_f32_16x16x32_bf16 v[40:43], a[108:111], a[12:15], v[40:43]
  ds_read_b128 a[36:39], v3 offset:8192
  s_add_u32 s25, s25, 8192
  ds_read_b128 a[40:43], v2 offset:9216
  ds_read_b128 a[44:47], v3 offset:9216
  v_max3_f32 v194, v44, v45, v46
  v_max_f32 v194, v194, v47
  v_mov_b32 v195, v194
  v_exp_f32 v36, v36
  v_exp_f32 v37, v37
  v_permlane32_swap_b32 v194, v195
  v_max_f32 v194, v194, v195
  v_mov_b32 v195, v194
  v_exp_f32 v38, v38
  v_exp_f32 v39, v39
  v_permlane16_swap_b32 v194, v195
  v_max_f32 v194, v194, v195
  v_sub_f32 v23, 0, v194
  v_sub_f32 v22, 0, v194
  v_sub_f32 v21, 0, v194
  v_sub_f32 v20, 0, v194
  v_exp_f32 v40, v40
  s_waitcnt lgkmcnt(3)
  v_mfma_f32_16x16x32_bf16 v[128:131], a[202:205], a[32:35], 0
  v_exp_f32 v41, v41
  v_mfma_f32_16x16x32_bf16 v[132:135], a[200:203], a[32:35], 0
  v_exp_f32 v42, v42
  v_mfma_f32_16x16x32_bf16 v[128:131], a[208:211], a[32:35], v[128:131]
  v_exp_f32 v43, v43
  v_mfma_f32_16x16x32_bf16 v[132:135], a[206:209], a[32:35], v[132:135]
  v_cvt_pk_bf16_f32 v76, v36, v37
  v_cvt_pk_bf16_f32 v77, v38, v39
  s_waitcnt lgkmcnt(2)
  v_mfma_f32_16x16x32_bf16 v[136:139], a[202:205], a[36:39], 0
  v_cvt_pk_bf16_f32 v128, v128, v129
  v_cvt_pk_bf16_f32 v130, v130, v131
  v_mfma_f32_16x16x32_bf16 v[140:143], a[200:203], a[36:39], 0
  v_cvt_pk_bf16_f32 v132, v132, v133
  v_cvt_pk_bf16_f32 v134, v134, v135
  v_mfma_f32_16x16x32_bf16 v[136:139], a[208:211], a[36:39], v[136:139]
  v_accvgpr_write_b32 a32, v128
  v_accvgpr_write_b32 a33, v130
  v_mfma_f32_16x16x32_bf16 v[140:143], a[206:209], a[36:39], v[140:143]
  v_accvgpr_write_b32 a34, v132
  v_accvgpr_write_b32 a35, v134
  s_waitcnt lgkmcnt(1)
  v_mfma_f32_16x16x32_bf16 v[144:147], a[202:205], a[40:43], 0
  v_cvt_pk_bf16_f32 v136, v136, v137
  v_cvt_pk_bf16_f32 v138, v138, v139
  v_mfma_f32_16x16x32_bf16 v[148:151], a[200:203], a[40:43], 0
  v_cvt_pk_bf16_f32 v140, v140, v141
  v_cvt_pk_bf16_f32 v142, v142, v143
  v_mfma_f32_16x16x32_bf16 v[144:147], a[208:211], a[40:43], v[144:147]
  v_accvgpr_write_b32 a36, v136
  v_accvgpr_write_b32 a37, v138
  v_mfma_f32_16x16x32_bf16 v[148:151], a[206:209], a[40:43], v[148:151]
  v_accvgpr_write_b32 a38, v140
  v_accvgpr_write_b32 a39, v142
  s_waitcnt lgkmcnt(0)
  v_mfma_f32_16x16x32_bf16 v[152:155], a[202:205], a[44:47], 0
  v_cvt_pk_bf16_f32 v144, v144, v145
  v_cvt_pk_bf16_f32 v146, v146, v147
  v_mfma_f32_16x16x32_bf16 v[156:159], a[200:203], a[44:47], 0
  v_cvt_pk_bf16_f32 v148, v148, v149
  v_cvt_pk_bf16_f32 v150, v150, v151
  v_mfma_f32_16x16x32_bf16 v[152:155], a[208:211], a[44:47], v[152:155]
  v_accvgpr_write_b32 a40, v144
  v_accvgpr_write_b32 a41, v146
  v_mfma_f32_16x16x32_bf16 v[156:159], a[206:209], a[44:47], v[156:159]
  v_accvgpr_write_b32 a42, v148
  v_accvgpr_write_b32 a43, v150
  v_mfma_f32_16x16x32_bf16 v[52:55], a[80:83], a[32:35], 0
  v_cvt_pk_bf16_f32 v78, v40, v41
  v_cvt_pk_bf16_f32 v152, v152, v153
  v_mfma_f32_16x16x32_bf16 v[52:55], a[84:87], a[36:39], v[52:55]
  v_cvt_pk_bf16_f32 v154, v154, v155
  v_cvt_pk_bf16_f32 v156, v156, v157
  v_mfma_f32_16x16x32_bf16 v[52:55], a[88:91], a[40:43], v[52:55]
  s_waitcnt vmcnt(8)
  buffer_load_dwordx4 v10, s[16:19], s25 offen offset:0  lds
  v_mfma_f32_16x16x32_bf16 v[44:47], a[80:83], a[16:19], v[20:23]
  buffer_load_dwordx4 v11, s[16:19], s25 offen offset:1024  lds
  v_mfma_f32_16x16x32_bf16 v[48:51], a[96:99], a[16:19], v[20:23]
  buffer_load_dwordx4 v12, s[16:19], s25 offen offset:2048  lds
  v_mfma_f32_16x16x32_bf16 v[44:47], a[84:87], a[20:23], v[44:47]
  buffer_load_dwordx4 v13, s[16:19], s25 offen offset:3072  lds
  v_mfma_f32_16x16x32_bf16 v[48:51], a[100:103], a[20:23], v[48:51]
  s_add_u32 m0, s47, 24576
  ds_read_b128 a[48:51], v2 offset:12288
  v_mfma_f32_16x16x32_bf16 v[44:47], a[88:91], a[24:27], v[44:47]
  ds_read_b128 a[52:55], v3 offset:12288
  ds_read_b128 a[56:59], v2 offset:13312
  v_mfma_f32_16x16x32_bf16 v[48:51], a[104:107], a[24:27], v[48:51]
  ds_read_b128 a[60:63], v3 offset:13312
  v_cvt_pk_bf16_f32 v158, v158, v159
  v_mfma_f32_16x16x32_bf16 v[44:47], a[92:95], a[28:31], v[44:47]
  v_accvgpr_write_b32 a44, v152
  v_accvgpr_write_b32 a45, v154
  v_mfma_f32_16x16x32_bf16 v[48:51], a[108:111], a[28:31], v[48:51]
  v_accvgpr_write_b32 a46, v156
  v_accvgpr_write_b32 a47, v158
  s_add_u32 s25, s25, 8192
  v_cvt_pk_bf16_f32 v79, v42, v43
  v_mfma_f32_16x16x32_bf16 v[52:55], a[92:95], a[44:47], v[52:55]
  v_exp_f32 v44, v44
  v_exp_f32 v45, v45
  v_exp_f32 v46, v46
  v_exp_f32 v47, v47
  s_waitcnt lgkmcnt(3)
  v_mfma_f32_16x16x32_bf16 v[160:163], a[202:205], a[48:51], 0
  v_max3_f32 v196, v52, v53, v54
  v_max_f32 v196, v196, v55
  v_mfma_f32_16x16x32_bf16 v[164:167], a[200:203], a[48:51], 0
  v_mov_b32 v197, v196
  v_exp_f32 v48, v48
  v_mfma_f32_16x16x32_bf16 v[160:163], a[208:211], a[48:51], v[160:163]
  v_permlane32_swap_b32 v196, v197
  v_max_f32 v196, v196, v197
  v_mfma_f32_16x16x32_bf16 v[164:167], a[206:209], a[48:51], v[164:167]
  v_mov_b32 v197, v196
  v_exp_f32 v49, v49
  s_waitcnt lgkmcnt(2)
  v_mfma_f32_16x16x32_bf16 v[168:171], a[202:205], a[52:55], 0
  v_cvt_pk_bf16_f32 v160, v160, v161
  v_cvt_pk_bf16_f32 v162, v162, v163
  v_mfma_f32_16x16x32_bf16 v[172:175], a[200:203], a[52:55], 0
  v_cvt_pk_bf16_f32 v164, v164, v165
  v_cvt_pk_bf16_f32 v166, v166, v167
  v_mfma_f32_16x16x32_bf16 v[168:171], a[208:211], a[52:55], v[168:171]
  v_accvgpr_write_b32 a48, v160
  v_accvgpr_write_b32 a49, v162
  v_mfma_f32_16x16x32_bf16 v[172:175], a[206:209], a[52:55], v[172:175]
  v_accvgpr_write_b32 a50, v164
  v_accvgpr_write_b32 a51, v166
  s_waitcnt lgkmcnt(1)
  v_mfma_f32_16x16x32_bf16 v[176:179], a[202:205], a[56:59], 0
  v_cvt_pk_bf16_f32 v168, v168, v169
  v_cvt_pk_bf16_f32 v170, v170, v171
  v_mfma_f32_16x16x32_bf16 v[180:183], a[200:203], a[56:59], 0
  v_cvt_pk_bf16_f32 v172, v172, v173
  v_cvt_pk_bf16_f32 v174, v174, v175
  v_mfma_f32_16x16x32_bf16 v[176:179], a[208:211], a[56:59], v[176:179]
  v_accvgpr_write_b32 a52, v168
  v_accvgpr_write_b32 a53, v170
  v_mfma_f32_16x16x32_bf16 v[180:183], a[206:209], a[56:59], v[180:183]
  v_accvgpr_write_b32 a54, v172
  v_accvgpr_write_b32 a55, v174
  s_waitcnt lgkmcnt(0)
  v_mfma_f32_16x16x32_bf16 v[184:187], a[202:205], a[60:63], 0
  v_cvt_pk_bf16_f32 v176, v176, v177
  v_cvt_pk_bf16_f32 v178, v178, v179
  v_mfma_f32_16x16x32_bf16 v[188:191], a[200:203], a[60:63], 0
  v_cvt_pk_bf16_f32 v180, v180, v181
  v_cvt_pk_bf16_f32 v182, v182, v183
  v_mfma_f32_16x16x32_bf16 v[184:187], a[208:211], a[60:63], v[184:187]
  v_accvgpr_write_b32 a56, v176
  v_accvgpr_write_b32 a57, v178
  v_mfma_f32_16x16x32_bf16 v[188:191], a[206:209], a[60:63], v[188:191]
  v_accvgpr_write_b32 a58, v180
  v_accvgpr_write_b32 a59, v182
  v_mfma_f32_16x16x32_bf16 v[60:63], a[80:83], a[48:51], 0
  v_permlane16_swap_b32 v196, v197
  v_cvt_pk_bf16_f32 v184, v184, v185
  v_mfma_f32_16x16x32_bf16 v[60:63], a[84:87], a[52:55], v[60:63]
  v_cvt_pk_bf16_f32 v186, v186, v187
  v_cvt_pk_bf16_f32 v188, v188, v189
  v_mfma_f32_16x16x32_bf16 v[60:63], a[88:91], a[56:59], v[60:63]
  s_waitcnt vmcnt(8)
  buffer_load_dwordx4 v10, s[16:19], s25 offen offset:0  lds
  buffer_load_dwordx4 v11, s[16:19], s25 offen offset:1024  lds
  buffer_load_dwordx4 v12, s[16:19], s25 offen offset:2048  lds
  buffer_load_dwordx4 v13, s[16:19], s25 offen offset:3072  lds
  ds_read_b128 a[64:67], v2 offset:16384
  ds_read_b128 a[68:71], v3 offset:16384
  ds_read_b128 a[72:75], v2 offset:17408
  ds_read_b128 a[76:79], v3 offset:17408
  v_cvt_pk_bf16_f32 v190, v190, v191
  v_accvgpr_write_b32 a60, v184
  v_accvgpr_write_b32 a61, v186
  v_accvgpr_write_b32 a62, v188
  v_accvgpr_write_b32 a63, v190
  v_max_f32 v196, v196, v197
  v_sub_f32 v27, 0, v196
  v_mfma_f32_16x16x32_bf16 v[60:63], a[92:95], a[60:63], v[60:63]
  v_sub_f32 v26, 0, v196
  v_sub_f32 v25, 0, v196
  v_sub_f32 v24, 0, v196
  v_exp_f32 v50, v50
  v_exp_f32 v51, v51
  v_mfma_f32_16x16x32_bf16 v[52:55], a[80:83], a[32:35], v[24:27]
  v_max3_f32 v198, v60, v61, v62
  v_max_f32 v198, v198, v63
  v_mfma_f32_16x16x32_bf16 v[56:59], a[96:99], a[32:35], v[24:27]
  v_mov_b32 v199, v198
  v_cvt_pk_bf16_f32 v84, v44, v45
  s_waitcnt lgkmcnt(3)
  v_mfma_f32_16x16x32_bf16 v[128:131], a[202:205], a[64:67], 0
  v_permlane32_swap_b32 v198, v199
  v_max_f32 v198, v198, v199
  v_mfma_f32_16x16x32_bf16 v[132:135], a[200:203], a[64:67], 0
  v_mov_b32 v199, v198
  v_cvt_pk_bf16_f32 v85, v46, v47
  v_mfma_f32_16x16x32_bf16 v[128:131], a[208:211], a[64:67], v[128:131]
  v_permlane16_swap_b32 v198, v199
  v_max_f32 v198, v198, v199
  v_mfma_f32_16x16x32_bf16 v[132:135], a[206:209], a[64:67], v[132:135]
  v_sub_f32 v31, 0, v198
  v_sub_f32 v30, 0, v198
  s_waitcnt lgkmcnt(2)
  v_mfma_f32_16x16x32_bf16 v[136:139], a[202:205], a[68:71], 0
  v_cvt_pk_bf16_f32 v128, v128, v129
  v_cvt_pk_bf16_f32 v130, v130, v131
  v_mfma_f32_16x16x32_bf16 v[140:143], a[200:203], a[68:71], 0
  v_cvt_pk_bf16_f32 v132, v132, v133
  v_cvt_pk_bf16_f32 v134, v134, v135
  v_mfma_f32_16x16x32_bf16 v[136:139], a[208:211], a[68:71], v[136:139]
  v_accvgpr_write_b32 a64, v128
  v_accvgpr_write_b32 a65, v130
  v_mfma_f32_16x16x32_bf16 v[140:143], a[206:209], a[68:71], v[140:143]
  v_accvgpr_write_b32 a66, v132
  v_accvgpr_write_b32 a67, v134
  s_waitcnt lgkmcnt(1)
  v_mfma_f32_16x16x32_bf16 v[144:147], a[202:205], a[72:75], 0
  v_cvt_pk_bf16_f32 v136, v136, v137
  v_cvt_pk_bf16_f32 v138, v138, v139
  v_mfma_f32_16x16x32_bf16 v[148:151], a[200:203], a[72:75], 0
  v_cvt_pk_bf16_f32 v140, v140, v141
  v_cvt_pk_bf16_f32 v142, v142, v143
  v_mfma_f32_16x16x32_bf16 v[144:147], a[208:211], a[72:75], v[144:147]
  v_accvgpr_write_b32 a68, v136
  v_accvgpr_write_b32 a69, v138
  v_mfma_f32_16x16x32_bf16 v[148:151], a[206:209], a[72:75], v[148:151]
  v_accvgpr_write_b32 a70, v140
  v_accvgpr_write_b32 a71, v142
  s_waitcnt lgkmcnt(0)
  v_mfma_f32_16x16x32_bf16 v[152:155], a[202:205], a[76:79], 0
  v_cvt_pk_bf16_f32 v144, v144, v145
  v_cvt_pk_bf16_f32 v146, v146, v147
  v_mfma_f32_16x16x32_bf16 v[156:159], a[200:203], a[76:79], 0
  v_cvt_pk_bf16_f32 v148, v148, v149
  v_cvt_pk_bf16_f32 v150, v150, v151
  v_mfma_f32_16x16x32_bf16 v[152:155], a[208:211], a[76:79], v[152:155]
  v_accvgpr_write_b32 a72, v144
  v_accvgpr_write_b32 a73, v146
  v_mfma_f32_16x16x32_bf16 v[156:159], a[206:209], a[76:79], v[156:159]
  v_accvgpr_write_b32 a74, v148
  v_accvgpr_write_b32 a75, v150
  v_mfma_f32_16x16x32_bf16 v[68:71], a[80:83], a[64:67], 0
  v_sub_f32 v29, 0, v198
  v_cvt_pk_bf16_f32 v152, v152, v153
  v_mfma_f32_16x16x32_bf16 v[68:71], a[84:87], a[68:71], v[68:71]
  v_cvt_pk_bf16_f32 v154, v154, v155
  v_cvt_pk_bf16_f32 v156, v156, v157
  v_mfma_f32_16x16x32_bf16 v[68:71], a[88:91], a[72:75], v[68:71]
  v_cvt_pk_bf16_f32 v158, v158, v159
  v_accvgpr_write_b32 a76, v152
  v_mfma_f32_16x16x32_bf16 v[52:55], a[84:87], a[36:39], v[52:55]
  v_accvgpr_write_b32 a77, v154
  v_accvgpr_write_b32 a78, v156
  v_mfma_f32_16x16x32_bf16 v[56:59], a[100:103], a[36:39], v[56:59]
  v_accvgpr_write_b32 a79, v158
  v_sub_f32 v28, 0, v198
  v_mfma_f32_16x16x32_bf16 v[52:55], a[88:91], a[40:43], v[52:55]
  v_cvt_pk_bf16_f32 v86, v48, v49
  v_cvt_pk_bf16_f32 v87, v50, v51
  v_mfma_f32_16x16x32_bf16 v[68:71], a[92:95], a[76:79], v[68:71]
  s_add_u32 s25, s25, 8192
  v_mfma_f32_16x16x32_bf16 v[60:63], a[80:83], a[48:51], v[28:31]
  v_mfma_f32_16x16x32_bf16 v[64:67], a[96:99], a[48:51], v[28:31]
  s_nop 0
  v_max3_f32 v200, v68, v69, v70
  v_mfma_f32_16x16x32_bf16 v[60:63], a[84:87], a[52:55], v[60:63]
  v_max_f32 v200, v200, v71
  v_mov_b32 v201, v200
  v_mfma_f32_16x16x32_bf16 v[64:67], a[100:103], a[52:55], v[64:67]
  s_nop 0
  v_permlane32_swap_b32 v200, v201
  v_mfma_f32_16x16x32_bf16 v[56:59], a[104:107], a[40:43], v[56:59]
  v_max_f32 v200, v200, v201
  v_mov_b32 v201, v200
  v_mfma_f32_16x16x32_bf16 v[60:63], a[88:91], a[56:59], v[60:63]
  s_nop 0
  v_permlane16_swap_b32 v200, v201
  v_mfma_f32_16x16x32_bf16 v[64:67], a[104:107], a[56:59], v[64:67]
  v_max_f32 v200, v200, v201
  v_sub_f32 v35, 0, v200
  v_mfma_f32_16x16x32_bf16 v[52:55], a[92:95], a[44:47], v[52:55]
  v_sub_f32 v34, 0, v200
  v_sub_f32 v33, 0, v200
  v_mfma_f32_16x16x32_bf16 v[56:59], a[108:111], a[44:47], v[56:59]
  v_sub_f32 v32, 0, v200
  v_mfma_f32_16x16x32_bf16 v[60:63], a[92:95], a[60:63], v[60:63]
  s_nop 0
  v_exp_f32 v52, v52
  v_mfma_f32_16x16x32_bf16 v[68:71], a[80:83], a[64:67], v[32:35]
  v_exp_f32 v53, v53
  v_mfma_f32_16x16x32_bf16 v[72:75], a[96:99], a[64:67], v[32:35]
  v_exp_f32 v54, v54
  v_mfma_f32_16x16x32_bf16 v[68:71], a[84:87], a[68:71], v[68:71]
  v_exp_f32 v55, v55
  v_mfma_f32_16x16x32_bf16 v[72:75], a[100:103], a[68:71], v[72:75]
  v_exp_f32 v56, v56
  v_mfma_f32_16x16x32_bf16 v[68:71], a[88:91], a[72:75], v[68:71]
  v_exp_f32 v57, v57
  v_mfma_f32_16x16x32_bf16 v[72:75], a[104:107], a[72:75], v[72:75]
  v_exp_f32 v58, v58
  v_mfma_f32_16x16x32_bf16 v[64:67], a[108:111], a[60:63], v[64:67]
  v_exp_f32 v59, v59
  v_mfma_f32_16x16x32_bf16 v[68:71], a[92:95], a[76:79], v[68:71]
  v_exp_f32 v60, v60
  v_mfma_f32_16x16x32_bf16 v[72:75], a[108:111], a[76:79], v[72:75]
  v_exp_f32 v61, v61
  v_exp_f32 v62, v62
  v_exp_f32 v63, v63
  v_exp_f32 v64, v64
  v_exp_f32 v65, v65
  v_exp_f32 v66, v66
  v_exp_f32 v67, v67
  v_exp_f32 v68, v68
  v_exp_f32 v69, v69
  v_exp_f32 v70, v70
  v_exp_f32 v71, v71
  v_exp_f32 v72, v72
  v_cvt_pk_bf16_f32 v92, v52, v53
  v_cvt_pk_bf16_f32 v93, v54, v55
  v_cvt_pk_bf16_f32 v94, v56, v57
  v_cvt_pk_bf16_f32 v95, v58, v59
  v_cvt_pk_bf16_f32 v100, v60, v61
  v_cvt_pk_bf16_f32 v101, v62, v63
  v_cvt_pk_bf16_f32 v102, v64, v65
  v_cvt_pk_bf16_f32 v103, v66, v67
  v_cvt_pk_bf16_f32 v108, v68, v69
  v_cvt_pk_bf16_f32 v109, v70, v71
  s_add_u32 s85, s29, 1
  s_mul_i32 s31, s85, 147456
  s_mul_i32 s40, s24, 16384
  s_add_u32 s31, s31, s40
  s_add_u32 s31, s31, 81920
  s_sub_u32 s34, s31, 3968
  s_sub_u32 s35, s33, 3072
  s_mov_b32 s36, 3968
  s_mov_b32 s38, 3840
  s_mov_b32 s37, 3072
  s_mov_b32 s39, 2048
  s_waitcnt vmcnt(8) lgkmcnt(0)
  s_barrier
  s_mov_b32 m0, s32
  ds_read_b128 a[80:83], v4 offset:8192
  ds_read_b128 a[84:87], v5 offset:8192
  ds_read_b128 a[88:91], v4 offset:9216
  ds_read_b128 a[92:95], v5 offset:9216
  ds_read_b128 a[96:99], v4 offset:12288
  ds_read_b128 a[100:103], v5 offset:12288
  ds_read_b128 a[104:107], v4 offset:13312
  ds_read_b128 a[108:111], v5 offset:13312
  buffer_load_dwordx4 v10, s[16:19], s25 offen offset:0  lds
  buffer_load_dwordx4 v11, s[16:19], s25 offen offset:1024  lds
  buffer_load_dwordx4 v12, s[16:19], s25 offen offset:2048  lds
  buffer_load_dwordx4 v13, s[16:19], s25 offen offset:3072  lds
  s_add_u32 s25, s25, 8192
  s_mov_b32 m0, 152576
  v_xor_b32 v4, 0x4000, v4
  v_xor_b32 v5, 0x4000, v5
  buffer_load_dwordx4 v14, s[12:15], s83 offen lds
  s_waitcnt lgkmcnt(0)
  s_add_u32 s26, s25, 139264
  s_add_u32 s27, s25, 253952
  v_mfma_f32_16x16x32_bf16 v[36:39], a[80:83], a[0:3], v[16:19]
  ds_read_b64_tr_b16 a[112:113], v6 offset:8192
  ds_read_b64_tr_b16 a[114:115], v6 offset:12288
  v_mfma_f32_16x16x32_bf16 v[36:39], a[84:87], a[4:7], v[36:39]
  v_exp_f32 v73, v73
  v_mfma_f32_16x16x32_bf16 v[36:39], a[88:91], a[8:11], v[36:39]
  ds_read_b64_tr_b16 a[116:117], v7 offset:8192
  v_cvt_pk_bf16_f32 v110, v72, v73
  v_mfma_f32_16x16x32_bf16 v[36:39], a[92:95], a[12:15], v[36:39]
  v_exp_f32 v74, v74
  v_mfma_f32_16x16x32_bf16 v[40:43], a[96:99], a[0:3], v[16:19]
  ds_read_b64_tr_b16 a[118:119], v7 offset:12288
  ds_read_b64_tr_b16 a[120:121], v8 offset:8192
  v_mfma_f32_16x16x32_bf16 v[40:43], a[100:103], a[4:7], v[40:43]
  v_exp_f32 v75, v75
  v_mfma_f32_16x16x32_bf16 v[40:43], a[104:107], a[8:11], v[40:43]
  ds_read_b64_tr_b16 a[122:123], v8 offset:12288
  v_cvt_pk_bf16_f32 v111, v74, v75
  v_mfma_f32_16x16x32_bf16 v[40:43], a[108:111], a[12:15], v[40:43]
  v_exp_f32 v36, v36
  v_mfma_f32_16x16x32_bf16 v[44:47], a[80:83], a[16:19], v[20:23]
  ds_read_b64_tr_b16 a[124:125], v9 offset:8192
  ds_read_b64_tr_b16 a[126:127], v9 offset:12288
  v_mfma_f32_16x16x32_bf16 v[44:47], a[84:87], a[20:23], v[44:47]
  v_exp_f32 v37, v37
  v_mfma_f32_16x16x32_bf16 v[44:47], a[88:91], a[24:27], v[44:47]
  ds_read_b64_tr_b16 a[128:129], v6 offset:9216
  v_cvt_pk_bf16_f32 v80, v36, v37
  v_mfma_f32_16x16x32_bf16 v[44:47], a[92:95], a[28:31], v[44:47]
  v_exp_f32 v38, v38
  v_mfma_f32_16x16x32_bf16 v[48:51], a[96:99], a[16:19], v[20:23]
  ds_read_b64_tr_b16 a[130:131], v6 offset:13312
  ds_read_b64_tr_b16 a[132:133], v7 offset:9216
  v_mfma_f32_16x16x32_bf16 v[48:51], a[100:103], a[20:23], v[48:51]
  ds_read_b64_tr_b16 a[134:135], v7 offset:13312
  ds_read_b64_tr_b16 a[136:137], v8 offset:9216
  v_mfma_f32_16x16x32_bf16 v[48:51], a[104:107], a[24:27], v[48:51]
  v_exp_f32 v39, v39
  v_mfma_f32_16x16x32_bf16 v[48:51], a[108:111], a[28:31], v[48:51]
  ds_read_b64_tr_b16 a[138:139], v8 offset:13312
  v_cvt_pk_bf16_f32 v81, v38, v39
  v_mfma_f32_16x16x32_bf16 v[52:55], a[80:83], a[32:35], v[24:27]
  v_exp_f32 v40, v40
  v_mfma_f32_16x16x32_bf16 v[52:55], a[84:87], a[36:39], v[52:55]
  ds_read_b64_tr_b16 a[140:141], v9 offset:9216
  ds_read_b64_tr_b16 a[142:143], v9 offset:13312
  v_mfma_f32_16x16x32_bf16 v[52:55], a[88:91], a[40:43], v[52:55]
  v_exp_f32 v41, v41
  v_mfma_f32_16x16x32_bf16 v[52:55], a[92:95], a[44:47], v[52:55]
  v_cvt_pk_bf16_f32 v82, v40, v41
  v_xor_b32 v6, 0x4000, v6
  v_mfma_f32_16x16x32_bf16 v[56:59], a[96:99], a[32:35], v[24:27]
  v_exp_f32 v42, v42
  v_mfma_f32_16x16x32_bf16 v[56:59], a[100:103], a[36:39], v[56:59]
  v_xor_b32 v7, 0x4000, v7
  v_xor_b32 v8, 0x4000, v8
  v_mfma_f32_16x16x32_bf16 v[56:59], a[104:107], a[40:43], v[56:59]
  v_exp_f32 v43, v43
  v_mfma_f32_16x16x32_bf16 v[56:59], a[108:111], a[44:47], v[56:59]
  v_cvt_pk_bf16_f32 v83, v42, v43
  v_xor_b32 v9, 0x4000, v9
  v_mfma_f32_16x16x32_bf16 v[60:63], a[80:83], a[48:51], v[28:31]
  v_exp_f32 v44, v44
  v_mfma_f32_16x16x32_bf16 v[60:63], a[84:87], a[52:55], v[60:63]
  v_mfma_f32_16x16x32_bf16 v[60:63], a[88:91], a[56:59], v[60:63]
  v_exp_f32 v45, v45
  v_mfma_f32_16x16x32_bf16 v[60:63], a[92:95], a[60:63], v[60:63]
  v_cvt_pk_bf16_f32 v88, v44, v45
  v_mfma_f32_16x16x32_bf16 v[64:67], a[96:99], a[48:51], v[28:31]
  v_exp_f32 v46, v46
  v_mfma_f32_16x16x32_bf16 v[64:67], a[100:103], a[52:55], v[64:67]
  v_mfma_f32_16x16x32_bf16 v[64:67], a[104:107], a[56:59], v[64:67]
  v_exp_f32 v47, v47
  v_mfma_f32_16x16x32_bf16 v[64:67], a[108:111], a[60:63], v[64:67]
  v_cvt_pk_bf16_f32 v89, v46, v47
  v_mfma_f32_16x16x32_bf16 v[68:71], a[80:83], a[64:67], v[32:35]
  v_exp_f32 v48, v48
  v_mfma_f32_16x16x32_bf16 v[68:71], a[84:87], a[68:71], v[68:71]
  v_mfma_f32_16x16x32_bf16 v[68:71], a[88:91], a[72:75], v[68:71]
  v_exp_f32 v49, v49
  v_mfma_f32_16x16x32_bf16 v[68:71], a[92:95], a[76:79], v[68:71]
  v_cvt_pk_bf16_f32 v90, v48, v49
  s_waitcnt vmcnt(9) lgkmcnt(0)
  v_mfma_f32_16x16x32_bf16 v[72:75], a[96:99], a[64:67], v[32:35]
  v_exp_f32 v50, v50
  v_mfma_f32_16x16x32_bf16 v[72:75], a[100:103], a[68:71], v[72:75]
  s_barrier
  v_mfma_f32_16x16x32_bf16 v[72:75], a[104:107], a[72:75], v[72:75]
  v_exp_f32 v51, v51
  v_mfma_f32_16x16x32_bf16 v[72:75], a[108:111], a[76:79], v[72:75]
  s_xor_b32 m0, s32, 0x2000
  v_cvt_pk_bf16_f32 v91, v50, v51
  v_mfma_f32_16x16x32_bf16 v[128:131], a[112:115], v[76:79], 0
  v_exp_f32 v52, v52
  v_mfma_f32_16x16x32_bf16 v[160:163], a[112:115], v[84:87], 0
  buffer_load_dwordx4 v10, s[16:19], s25 offen offset:0  lds
  v_mfma_f32_16x16x32_bf16 v[192:195], a[112:115], v[92:95], 0
  v_exp_f32 v53, v53
  v_mfma_f32_16x16x32_bf16 v[224:227], a[112:115], v[100:103], 0
  ds_read_b128 a[80:83], v4 offset:0
  v_cvt_pk_bf16_f32 v96, v52, v53
  v_mfma_f32_16x16x32_bf16 a[168:171], a[112:115], v[108:111], 0
  v_exp_f32 v54, v54
  v_mfma_f32_16x16x32_bf16 v[132:135], a[116:119], v[76:79], 0
  ds_read_b128 a[84:87], v5 offset:0
  ds_read_b128 a[88:91], v4 offset:1024
  v_mfma_f32_16x16x32_bf16 v[164:167], a[116:119], v[84:87], 0
  buffer_load_dwordx4 v11, s[16:19], s25 offen offset:1024  lds
  v_mfma_f32_16x16x32_bf16 v[196:199], a[116:119], v[92:95], 0
  v_exp_f32 v55, v55
  v_mfma_f32_16x16x32_bf16 v[228:231], a[116:119], v[100:103], 0
  ds_read_b128 a[92:95], v5 offset:1024
  v_cvt_pk_bf16_f32 v97, v54, v55
  v_mfma_f32_16x16x32_bf16 a[172:175], a[116:119], v[108:111], 0
  v_exp_f32 v56, v56
  v_mfma_f32_16x16x32_bf16 v[136:139], a[120:123], v[76:79], 0
  buffer_load_dwordx4 v12, s[16:19], s25 offen offset:2048  lds
  v_mfma_f32_16x16x32_bf16 v[168:171], a[120:123], v[84:87], 0
  v_exp_f32 v57, v57
  v_mfma_f32_16x16x32_bf16 v[200:203], a[120:123], v[92:95], 0
  ds_read_b128 a[96:99], v4 offset:4096
  v_cvt_pk_bf16_f32 v98, v56, v57
  v_mfma_f32_16x16x32_bf16 v[232:235], a[120:123], v[100:103], 0
  v_exp_f32 v58, v58
  v_mfma_f32_16x16x32_bf16 a[176:179], a[120:123], v[108:111], 0
  ds_read_b128 a[100:103], v5 offset:4096
  ds_read_b128 a[104:107], v4 offset:5120
  v_mfma_f32_16x16x32_bf16 v[140:143], a[124:127], v[76:79], 0
  v_exp_f32 v59, v59
  v_mfma_f32_16x16x32_bf16 v[172:175], a[124:127], v[84:87], 0
  ds_read_b128 a[108:111], v5 offset:5120
  v_cvt_pk_bf16_f32 v99, v58, v59
  v_mfma_f32_16x16x32_bf16 v[204:207], a[124:127], v[92:95], 0
  v_exp_f32 v60, v60
  v_mfma_f32_16x16x32_bf16 v[236:239], a[124:127], v[100:103], 0
  buffer_load_dwordx4 v13, s[16:19], s25 offen offset:3072  lds
  v_mfma_f32_16x16x32_bf16 a[180:183], a[124:127], v[108:111], 0
  v_exp_f32 v61, v61
  v_mfma_f32_16x16x32_bf16 v[144:147], a[128:131], v[76:79], 0
  s_add_u32 s25, s25, 8192
  v_cvt_pk_bf16_f32 v104, v60, v61
  v_mfma_f32_16x16x32_bf16 v[176:179], a[128:131], v[84:87], 0
  v_exp_f32 v62, v62
  v_mfma_f32_16x16x32_bf16 v[208:211], a[128:131], v[92:95], 0
  s_xor_b32 s32, s32, 0x4000
  s_mov_b32 m0, 152576
  v_mfma_f32_16x16x32_bf16 v[240:243], a[128:131], v[100:103], 0
  v_exp_f32 v63, v63
  v_mfma_f32_16x16x32_bf16 a[184:187], a[128:131], v[108:111], 0
  v_cvt_pk_bf16_f32 v105, v62, v63
  v_mfma_f32_16x16x32_bf16 v[148:151], a[132:135], v[76:79], 0
  v_exp_f32 v64, v64
  v_mfma_f32_16x16x32_bf16 v[180:183], a[132:135], v[84:87], 0
  buffer_load_dwordx4 v123, s[12:15], s83 offen offset:2048 nt lds
  v_mfma_f32_16x16x32_bf16 v[212:215], a[132:135], v[92:95], 0
  v_exp_f32 v65, v65
  v_mfma_f32_16x16x32_bf16 v[244:247], a[132:135], v[100:103], 0
  v_cvt_pk_bf16_f32 v106, v64, v65
  v_mfma_f32_16x16x32_bf16 a[188:191], a[132:135], v[108:111], 0
  v_exp_f32 v66, v66
  v_mfma_f32_16x16x32_bf16 v[152:155], a[136:139], v[76:79], 0
  v_mfma_f32_16x16x32_bf16 v[184:187], a[136:139], v[84:87], 0
  v_exp_f32 v67, v67
  v_mfma_f32_16x16x32_bf16 v[216:219], a[136:139], v[92:95], 0
  v_cvt_pk_bf16_f32 v107, v66, v67
  v_mfma_f32_16x16x32_bf16 v[248:251], a[136:139], v[100:103], 0
  v_exp_f32 v68, v68
  v_mfma_f32_16x16x32_bf16 a[192:195], a[136:139], v[108:111], 0
  v_mfma_f32_16x16x32_bf16 v[156:159], a[140:143], v[76:79], 0
  v_exp_f32 v69, v69
  v_mfma_f32_16x16x32_bf16 v[188:191], a[140:143], v[84:87], 0
  v_cvt_pk_bf16_f32 v112, v68, v69
  v_mfma_f32_16x16x32_bf16 v[220:223], a[140:143], v[92:95], 0
  v_exp_f32 v70, v70
  v_mfma_f32_16x16x32_bf16 v[252:255], a[140:143], v[100:103], 0
  s_waitcnt lgkmcnt(0)
  v_mfma_f32_16x16x32_bf16 a[196:199], a[140:143], v[108:111], 0
L_odd_r0a:
  v_smfmac_f32_16x16x64_bf16 a[144:147], a[164:167], v[76:83], v1
  v_exp_f32 v71, v71
  v_mfma_f32_16x16x32_bf16 v[36:39], a[80:83], a[0:3], v[16:19]
  ds_read_b64_tr_b16 a[112:113], v6 offset:0
  v_cvt_pk_bf16_f32 v113, v70, v71
  v_mfma_f32_16x16x32_bf16 v[36:39], a[84:87], a[4:7], v[36:39]
  v_exp_f32 v72, v72
  v_mfma_f32_16x16x32_bf16 v[36:39], a[88:91], a[8:11], v[36:39]
  ds_read_b64_tr_b16 a[114:115], v6 offset:4096
  ds_read_b64_tr_b16 a[116:117], v7 offset:0
  v_mfma_f32_16x16x32_bf16 v[36:39], a[92:95], a[12:15], v[36:39]
  v_exp_f32 v73, v73
  v_mfma_f32_16x16x32_bf16 v[40:43], a[96:99], a[0:3], v[16:19]
  ds_read_b64_tr_b16 a[118:119], v7 offset:4096
  v_cvt_pk_bf16_f32 v114, v72, v73
  v_mfma_f32_16x16x32_bf16 v[40:43], a[100:103], a[4:7], v[40:43]
  v_exp_f32 v74, v74
  v_mfma_f32_16x16x32_bf16 v[40:43], a[104:107], a[8:11], v[40:43]
  ds_read_b64_tr_b16 a[120:121], v8 offset:0
  ds_read_b64_tr_b16 a[122:123], v8 offset:4096
  v_mfma_f32_16x16x32_bf16 v[40:43], a[108:111], a[12:15], v[40:43]
  v_exp_f32 v75, v75
  v_smfmac_f32_16x16x64_bf16 a[148:151], a[164:167], v[84:91], v1
  ds_read_b64_tr_b16 a[124:125], v9 offset:0
  v_cvt_pk_bf16_f32 v115, v74, v75
  v_mfma_f32_16x16x32_bf16 v[44:47], a[80:83], a[16:19], v[20:23]
  v_exp_f32 v36, v36
  v_mfma_f32_16x16x32_bf16 v[44:47], a[84:87], a[20:23], v[44:47]
  ds_read_b64_tr_b16 a[126:127], v9 offset:4096
  ds_read_b64_tr_b16 a[128:129], v6 offset:1024
  v_mfma_f32_16x16x32_bf16 v[44:47], a[88:91], a[24:27], v[44:47]
  v_exp_f32 v37, v37
  v_mfma_f32_16x16x32_bf16 v[44:47], a[92:95], a[28:31], v[44:47]
  ds_read_b64_tr_b16 a[130:131], v6 offset:5120
  v_cvt_pk_bf16_f32 v76, v36, v37
  v_mfma_f32_16x16x32_bf16 v[48:51], a[96:99], a[16:19], v[20:23]
  v_exp_f32 v38, v38
  v_mfma_f32_16x16x32_bf16 v[48:51], a[100:103], a[20:23], v[48:51]
  ds_read_b64_tr_b16 a[132:133], v7 offset:1024
  ds_read_b64_tr_b16 a[134:135], v7 offset:5120
  v_mfma_f32_16x16x32_bf16 v[48:51], a[104:107], a[24:27], v[48:51]
  v_exp_f32 v39, v39
  v_mfma_f32_16x16x32_bf16 v[48:51], a[108:111], a[28:31], v[48:51]
  ds_read_b64_tr_b16 a[136:137], v8 offset:1024
  v_cvt_pk_bf16_f32 v77, v38, v39
  v_smfmac_f32_16x16x64_bf16 a[152:155], a[164:167], v[92:99], v1
  v_exp_f32 v40, v40
  v_mfma_f32_16x16x32_bf16 v[52:55], a[80:83], a[32:35], v[24:27]
  ds_read_b64_tr_b16 a[138:139], v8 offset:5120
  ds_read_b64_tr_b16 a[140:141], v9 offset:1024
  v_mfma_f32_16x16x32_bf16 v[52:55], a[84:87], a[36:39], v[52:55]
  v_exp_f32 v41, v41
  v_mfma_f32_16x16x32_bf16 v[52:55], a[88:91], a[40:43], v[52:55]
  ds_read_b64_tr_b16 a[142:143], v9 offset:5120
  v_cvt_pk_bf16_f32 v78, v40, v41
  v_mfma_f32_16x16x32_bf16 v[52:55], a[92:95], a[44:47], v[52:55]
  v_exp_f32 v42, v42
  v_mfma_f32_16x16x32_bf16 v[56:59], a[96:99], a[32:35], v[24:27]
  s_add_u32 s34, s34, s36
  s_add_u32 s35, s35, s37
  v_mfma_f32_16x16x32_bf16 v[56:59], a[100:103], a[36:39], v[56:59]
  v_exp_f32 v43, v43
  v_mfma_f32_16x16x32_bf16 v[56:59], a[104:107], a[40:43], v[56:59]
  s_xor_b32 s36, s36, s38
  v_cvt_pk_bf16_f32 v79, v42, v43
  v_mfma_f32_16x16x32_bf16 v[56:59], a[108:111], a[44:47], v[56:59]
  v_exp_f32 v44, v44
  v_smfmac_f32_16x16x64_bf16 a[156:159], a[164:167], v[100:107], v1
  s_xor_b32 s37, s37, s39
  v_mfma_f32_16x16x32_bf16 v[60:63], a[80:83], a[48:51], v[28:31]
  v_exp_f32 v45, v45
  v_mfma_f32_16x16x32_bf16 v[60:63], a[84:87], a[52:55], v[60:63]
  v_cvt_pk_bf16_f32 v84, v44, v45
  v_mfma_f32_16x16x32_bf16 v[60:63], a[88:91], a[56:59], v[60:63]
  v_exp_f32 v46, v46
  v_mfma_f32_16x16x32_bf16 v[60:63], a[92:95], a[60:63], v[60:63]
  v_mfma_f32_16x16x32_bf16 v[64:67], a[96:99], a[48:51], v[28:31]
  v_mfma_f32_16x16x32_bf16 v[64:67], a[100:103], a[52:55], v[64:67]
  v_exp_f32 v47, v47
  v_mfma_f32_16x16x32_bf16 v[64:67], a[104:107], a[56:59], v[64:67]
  v_cvt_pk_bf16_f32 v85, v46, v47
  v_mfma_f32_16x16x32_bf16 v[64:67], a[108:111], a[60:63], v[64:67]
  v_exp_f32 v48, v48
  v_smfmac_f32_16x16x64_bf16 a[160:163], a[164:167], v[108:115], v1
  v_mfma_f32_16x16x32_bf16 v[68:71], a[80:83], a[64:67], v[32:35]
  v_exp_f32 v49, v49
  v_mfma_f32_16x16x32_bf16 v[68:71], a[84:87], a[68:71], v[68:71]
  v_cvt_pk_bf16_f32 v86, v48, v49
  v_mfma_f32_16x16x32_bf16 v[68:71], a[88:91], a[72:75], v[68:71]
  v_exp_f32 v50, v50
  v_mfma_f32_16x16x32_bf16 v[68:71], a[92:95], a[76:79], v[68:71]
  v_mfma_f32_16x16x32_bf16 v[72:75], a[96:99], a[64:67], v[32:35]
  v_exp_f32 v51, v51
  v_mfma_f32_16x16x32_bf16 v[72:75], a[100:103], a[68:71], v[72:75]
  v_cvt_pk_bf16_f32 v87, v50, v51
  s_waitcnt vmcnt(10) lgkmcnt(0)
  v_mfma_f32_16x16x32_bf16 v[72:75], a[104:107], a[72:75], v[72:75]
  v_exp_f32 v52, v52
  v_mfma_f32_16x16x32_bf16 v[72:75], a[108:111], a[76:79], v[72:75]
  s_barrier
  v_mfma_f32_16x16x32_bf16 v[128:131], a[112:115], v[80:83], v[128:131]
  v_exp_f32 v53, v53
  v_mfma_f32_16x16x32_bf16 v[160:163], a[112:115], v[88:91], v[160:163]
  s_mov_b32 m0, s32
  v_cvt_pk_bf16_f32 v92, v52, v53
  v_mfma_f32_16x16x32_bf16 v[192:195], a[112:115], v[96:99], v[192:195]
  v_exp_f32 v54, v54
  v_mfma_f32_16x16x32_bf16 v[224:227], a[112:115], v[104:107], v[224:227]
  buffer_load_dwordx4 v10, s[16:19], s25 offen offset:0  lds
  v_mfma_f32_16x16x32_bf16 a[168:171], a[112:115], v[112:115], a[168:171]
  v_exp_f32 v55, v55
  v_mfma_f32_16x16x32_bf16 v[132:135], a[116:119], v[80:83], v[132:135]
  ds_read_b128 a[80:83], v4 offset:8192
  v_cvt_pk_bf16_f32 v93, v54, v55
  v_mfma_f32_16x16x32_bf16 v[164:167], a[116:119], v[88:91], v[164:167]
  v_exp_f32 v56, v56
  v_mfma_f32_16x16x32_bf16 v[196:199], a[116:119], v[96:99], v[196:199]
  ds_read_b128 a[84:87], v5 offset:8192
  ds_read_b128 a[88:91], v4 offset:9216
  v_mfma_f32_16x16x32_bf16 v[228:231], a[116:119], v[104:107], v[228:231]
  v_exp_f32 v57, v57
  v_mfma_f32_16x16x32_bf16 a[172:175], a[116:119], v[112:115], a[172:175]
  ds_read_b128 a[92:95], v5 offset:9216
  v_cvt_pk_bf16_f32 v94, v56, v57
  v_mfma_f32_16x16x32_bf16 v[136:139], a[120:123], v[80:83], v[136:139]
  v_exp_f32 v58, v58
  v_mfma_f32_16x16x32_bf16 v[168:171], a[120:123], v[88:91], v[168:171]
  buffer_load_dwordx4 v11, s[16:19], s25 offen offset:1024  lds
  v_mfma_f32_16x16x32_bf16 v[200:203], a[120:123], v[96:99], v[200:203]
  v_exp_f32 v59, v59
  v_mfma_f32_16x16x32_bf16 v[232:235], a[120:123], v[104:107], v[232:235]
  ds_read_b128 a[96:99], v4 offset:12288
  v_cvt_pk_bf16_f32 v95, v58, v59
  v_mfma_f32_16x16x32_bf16 a[176:179], a[120:123], v[112:115], a[176:179]
  v_exp_f32 v60, v60
  v_mfma_f32_16x16x32_bf16 v[140:143], a[124:127], v[80:83], v[140:143]
  buffer_load_dwordx4 v12, s[16:19], s25 offen offset:2048  lds
  v_mfma_f32_16x16x32_bf16 v[172:175], a[124:127], v[88:91], v[172:175]
  v_exp_f32 v61, v61
  v_mfma_f32_16x16x32_bf16 v[204:207], a[124:127], v[96:99], v[204:207]
  ds_read_b128 a[100:103], v5 offset:12288
  v_cvt_pk_bf16_f32 v100, v60, v61
  v_mfma_f32_16x16x32_bf16 v[236:239], a[124:127], v[104:107], v[236:239]
  v_exp_f32 v62, v62
  v_mfma_f32_16x16x32_bf16 a[180:183], a[124:127], v[112:115], a[180:183]
  buffer_load_dwordx4 v13, s[16:19], s25 offen offset:3072  lds
  v_mfma_f32_16x16x32_bf16 v[144:147], a[128:131], v[80:83], v[144:147]
  ds_read_b128 a[104:107], v4 offset:13312
  ds_read_b128 a[108:111], v5 offset:13312
  v_mfma_f32_16x16x32_bf16 v[176:179], a[128:131], v[88:91], v[176:179]
  v_exp_f32 v63, v63
  v_mfma_f32_16x16x32_bf16 v[208:211], a[128:131], v[96:99], v[208:211]
  s_add_u32 s25, s25, 8192
  v_cvt_pk_bf16_f32 v101, v62, v63
  v_mfma_f32_16x16x32_bf16 v[240:243], a[128:131], v[104:107], v[240:243]
  v_exp_f32 v64, v64
  v_mfma_f32_16x16x32_bf16 a[184:187], a[128:131], v[112:115], a[184:187]
  s_mov_b32 m0, s35
  v_xor_b32 v4, 0x4000, v4
  v_mfma_f32_16x16x32_bf16 v[148:151], a[132:135], v[80:83], v[148:151]
  v_exp_f32 v65, v65
  v_mfma_f32_16x16x32_bf16 v[180:183], a[132:135], v[88:91], v[180:183]
  v_cvt_pk_bf16_f32 v102, v64, v65
  v_xor_b32 v5, 0x4000, v5
  v_mfma_f32_16x16x32_bf16 v[212:215], a[132:135], v[96:99], v[212:215]
  v_exp_f32 v66, v66
  v_mfma_f32_16x16x32_bf16 v[244:247], a[132:135], v[104:107], v[244:247]
  buffer_load_dwordx4 v122, s[12:15], s34 offen offset:0 nt lds
  v_mfma_f32_16x16x32_bf16 a[188:191], a[132:135], v[112:115], a[188:191]
  v_exp_f32 v67, v67
  v_mfma_f32_16x16x32_bf16 v[152:155], a[136:139], v[80:83], v[152:155]
  v_cvt_pk_bf16_f32 v103, v66, v67
  v_mfma_f32_16x16x32_bf16 v[184:187], a[136:139], v[88:91], v[184:187]
  v_exp_f32 v68, v68
  v_mfma_f32_16x16x32_bf16 v[216:219], a[136:139], v[96:99], v[216:219]
  v_mfma_f32_16x16x32_bf16 v[248:251], a[136:139], v[104:107], v[248:251]
  v_exp_f32 v69, v69
  v_mfma_f32_16x16x32_bf16 a[192:195], a[136:139], v[112:115], a[192:195]
  v_cvt_pk_bf16_f32 v108, v68, v69
  v_mfma_f32_16x16x32_bf16 v[156:159], a[140:143], v[80:83], v[156:159]
  v_exp_f32 v70, v70
  v_mfma_f32_16x16x32_bf16 v[188:191], a[140:143], v[88:91], v[188:191]
  v_mfma_f32_16x16x32_bf16 v[220:223], a[140:143], v[96:99], v[220:223]
  v_exp_f32 v71, v71
  v_mfma_f32_16x16x32_bf16 v[252:255], a[140:143], v[104:107], v[252:255]
  v_cvt_pk_bf16_f32 v109, v70, v71
  s_waitcnt lgkmcnt(0)
  v_mfma_f32_16x16x32_bf16 a[196:199], a[140:143], v[112:115], a[196:199]
  v_exp_f32 v72, v72
  v_mfma_f32_16x16x32_bf16 v[36:39], a[80:83], a[0:3], v[16:19]
  ds_read_b64_tr_b16 a[112:113], v6 offset:8192
  ds_read_b64_tr_b16 a[114:115], v6 offset:12288
  v_mfma_f32_16x16x32_bf16 v[36:39], a[84:87], a[4:7], v[36:39]
  v_exp_f32 v73, v73
  v_mfma_f32_16x16x32_bf16 v[36:39], a[88:91], a[8:11], v[36:39]
  ds_read_b64_tr_b16 a[116:117], v7 offset:8192
  v_cvt_pk_bf16_f32 v110, v72, v73
  v_mfma_f32_16x16x32_bf16 v[36:39], a[92:95], a[12:15], v[36:39]
  v_exp_f32 v74, v74
  v_mfma_f32_16x16x32_bf16 v[40:43], a[96:99], a[0:3], v[16:19]
  ds_read_b64_tr_b16 a[118:119], v7 offset:12288
  ds_read_b64_tr_b16 a[120:121], v8 offset:8192
  v_mfma_f32_16x16x32_bf16 v[40:43], a[100:103], a[4:7], v[40:43]
  v_exp_f32 v75, v75
  v_mfma_f32_16x16x32_bf16 v[40:43], a[104:107], a[8:11], v[40:43]
  ds_read_b64_tr_b16 a[122:123], v8 offset:12288
  v_cvt_pk_bf16_f32 v111, v74, v75
  v_mfma_f32_16x16x32_bf16 v[40:43], a[108:111], a[12:15], v[40:43]
  v_exp_f32 v36, v36
  v_mfma_f32_16x16x32_bf16 v[44:47], a[80:83], a[16:19], v[20:23]
  ds_read_b64_tr_b16 a[124:125], v9 offset:8192
  ds_read_b64_tr_b16 a[126:127], v9 offset:12288
  v_mfma_f32_16x16x32_bf16 v[44:47], a[84:87], a[20:23], v[44:47]
  v_exp_f32 v37, v37
  v_mfma_f32_16x16x32_bf16 v[44:47], a[88:91], a[24:27], v[44:47]
  ds_read_b64_tr_b16 a[128:129], v6 offset:9216
  v_cvt_pk_bf16_f32 v80, v36, v37
  v_mfma_f32_16x16x32_bf16 v[44:47], a[92:95], a[28:31], v[44:47]
  v_exp_f32 v38, v38
  v_mfma_f32_16x16x32_bf16 v[48:51], a[96:99], a[16:19], v[20:23]
  ds_read_b64_tr_b16 a[130:131], v6 offset:13312
  ds_read_b64_tr_b16 a[132:133], v7 offset:9216
  v_mfma_f32_16x16x32_bf16 v[48:51], a[100:103], a[20:23], v[48:51]
  ds_read_b64_tr_b16 a[134:135], v7 offset:13312
  ds_read_b64_tr_b16 a[136:137], v8 offset:9216
  v_mfma_f32_16x16x32_bf16 v[48:51], a[104:107], a[24:27], v[48:51]
  v_exp_f32 v39, v39
  v_mfma_f32_16x16x32_bf16 v[48:51], a[108:111], a[28:31], v[48:51]
  ds_read_b64_tr_b16 a[138:139], v8 offset:13312
  v_cvt_pk_bf16_f32 v81, v38, v39
  v_mfma_f32_16x16x32_bf16 v[52:55], a[80:83], a[32:35], v[24:27]
  v_exp_f32 v40, v40
  v_mfma_f32_16x16x32_bf16 v[52:55], a[84:87], a[36:39], v[52:55]
  ds_read_b64_tr_b16 a[140:141], v9 offset:9216
  ds_read_b64_tr_b16 a[142:143], v9 offset:13312
  v_mfma_f32_16x16x32_bf16 v[52:55], a[88:91], a[40:43], v[52:55]
  v_exp_f32 v41, v41
  v_mfma_f32_16x16x32_bf16 v[52:55], a[92:95], a[44:47], v[52:55]
  v_cvt_pk_bf16_f32 v82, v40, v41
  v_xor_b32 v6, 0x4000, v6
  v_mfma_f32_16x16x32_bf16 v[56:59], a[96:99], a[32:35], v[24:27]
  v_exp_f32 v42, v42
  v_mfma_f32_16x16x32_bf16 v[56:59], a[100:103], a[36:39], v[56:59]
  v_xor_b32 v7, 0x4000, v7
  v_xor_b32 v8, 0x4000, v8
  v_mfma_f32_16x16x32_bf16 v[56:59], a[104:107], a[40:43], v[56:59]
  v_exp_f32 v43, v43
  v_mfma_f32_16x16x32_bf16 v[56:59], a[108:111], a[44:47], v[56:59]
  v_cvt_pk_bf16_f32 v83, v42, v43
  v_xor_b32 v9, 0x4000, v9
  v_mfma_f32_16x16x32_bf16 v[60:63], a[80:83], a[48:51], v[28:31]
  v_exp_f32 v44, v44
  v_mfma_f32_16x16x32_bf16 v[60:63], a[84:87], a[52:55], v[60:63]
  v_mfma_f32_16x16x32_bf16 v[60:63], a[88:91], a[56:59], v[60:63]
  v_exp_f32 v45, v45
  v_mfma_f32_16x16x32_bf16 v[60:63], a[92:95], a[60:63], v[60:63]
  v_cvt_pk_bf16_f32 v88, v44, v45
  v_mfma_f32_16x16x32_bf16 v[64:67], a[96:99], a[48:51], v[28:31]
  v_exp_f32 v46, v46
  v_mfma_f32_16x16x32_bf16 v[64:67], a[100:103], a[52:55], v[64:67]
  v_mfma_f32_16x16x32_bf16 v[64:67], a[104:107], a[56:59], v[64:67]
  v_exp_f32 v47, v47
  v_mfma_f32_16x16x32_bf16 v[64:67], a[108:111], a[60:63], v[64:67]
  v_cvt_pk_bf16_f32 v89, v46, v47
  v_mfma_f32_16x16x32_bf16 v[68:71], a[80:83], a[64:67], v[32:35]
  v_exp_f32 v48, v48
  v_mfma_f32_16x16x32_bf16 v[68:71], a[84:87], a[68:71], v[68:71]
  v_mfma_f32_16x16x32_bf16 v[68:71], a[88:91], a[72:75], v[68:71]
  v_exp_f32 v49, v49
  v_mfma_f32_16x16x32_bf16 v[68:71], a[92:95], a[76:79], v[68:71]
  v_cvt_pk_bf16_f32 v90, v48, v49
  s_waitcnt vmcnt(10) lgkmcnt(0)
  v_mfma_f32_16x16x32_bf16 v[72:75], a[96:99], a[64:67], v[32:35]
  v_exp_f32 v50, v50
  v_mfma_f32_16x16x32_bf16 v[72:75], a[100:103], a[68:71], v[72:75]
  s_barrier
  v_mfma_f32_16x16x32_bf16 v[72:75], a[104:107], a[72:75], v[72:75]
  v_exp_f32 v51, v51
  v_mfma_f32_16x16x32_bf16 v[72:75], a[108:111], a[76:79], v[72:75]
  s_xor_b32 m0, s32, 0x2000
  v_cvt_pk_bf16_f32 v91, v50, v51
  v_mfma_f32_16x16x32_bf16 v[128:131], a[112:115], v[76:79], v[128:131]
  v_exp_f32 v52, v52
  v_mfma_f32_16x16x32_bf16 v[160:163], a[112:115], v[84:87], v[160:163]
  buffer_load_dwordx4 v10, s[16:19], s25 offen offset:0  lds
  v_mfma_f32_16x16x32_bf16 v[192:195], a[112:115], v[92:95], v[192:195]
  v_exp_f32 v53, v53
  v_mfma_f32_16x16x32_bf16 v[224:227], a[112:115], v[100:103], v[224:227]
  ds_read_b128 a[80:83], v4 offset:0
  v_cvt_pk_bf16_f32 v96, v52, v53
  v_mfma_f32_16x16x32_bf16 a[168:171], a[112:115], v[108:111], a[168:171]
  v_exp_f32 v54, v54
  v_mfma_f32_16x16x32_bf16 v[132:135], a[116:119], v[76:79], v[132:135]
  ds_read_b128 a[84:87], v5 offset:0
  ds_read_b128 a[88:91], v4 offset:1024
  v_mfma_f32_16x16x32_bf16 v[164:167], a[116:119], v[84:87], v[164:167]
  buffer_load_dwordx4 v11, s[16:19], s25 offen offset:1024  lds
  v_mfma_f32_16x16x32_bf16 v[196:199], a[116:119], v[92:95], v[196:199]
  v_exp_f32 v55, v55
  v_mfma_f32_16x16x32_bf16 v[228:231], a[116:119], v[100:103], v[228:231]
  ds_read_b128 a[92:95], v5 offset:1024
  v_cvt_pk_bf16_f32 v97, v54, v55
  v_mfma_f32_16x16x32_bf16 a[172:175], a[116:119], v[108:111], a[172:175]
  v_exp_f32 v56, v56
  v_mfma_f32_16x16x32_bf16 v[136:139], a[120:123], v[76:79], v[136:139]
  buffer_load_dwordx4 v12, s[16:19], s25 offen offset:2048  lds
  v_mfma_f32_16x16x32_bf16 v[168:171], a[120:123], v[84:87], v[168:171]
  v_exp_f32 v57, v57
  v_mfma_f32_16x16x32_bf16 v[200:203], a[120:123], v[92:95], v[200:203]
  ds_read_b128 a[96:99], v4 offset:4096
  v_cvt_pk_bf16_f32 v98, v56, v57
  v_mfma_f32_16x16x32_bf16 v[232:235], a[120:123], v[100:103], v[232:235]
  v_exp_f32 v58, v58
  v_mfma_f32_16x16x32_bf16 a[176:179], a[120:123], v[108:111], a[176:179]
  ds_read_b128 a[100:103], v5 offset:4096
  ds_read_b128 a[104:107], v4 offset:5120
  v_mfma_f32_16x16x32_bf16 v[140:143], a[124:127], v[76:79], v[140:143]
  v_exp_f32 v59, v59
  v_mfma_f32_16x16x32_bf16 v[172:175], a[124:127], v[84:87], v[172:175]
  ds_read_b128 a[108:111], v5 offset:5120
  v_cvt_pk_bf16_f32 v99, v58, v59
  v_mfma_f32_16x16x32_bf16 v[204:207], a[124:127], v[92:95], v[204:207]
  v_exp_f32 v60, v60
  v_mfma_f32_16x16x32_bf16 v[236:239], a[124:127], v[100:103], v[236:239]
  buffer_load_dwordx4 v13, s[16:19], s25 offen offset:3072  lds
  v_mfma_f32_16x16x32_bf16 a[180:183], a[124:127], v[108:111], a[180:183]
  v_exp_f32 v61, v61
  v_mfma_f32_16x16x32_bf16 v[144:147], a[128:131], v[76:79], v[144:147]
  s_add_u32 s25, s25, 8192
  v_cvt_pk_bf16_f32 v104, v60, v61
  v_mfma_f32_16x16x32_bf16 v[176:179], a[128:131], v[84:87], v[176:179]
  v_exp_f32 v62, v62
  v_mfma_f32_16x16x32_bf16 v[208:211], a[128:131], v[92:95], v[208:211]
  s_xor_b32 s32, s32, 0x4000
  s_mov_b32 m0, s35
  v_mfma_f32_16x16x32_bf16 v[240:243], a[128:131], v[100:103], v[240:243]
  v_exp_f32 v63, v63
  v_mfma_f32_16x16x32_bf16 a[184:187], a[128:131], v[108:111], a[184:187]
  v_cvt_pk_bf16_f32 v105, v62, v63
  v_mfma_f32_16x16x32_bf16 v[148:151], a[132:135], v[76:79], v[148:151]
  v_exp_f32 v64, v64
  v_mfma_f32_16x16x32_bf16 v[180:183], a[132:135], v[84:87], v[180:183]
  buffer_load_dwordx4 v123, s[12:15], s34 offen offset:2048 nt lds
  v_mfma_f32_16x16x32_bf16 v[212:215], a[132:135], v[92:95], v[212:215]
  v_exp_f32 v65, v65
  v_mfma_f32_16x16x32_bf16 v[244:247], a[132:135], v[100:103], v[244:247]
  v_cvt_pk_bf16_f32 v106, v64, v65
  v_mfma_f32_16x16x32_bf16 a[188:191], a[132:135], v[108:111], a[188:191]
  v_exp_f32 v66, v66
  v_mfma_f32_16x16x32_bf16 v[152:155], a[136:139], v[76:79], v[152:155]
  v_mfma_f32_16x16x32_bf16 v[184:187], a[136:139], v[84:87], v[184:187]
  v_exp_f32 v67, v67
  v_mfma_f32_16x16x32_bf16 v[216:219], a[136:139], v[92:95], v[216:219]
  v_cvt_pk_bf16_f32 v107, v66, v67
  v_mfma_f32_16x16x32_bf16 v[248:251], a[136:139], v[100:103], v[248:251]
  v_exp_f32 v68, v68
  v_mfma_f32_16x16x32_bf16 a[192:195], a[136:139], v[108:111], a[192:195]
  v_mfma_f32_16x16x32_bf16 v[156:159], a[140:143], v[76:79], v[156:159]
  v_exp_f32 v69, v69
  v_mfma_f32_16x16x32_bf16 v[188:191], a[140:143], v[84:87], v[188:191]
  v_cvt_pk_bf16_f32 v112, v68, v69
  v_mfma_f32_16x16x32_bf16 v[220:223], a[140:143], v[92:95], v[220:223]
  v_exp_f32 v70, v70
  v_mfma_f32_16x16x32_bf16 v[252:255], a[140:143], v[100:103], v[252:255]
  s_waitcnt lgkmcnt(0)
  v_mfma_f32_16x16x32_bf16 a[196:199], a[140:143], v[108:111], a[196:199]
  s_cmp_eq_u32 s25, s26
  s_cbranch_scc0 L_odd_r0a
  s_cmp_eq_u32 s26, s27
  s_cbranch_scc1 L_exit_r0a
  s_mov_b32 s26, s27
  s_mov_b32 s34, s83
  s_mov_b32 s36, 0
  s_mov_b32 s37, 0
  s_mov_b32 s35, 152576
  s_mov_b32 s38, 0
  s_mov_b32 s39, 0
  s_branch L_odd_r0a
L_exit_r0a:
  v_smfmac_f32_16x16x64_bf16 a[144:147], a[164:167], v[76:83], v1
  v_add_u32 v2, s33, v4
  v_add_u32 v3, s33, v5
  v_smfmac_f32_16x16x64_bf16 a[148:151], a[164:167], v[84:91], v1
  ds_read_b64_tr_b16 a[112:113], v6 offset:0
  ds_read_b64_tr_b16 a[114:115], v6 offset:4096
  v_smfmac_f32_16x16x64_bf16 a[152:155], a[164:167], v[92:99], v1
  ds_read_b64_tr_b16 a[116:117], v7 offset:0
  ds_read_b64_tr_b16 a[118:119], v7 offset:4096
  v_smfmac_f32_16x16x64_bf16 a[156:159], a[164:167], v[100:107], v1
  ds_read_b64_tr_b16 a[120:121], v8 offset:0
  ds_read_b64_tr_b16 a[122:123], v8 offset:4096
  ds_read_b64_tr_b16 a[124:125], v9 offset:0
  ds_read_b64_tr_b16 a[126:127], v9 offset:4096
  ds_read_b64_tr_b16 a[128:129], v6 offset:1024
  ds_read_b64_tr_b16 a[130:131], v6 offset:5120
  ds_read_b64_tr_b16 a[132:133], v7 offset:1024
  ds_read_b64_tr_b16 a[134:135], v7 offset:5120
  ds_read_b64_tr_b16 a[136:137], v8 offset:1024
  ds_read_b64_tr_b16 a[138:139], v8 offset:5120
  ds_read_b64_tr_b16 a[140:141], v9 offset:1024
  ds_read_b64_tr_b16 a[142:143], v9 offset:5120
  s_waitcnt vmcnt(10)
  s_waitcnt lgkmcnt(0)
  s_barrier
  v_mfma_f32_16x16x32_bf16 v[128:131], a[112:115], v[80:83], v[128:131]
  ds_read_b128 a[0:3], v2 offset:0
  ds_read_b128 a[16:19], v2 offset:4096
  v_mfma_f32_16x16x32_bf16 v[132:135], a[116:119], v[80:83], v[132:135]
  ds_read_b128 a[32:35], v2 offset:8192
  ds_read_b128 a[48:51], v2 offset:12288
  v_mfma_f32_16x16x32_bf16 v[136:139], a[120:123], v[80:83], v[136:139]
  ds_read_b128 a[4:7], v3 offset:0
  ds_read_b128 a[20:23], v3 offset:4096
  v_mfma_f32_16x16x32_bf16 v[140:143], a[124:127], v[80:83], v[140:143]
  ds_read_b128 a[36:39], v3 offset:8192
  ds_read_b128 a[52:55], v3 offset:12288
  v_mfma_f32_16x16x32_bf16 v[144:147], a[128:131], v[80:83], v[144:147]
  ds_read_b128 a[8:11], v2 offset:1024
  ds_read_b128 a[24:27], v2 offset:5120
  v_mfma_f32_16x16x32_bf16 v[148:151], a[132:135], v[80:83], v[148:151]
  ds_read_b128 a[40:43], v2 offset:9216
  ds_read_b128 a[56:59], v2 offset:13312
  v_mfma_f32_16x16x32_bf16 v[152:155], a[136:139], v[80:83], v[152:155]
  ds_read_b128 a[12:15], v3 offset:1024
  ds_read_b128 a[28:31], v3 offset:5120
  v_mfma_f32_16x16x32_bf16 v[156:159], a[140:143], v[80:83], v[156:159]
  ds_read_b128 a[44:47], v3 offset:9216
  ds_read_b128 a[60:63], v3 offset:13312
  s_waitcnt lgkmcnt(15)
  v_mfma_f32_16x16x32_bf16 v[36:39], a[202:205], a[0:3], 0
  s_mov_b32 m0, s32
  v_accvgpr_read_b32 v116, a144
  s_waitcnt lgkmcnt(14)
  v_mfma_f32_16x16x32_bf16 v[44:47], a[202:205], a[16:19], 0
  buffer_load_dwordx4 v10, s[16:19], s25 offen offset:0  lds
  s_waitcnt lgkmcnt(13)
  v_mfma_f32_16x16x32_bf16 v[52:55], a[202:205], a[32:35], 0
  buffer_load_dwordx4 v11, s[16:19], s25 offen offset:1024  lds
  s_waitcnt lgkmcnt(12)
  v_mfma_f32_16x16x32_bf16 v[60:63], a[202:205], a[48:51], 0
  buffer_load_dwordx4 v12, s[16:19], s25 offen offset:2048  lds
  v_mfma_f32_16x16x32_bf16 v[36:39], a[208:211], a[0:3], v[36:39]
  buffer_load_dwordx4 v13, s[16:19], s25 offen offset:3072  lds
  v_mfma_f32_16x16x32_bf16 v[44:47], a[208:211], a[16:19], v[44:47]
  v_accvgpr_read_b32 v126, a145
  v_add_f32 v116, v116, v126
  v_mfma_f32_16x16x32_bf16 v[52:55], a[208:211], a[32:35], v[52:55]
  v_cmp_nge_f32 vcc, s84, v116
  v_cvt_pk_bf16_f32 v36, v36, v37
  v_mfma_f32_16x16x32_bf16 v[60:63], a[208:211], a[48:51], v[60:63]
  v_cvt_pk_bf16_f32 v38, v38, v39
  v_cvt_pk_bf16_f32 v44, v44, v45
  v_mfma_f32_16x16x32_bf16 v[40:43], a[200:203], a[0:3], 0
  v_cvt_pk_bf16_f32 v46, v46, v47
  v_cvt_pk_bf16_f32 v52, v52, v53
  v_mfma_f32_16x16x32_bf16 v[48:51], a[200:203], a[16:19], 0
  v_cvt_pk_bf16_f32 v54, v54, v55
  v_cvt_pk_bf16_f32 v60, v60, v61
  v_mfma_f32_16x16x32_bf16 v[56:59], a[200:203], a[32:35], 0
  v_cvt_pk_bf16_f32 v62, v62, v63
  s_or_b64 s[96:97], s[96:97], vcc
  v_mfma_f32_16x16x32_bf16 v[64:67], a[200:203], a[48:51], 0
  v_cmp_nle_f32 vcc, s94, v116
  v_rcp_f32 v116, v116
  v_mfma_f32_16x16x32_bf16 v[40:43], a[206:209], a[0:3], v[40:43]
  v_accvgpr_write_b32 a0, v36
  v_accvgpr_write_b32 a1, v38
  v_mfma_f32_16x16x32_bf16 v[48:51], a[206:209], a[16:19], v[48:51]
  v_accvgpr_write_b32 a16, v44
  v_accvgpr_write_b32 a17, v46
  v_mfma_f32_16x16x32_bf16 v[56:59], a[206:209], a[32:35], v[56:59]
  v_accvgpr_write_b32 a32, v52
  v_accvgpr_write_b32 a33, v54
  v_mfma_f32_16x16x32_bf16 v[64:67], a[206:209], a[48:51], v[64:67]
  v_accvgpr_write_b32 a48, v60
  v_accvgpr_write_b32 a49, v62
  s_waitcnt lgkmcnt(11)
  v_mfma_f32_16x16x32_bf16 v[36:39], a[202:205], a[4:7], 0
  v_cvt_pk_bf16_f32 v40, v40, v41
  v_cvt_pk_bf16_f32 v42, v42, v43
  s_waitcnt lgkmcnt(10)
  v_mfma_f32_16x16x32_bf16 v[44:47], a[202:205], a[20:23], 0
  v_cvt_pk_bf16_f32 v48, v48, v49
  v_cvt_pk_bf16_f32 v50, v50, v51
  s_waitcnt lgkmcnt(9)
  v_mfma_f32_16x16x32_bf16 v[52:55], a[202:205], a[36:39], 0
  v_cvt_pk_bf16_f32 v56, v56, v57
  v_cvt_pk_bf16_f32 v58, v58, v59
  s_waitcnt lgkmcnt(8)
  v_mfma_f32_16x16x32_bf16 v[60:63], a[202:205], a[52:55], 0
  v_cvt_pk_bf16_f32 v64, v64, v65
  v_cvt_pk_bf16_f32 v66, v66, v67
  v_mfma_f32_16x16x32_bf16 v[36:39], a[208:211], a[4:7], v[36:39]
  v_accvgpr_write_b32 a2, v40
  v_accvgpr_write_b32 a3, v42
  v_mfma_f32_16x16x32_bf16 v[44:47], a[208:211], a[20:23], v[44:47]
  v_accvgpr_write_b32 a18, v48
  v_accvgpr_write_b32 a19, v50
  v_mfma_f32_16x16x32_bf16 v[52:55], a[208:211], a[36:39], v[52:55]
  v_accvgpr_write_b32 a34, v56
  v_accvgpr_write_b32 a35, v58
  v_mfma_f32_16x16x32_bf16 v[60:63], a[208:211], a[52:55], v[60:63]
  v_accvgpr_write_b32 a50, v64
  v_accvgpr_write_b32 a51, v66
  v_mfma_f32_16x16x32_bf16 v[40:43], a[200:203], a[4:7], 0
  v_cvt_pk_bf16_f32 v36, v36, v37
  v_cvt_pk_bf16_f32 v38, v38, v39
  v_mfma_f32_16x16x32_bf16 v[48:51], a[200:203], a[20:23], 0
  v_cvt_pk_bf16_f32 v44, v44, v45
  v_cvt_pk_bf16_f32 v46, v46, v47
  v_mfma_f32_16x16x32_bf16 v[56:59], a[200:203], a[36:39], 0
  v_cvt_pk_bf16_f32 v52, v52, v53
  v_cvt_pk_bf16_f32 v54, v54, v55
  v_mfma_f32_16x16x32_bf16 v[64:67], a[200:203], a[52:55], 0
  v_cvt_pk_bf16_f32 v60, v60, v61
  v_cvt_pk_bf16_f32 v62, v62, v63
  v_mfma_f32_16x16x32_bf16 v[40:43], a[206:209], a[4:7], v[40:43]
  v_accvgpr_write_b32 a4, v36
  v_accvgpr_write_b32 a5, v38
  v_mfma_f32_16x16x32_bf16 v[48:51], a[206:209], a[20:23], v[48:51]
  v_accvgpr_write_b32 a20, v44
  v_accvgpr_write_b32 a21, v46
  v_mfma_f32_16x16x32_bf16 v[56:59], a[206:209], a[36:39], v[56:59]
  v_accvgpr_write_b32 a36, v52
  v_accvgpr_write_b32 a37, v54
  v_mfma_f32_16x16x32_bf16 v[64:67], a[206:209], a[52:55], v[64:67]
  v_accvgpr_write_b32 a52, v60
  v_accvgpr_write_b32 a53, v62
  s_waitcnt lgkmcnt(7)
  v_mfma_f32_16x16x32_bf16 v[36:39], a[202:205], a[8:11], 0
  v_cvt_pk_bf16_f32 v40, v40, v41
  v_cvt_pk_bf16_f32 v42, v42, v43
  s_waitcnt lgkmcnt(6)
  v_mfma_f32_16x16x32_bf16 v[44:47], a[202:205], a[24:27], 0
  v_cvt_pk_bf16_f32 v48, v48, v49
  v_cvt_pk_bf16_f32 v50, v50, v51
  s_waitcnt lgkmcnt(5)
  v_mfma_f32_16x16x32_bf16 v[52:55], a[202:205], a[40:43], 0
  v_cvt_pk_bf16_f32 v56, v56, v57
  v_cvt_pk_bf16_f32 v58, v58, v59
  s_waitcnt lgkmcnt(4)
  v_mfma_f32_16x16x32_bf16 v[60:63], a[202:205], a[56:59], 0
  v_cvt_pk_bf16_f32 v64, v64, v65
  v_cvt_pk_bf16_f32 v66, v66, v67
  v_mfma_f32_16x16x32_bf16 v[36:39], a[208:211], a[8:11], v[36:39]
  v_accvgpr_write_b32 a6, v40
  v_accvgpr_write_b32 a7, v42
  v_mfma_f32_16x16x32_bf16 v[44:47], a[208:211], a[24:27], v[44:47]
  v_accvgpr_write_b32 a22, v48
  v_accvgpr_write_b32 a23, v50
  v_mfma_f32_16x16x32_bf16 v[52:55], a[208:211], a[40:43], v[52:55]
  v_accvgpr_write_b32 a38, v56
  v_accvgpr_write_b32 a39, v58
  v_mfma_f32_16x16x32_bf16 v[60:63], a[208:211], a[56:59], v[60:63]
  v_accvgpr_write_b32 a54, v64
  v_accvgpr_write_b32 a55, v66
  v_mfma_f32_16x16x32_bf16 v[40:43], a[200:203], a[8:11], 0
  v_cvt_pk_bf16_f32 v36, v36, v37
  v_cvt_pk_bf16_f32 v38, v38, v39
  v_mfma_f32_16x16x32_bf16 v[48:51], a[200:203], a[24:27], 0
  v_cvt_pk_bf16_f32 v44, v44, v45
  v_cvt_pk_bf16_f32 v46, v46, v47
  v_mfma_f32_16x16x32_bf16 v[56:59], a[200:203], a[40:43], 0
  v_cvt_pk_bf16_f32 v52, v52, v53
  v_cvt_pk_bf16_f32 v54, v54, v55
  v_mfma_f32_16x16x32_bf16 v[64:67], a[200:203], a[56:59], 0
  v_cvt_pk_bf16_f32 v60, v60, v61
  v_cvt_pk_bf16_f32 v62, v62, v63
  v_mfma_f32_16x16x32_bf16 v[40:43], a[206:209], a[8:11], v[40:43]
  v_accvgpr_write_b32 a8, v36
  v_accvgpr_write_b32 a9, v38
  v_mfma_f32_16x16x32_bf16 v[48:51], a[206:209], a[24:27], v[48:51]
  v_accvgpr_write_b32 a24, v44
  v_accvgpr_write_b32 a25, v46
  v_mfma_f32_16x16x32_bf16 v[56:59], a[206:209], a[40:43], v[56:59]
  v_accvgpr_write_b32 a40, v52
  v_accvgpr_write_b32 a41, v54
  v_mfma_f32_16x16x32_bf16 v[64:67], a[206:209], a[56:59], v[64:67]
  v_accvgpr_write_b32 a56, v60
  v_accvgpr_write_b32 a57, v62
  s_waitcnt lgkmcnt(3)
  v_mfma_f32_16x16x32_bf16 v[36:39], a[202:205], a[12:15], 0
  v_accvgpr_read_b32 v118, a148
  v_accvgpr_read_b32 v127, a149
  s_waitcnt lgkmcnt(2)
  v_mfma_f32_16x16x32_bf16 v[44:47], a[202:205], a[28:31], 0
  v_mul_f32 v128, v128, v116
  v_mul_f32 v129, v129, v116
  s_waitcnt lgkmcnt(1)
  v_mfma_f32_16x16x32_bf16 v[52:55], a[202:205], a[44:47], 0
  v_cvt_pk_bf16_f32 v40, v40, v41
  v_cvt_pk_bf16_f32 v42, v42, v43
  s_waitcnt lgkmcnt(0)
  v_mfma_f32_16x16x32_bf16 v[60:63], a[202:205], a[60:63], 0
  v_cvt_pk_bf16_f32 v48, v48, v49
  v_cvt_pk_bf16_f32 v50, v50, v51
  v_mfma_f32_16x16x32_bf16 v[36:39], a[208:211], a[12:15], v[36:39]
  v_cvt_pk_bf16_f32 v56, v56, v57
  v_cvt_pk_bf16_f32 v58, v58, v59
  v_mfma_f32_16x16x32_bf16 v[44:47], a[208:211], a[28:31], v[44:47]
  v_cvt_pk_bf16_f32 v64, v64, v65
  v_cvt_pk_bf16_f32 v66, v66, v67
  v_mfma_f32_16x16x32_bf16 v[52:55], a[208:211], a[44:47], v[52:55]
  v_add_f32 v118, v118, v127
  s_or_b64 s[96:97], s[96:97], vcc
  v_mfma_f32_16x16x32_bf16 v[60:63], a[208:211], a[60:63], v[60:63]
  v_mul_f32 v130, v130, v116
  v_mul_f32 v131, v131, v116
  v_mfma_f32_16x16x32_bf16 v[160:163], a[112:115], v[88:91], v[160:163]
  v_mul_f32 v132, v132, v116
  v_mul_f32 v133, v133, v116
  v_mfma_f32_16x16x32_bf16 v[164:167], a[116:119], v[88:91], v[164:167]
  v_cvt_pk_bf16_f32 v128, v128, v129
  v_accvgpr_write_b32 a10, v40
  v_mfma_f32_16x16x32_bf16 v[168:171], a[120:123], v[88:91], v[168:171]
  v_accvgpr_write_b32 a11, v42
  v_accvgpr_write_b32 a26, v48
  v_mfma_f32_16x16x32_bf16 v[40:43], a[200:203], a[12:15], 0
  v_accvgpr_write_b32 a27, v50
  v_accvgpr_write_b32 a42, v56
  v_mfma_f32_16x16x32_bf16 v[48:51], a[200:203], a[28:31], 0
  v_accvgpr_write_b32 a43, v58
  v_accvgpr_write_b32 a58, v64
  v_mfma_f32_16x16x32_bf16 v[56:59], a[200:203], a[44:47], 0
  v_accvgpr_write_b32 a59, v66
  v_mul_f32 v134, v134, v116
  v_mfma_f32_16x16x32_bf16 v[64:67], a[200:203], a[60:63], 0
  v_mul_f32 v135, v135, v116
  v_mul_f32 v136, v136, v116
  v_mfma_f32_16x16x32_bf16 v[172:175], a[124:127], v[88:91], v[172:175]
  v_mul_f32 v137, v137, v116
  v_cmp_nge_f32 vcc, s84, v118
  v_mfma_f32_16x16x32_bf16 v[176:179], a[128:131], v[88:91], v[176:179]
  v_cvt_pk_bf16_f32 v129, v130, v131
  v_cvt_pk_bf16_f32 v132, v132, v133
  v_mfma_f32_16x16x32_bf16 v[40:43], a[206:209], a[12:15], v[40:43]
  v_mul_f32 v138, v138, v116
  v_mul_f32 v139, v139, v116
  v_mfma_f32_16x16x32_bf16 v[48:51], a[206:209], a[28:31], v[48:51]
  v_mul_f32 v140, v140, v116
  v_mul_f32 v141, v141, v116
  v_mfma_f32_16x16x32_bf16 v[56:59], a[206:209], a[44:47], v[56:59]
  v_cvt_pk_bf16_f32 v133, v134, v135
  v_cvt_pk_bf16_f32 v136, v136, v137
  v_mfma_f32_16x16x32_bf16 v[64:67], a[206:209], a[60:63], v[64:67]
  s_or_b64 s[96:97], s[96:97], vcc
  ds_write_b64 v15, v[128:129] offset:0
  v_mfma_f32_16x16x32_bf16 v[180:183], a[132:135], v[88:91], v[180:183]
  v_mul_f32 v142, v142, v116
  v_mul_f32 v143, v143, v116
  v_mfma_f32_16x16x32_bf16 v[184:187], a[136:139], v[88:91], v[184:187]
  v_mul_f32 v144, v144, v116
  v_mul_f32 v145, v145, v116
  v_mfma_f32_16x16x32_bf16 v[188:191], a[140:143], v[88:91], v[188:191]
  v_cvt_pk_bf16_f32 v137, v138, v139
  v_cvt_pk_bf16_f32 v140, v140, v141
  v_mfma_f32_16x16x32_bf16 v[192:195], a[112:115], v[96:99], v[192:195]
  v_cmp_nle_f32 vcc, s94, v118
  v_mul_f32 v146, v146, v116
  v_mfma_f32_16x16x32_bf16 v[196:199], a[116:119], v[96:99], v[196:199]
  ds_write_b64 v15, v[132:133] offset:32
  v_mfma_f32_16x16x32_bf16 v[200:203], a[120:123], v[96:99], v[200:203]
  v_mul_f32 v147, v147, v116
  v_mul_f32 v148, v148, v116
  v_mfma_f32_16x16x32_bf16 v[204:207], a[124:127], v[96:99], v[204:207]
  v_mul_f32 v149, v149, v116
  v_cvt_pk_bf16_f32 v141, v142, v143
  v_mfma_f32_16x16x32_bf16 v[208:211], a[128:131], v[96:99], v[208:211]
  v_cvt_pk_bf16_f32 v144, v144, v145
  v_rcp_f32 v118, v118
  v_mfma_f32_16x16x32_bf16 v[212:215], a[132:135], v[96:99], v[212:215]
  v_cvt_pk_bf16_f32 v36, v36, v37
  v_cvt_pk_bf16_f32 v38, v38, v39
  v_mfma_f32_16x16x32_bf16 v[216:219], a[136:139], v[96:99], v[216:219]
  v_cvt_pk_bf16_f32 v44, v44, v45
  v_cvt_pk_bf16_f32 v46, v46, v47
  v_mfma_f32_16x16x32_bf16 v[220:223], a[140:143], v[96:99], v[220:223]
  v_cvt_pk_bf16_f32 v52, v52, v53
  v_cvt_pk_bf16_f32 v54, v54, v55
  v_mfma_f32_16x16x32_bf16 v[224:227], a[112:115], v[104:107], v[224:227]
  v_cvt_pk_bf16_f32 v60, v60, v61
  v_cvt_pk_bf16_f32 v62, v62, v63
  v_mfma_f32_16x16x32_bf16 v[228:231], a[116:119], v[104:107], v[228:231]
  ds_write_b64 v15, v[136:137] offset:64
  v_mfma_f32_16x16x32_bf16 v[232:235], a[120:123], v[104:107], v[232:235]
  v_mul_f32 v150, v150, v116
  v_mul_f32 v151, v151, v116
  v_mfma_f32_16x16x32_bf16 v[236:239], a[124:127], v[104:107], v[236:239]
  v_mul_f32 v152, v152, v116
  v_mul_f32 v153, v153, v116
  v_mfma_f32_16x16x32_bf16 v[240:243], a[128:131], v[104:107], v[240:243]
  v_cvt_pk_bf16_f32 v145, v146, v147
  v_cvt_pk_bf16_f32 v148, v148, v149
  v_mfma_f32_16x16x32_bf16 v[244:247], a[132:135], v[104:107], v[244:247]
  ds_write_b64 v15, v[140:141] offset:96
  v_mfma_f32_16x16x32_bf16 v[248:251], a[136:139], v[104:107], v[248:251]
  v_mul_f32 v154, v154, v116
  v_mul_f32 v155, v155, v116
  v_mfma_f32_16x16x32_bf16 v[252:255], a[140:143], v[104:107], v[252:255]
  v_mul_f32 v156, v156, v116
  v_mul_f32 v157, v157, v116
  v_accvgpr_read_b32 v120, a152
  v_accvgpr_read_b32 v126, a153
  v_accvgpr_write_b32 a12, v36
  v_accvgpr_write_b32 a13, v38
  v_mfma_f32_16x16x32_bf16 v[36:39], a[80:83], a[0:3], 0
  v_accvgpr_write_b32 a28, v44
  v_accvgpr_write_b32 a29, v46
  v_mfma_f32_16x16x32_bf16 v[44:47], a[80:83], a[16:19], 0
  v_accvgpr_write_b32 a44, v52
  v_accvgpr_write_b32 a45, v54
  v_mfma_f32_16x16x32_bf16 v[52:55], a[80:83], a[32:35], 0
  v_accvgpr_write_b32 a60, v60
  v_accvgpr_write_b32 a61, v62
  v_mfma_f32_16x16x32_bf16 v[60:63], a[80:83], a[48:51], 0
  v_cvt_pk_bf16_f32 v149, v150, v151
  v_cvt_pk_bf16_f32 v152, v152, v153
  v_mfma_f32_16x16x32_bf16 v[36:39], a[84:87], a[4:7], v[36:39]
  ds_write_b64 v15, v[144:145] offset:128
  v_mfma_f32_16x16x32_bf16 v[44:47], a[84:87], a[20:23], v[44:47]
  v_mul_f32 v158, v158, v116
  v_mul_f32 v159, v159, v116
  v_mfma_f32_16x16x32_bf16 v[52:55], a[84:87], a[36:39], v[52:55]
  v_mul_f32 v160, v160, v118
  v_mul_f32 v161, v161, v118
  v_mfma_f32_16x16x32_bf16 v[60:63], a[84:87], a[52:55], v[60:63]
  v_cvt_pk_bf16_f32 v153, v154, v155
  v_cvt_pk_bf16_f32 v156, v156, v157
  v_mfma_f32_16x16x32_bf16 v[36:39], a[88:91], a[8:11], v[36:39]
  v_add_f32 v120, v120, v126
  s_or_b64 s[96:97], s[96:97], vcc
  v_mfma_f32_16x16x32_bf16 v[44:47], a[88:91], a[24:27], v[44:47]
  ds_write_b64 v15, v[148:149] offset:160
  v_mfma_f32_16x16x32_bf16 v[52:55], a[88:91], a[40:43], v[52:55]
  v_mul_f32 v162, v162, v118
  v_mul_f32 v163, v163, v118
  v_mfma_f32_16x16x32_bf16 v[60:63], a[88:91], a[56:59], v[60:63]
  v_mul_f32 v164, v164, v118
  v_mul_f32 v165, v165, v118
  v_cvt_pk_bf16_f32 v157, v158, v159
  v_cvt_pk_bf16_f32 v160, v160, v161
  v_mul_f32 v166, v166, v118
  v_mul_f32 v167, v167, v118
  v_mul_f32 v168, v168, v118
  v_mul_f32 v169, v169, v118
  v_cmp_nge_f32 vcc, s84, v120
  v_cvt_pk_bf16_f32 v161, v162, v163
  v_cvt_pk_bf16_f32 v164, v164, v165
  v_mul_f32 v170, v170, v118
  v_mul_f32 v171, v171, v118
  v_mul_f32 v172, v172, v118
  v_mul_f32 v173, v173, v118
  v_cvt_pk_bf16_f32 v165, v166, v167
  v_cvt_pk_bf16_f32 v168, v168, v169
  s_or_b64 s[96:97], s[96:97], vcc
  ds_write_b64 v15, v[152:153] offset:192
  ds_write_b64 v15, v[156:157] offset:224
  ds_write_b64 v15, v[160:161] offset:4352
  v_mul_f32 v174, v174, v118
  v_mul_f32 v175, v175, v118
  v_mul_f32 v176, v176, v118
  v_mul_f32 v177, v177, v118
  v_exp_f32 v71, v71
  v_exp_f32 v72, v72
  v_exp_f32 v73, v73
  v_exp_f32 v74, v74
  v_exp_f32 v75, v75
  v_cvt_pk_bf16_f32 v169, v170, v171
  v_cvt_pk_bf16_f32 v172, v172, v173
  v_cmp_nle_f32 vcc, s94, v120
  v_mul_f32 v178, v178, v118
  v_mul_f32 v179, v179, v118
  v_mul_f32 v180, v180, v118
  v_mul_f32 v181, v181, v118
  v_cvt_pk_bf16_f32 v173, v174, v175
  v_cvt_pk_bf16_f32 v176, v176, v177
  v_rcp_f32 v120, v120
  v_mul_f32 v182, v182, v118
  v_mul_f32 v183, v183, v118
  v_mul_f32 v184, v184, v118
  v_mul_f32 v185, v185, v118
  v_cvt_pk_bf16_f32 v40, v40, v41
  v_cvt_pk_bf16_f32 v42, v42, v43
  v_cvt_pk_bf16_f32 v48, v48, v49
  v_cvt_pk_bf16_f32 v50, v50, v51
  v_cvt_pk_bf16_f32 v56, v56, v57
  v_cvt_pk_bf16_f32 v58, v58, v59
  v_cvt_pk_bf16_f32 v64, v64, v65
  v_cvt_pk_bf16_f32 v66, v66, v67
  v_cvt_pk_bf16_f32 v177, v178, v179
  v_cvt_pk_bf16_f32 v180, v180, v181
  v_cvt_pk_bf16_f32 v113, v70, v71
  v_cvt_pk_bf16_f32 v114, v72, v73
  v_cvt_pk_bf16_f32 v115, v74, v75
  v_mul_f32 v186, v186, v118
  v_mul_f32 v187, v187, v118
  v_smfmac_f32_16x16x64_bf16 a[160:163], a[164:167], v[108:115], v1
  ds_write_b64 v15, v[164:165] offset:4384
  v_mfma_f32_16x16x32_bf16 a[168:171], a[112:115], v[112:115], a[168:171]
  ds_write_b64 v15, v[168:169] offset:4416
  v_mfma_f32_16x16x32_bf16 a[172:175], a[116:119], v[112:115], a[172:175]
  ds_write_b64 v15, v[172:173] offset:4448
  v_mfma_f32_16x16x32_bf16 a[176:179], a[120:123], v[112:115], a[176:179]
  v_mul_f32 v188, v188, v118
  v_mul_f32 v189, v189, v118
  v_mfma_f32_16x16x32_bf16 a[180:183], a[124:127], v[112:115], a[180:183]
  v_accvgpr_read_b32 v122, a156
  v_accvgpr_read_b32 v127, a157
  v_mfma_f32_16x16x32_bf16 a[184:187], a[128:131], v[112:115], a[184:187]
  v_cvt_pk_bf16_f32 v181, v182, v183
  v_cvt_pk_bf16_f32 v184, v184, v185
  v_mfma_f32_16x16x32_bf16 a[188:191], a[132:135], v[112:115], a[188:191]
  v_accvgpr_write_b32 a14, v40
  v_accvgpr_write_b32 a15, v42
  v_mfma_f32_16x16x32_bf16 a[192:195], a[136:139], v[112:115], a[192:195]
  v_accvgpr_write_b32 a30, v48
  v_accvgpr_write_b32 a31, v50
  v_mfma_f32_16x16x32_bf16 v[36:39], a[92:95], a[12:15], v[36:39]
  v_accvgpr_write_b32 a46, v56
  v_accvgpr_write_b32 a47, v58
  v_mfma_f32_16x16x32_bf16 v[44:47], a[92:95], a[28:31], v[44:47]
  v_accvgpr_write_b32 a62, v64
  v_accvgpr_write_b32 a63, v66
  v_mfma_f32_16x16x32_bf16 v[52:55], a[92:95], a[44:47], v[52:55]
  ds_write_b64 v15, v[176:177] offset:4480
  v_mfma_f32_16x16x32_bf16 v[60:63], a[92:95], a[60:63], v[60:63]
  v_mul_f32 v190, v190, v118
  v_mul_f32 v191, v191, v118
  v_mfma_f32_16x16x32_bf16 a[196:199], a[140:143], v[112:115], a[196:199]
  v_mul_f32 v192, v192, v120
  v_mul_f32 v193, v193, v120
  v_cvt_pk_bf16_f32 v185, v186, v187
  v_cvt_pk_bf16_f32 v188, v188, v189
  v_add_f32 v122, v122, v127
  s_or_b64 s[96:97], s[96:97], vcc
  ds_write_b64 v15, v[180:181] offset:4512
  v_mul_f32 v194, v194, v120
  v_mul_f32 v195, v195, v120
  v_mul_f32 v196, v196, v120
  v_mul_f32 v197, v197, v120
  v_cvt_pk_bf16_f32 v189, v190, v191
  v_cvt_pk_bf16_f32 v192, v192, v193
  v_mul_f32 v198, v198, v120
  v_mul_f32 v199, v199, v120
  v_mul_f32 v200, v200, v120
  v_mul_f32 v201, v201, v120
  v_cmp_nge_f32 vcc, s84, v122
  v_cvt_pk_bf16_f32 v193, v194, v195
  v_cvt_pk_bf16_f32 v196, v196, v197
  v_mul_f32 v202, v202, v120
  v_mul_f32 v203, v203, v120
  v_mul_f32 v204, v204, v120
  v_mul_f32 v205, v205, v120
  v_cvt_pk_bf16_f32 v197, v198, v199
  v_cvt_pk_bf16_f32 v200, v200, v201
  s_or_b64 s[96:97], s[96:97], vcc
  ds_write_b64 v15, v[184:185] offset:4544
  ds_write_b64 v15, v[188:189] offset:4576
  ds_write_b64 v15, v[192:193] offset:8704
  v_mul_f32 v206, v206, v120
  v_mul_f32 v207, v207, v120
  v_mul_f32 v208, v208, v120
  v_mul_f32 v209, v209, v120
  v_cvt_pk_bf16_f32 v201, v202, v203
  v_cvt_pk_bf16_f32 v204, v204, v205
  v_cmp_nle_f32 vcc, s94, v122
  v_mul_f32 v210, v210, v120
  v_mul_f32 v211, v211, v120
  v_mul_f32 v212, v212, v120
  v_mul_f32 v213, v213, v120
  v_cvt_pk_bf16_f32 v205, v206, v207
  v_cvt_pk_bf16_f32 v208, v208, v209
  v_rcp_f32 v122, v122
  v_mul_f32 v214, v214, v120
  v_mul_f32 v215, v215, v120
  v_mul_f32 v216, v216, v120
  v_mul_f32 v217, v217, v120
  v_cvt_pk_bf16_f32 v209, v210, v211
  v_cvt_pk_bf16_f32 v212, v212, v213
  v_mul_f32 v218, v218, v120
  v_mul_f32 v219, v219, v120
  v_mul_f32 v220, v220, v120
  v_mul_f32 v221, v221, v120
  v_accvgpr_read_b32 v124, a160
  v_accvgpr_read_b32 v126, a161
  v_cvt_pk_bf16_f32 v213, v214, v215
  v_cvt_pk_bf16_f32 v216, v216, v217
  v_max3_f32 v16, v36, v37, v38
  v_max3_f32 v20, v44, v45, v46
  v_max3_f32 v24, v52, v53, v54
  v_max3_f32 v28, v60, v61, v62
  v_mul_f32 v222, v222, v120
  v_mul_f32 v223, v223, v120
  v_mul_f32 v224, v224, v122
  v_mul_f32 v225, v225, v122
  v_cvt_pk_bf16_f32 v217, v218, v219
  v_cvt_pk_bf16_f32 v220, v220, v221
  v_add_f32 v124, v124, v126
  s_or_b64 s[96:97], s[96:97], vcc
  ds_write_b64 v15, v[196:197] offset:8736
  ds_write_b64 v15, v[200:201] offset:8768
  ds_write_b64 v15, v[204:205] offset:8800
  ds_write_b64 v15, v[208:209] offset:8832
  ds_write_b64 v15, v[212:213] offset:8864
  v_mul_f32 v226, v226, v122
  v_mul_f32 v227, v227, v122
  v_mul_f32 v228, v228, v122
  v_mul_f32 v229, v229, v122
  v_max_f32 v16, v16, v39
  v_max_f32 v20, v20, v47
  v_max_f32 v24, v24, v55
  v_max_f32 v28, v28, v63
  v_cvt_pk_bf16_f32 v221, v222, v223
  v_cvt_pk_bf16_f32 v224, v224, v225
  v_mul_f32 v230, v230, v122
  v_mul_f32 v231, v231, v122
  v_mul_f32 v232, v232, v122
  v_mul_f32 v233, v233, v122
  v_cmp_nge_f32 vcc, s84, v124
  v_cvt_pk_bf16_f32 v225, v226, v227
  v_cvt_pk_bf16_f32 v228, v228, v229
  v_mov_b32 v17, v16
  v_mov_b32 v21, v20
  v_mov_b32 v25, v24
  v_mov_b32 v29, v28
  v_mul_f32 v234, v234, v122
  v_mul_f32 v235, v235, v122
  v_mul_f32 v236, v236, v122
  v_mul_f32 v237, v237, v122
  v_cvt_pk_bf16_f32 v229, v230, v231
  v_cvt_pk_bf16_f32 v232, v232, v233
  s_or_b64 s[96:97], s[96:97], vcc
  ds_write_b64 v15, v[216:217] offset:8896
  ds_write_b64 v15, v[220:221] offset:8928
  ds_write_b64 v15, v[224:225] offset:13056
  v_mul_f32 v238, v238, v122
  v_mul_f32 v239, v239, v122
  v_mul_f32 v240, v240, v122
  v_mul_f32 v241, v241, v122
  v_permlane32_swap_b32 v16, v17
  v_permlane32_swap_b32 v20, v21
  v_permlane32_swap_b32 v24, v25
  v_permlane32_swap_b32 v28, v29
  v_cvt_pk_bf16_f32 v233, v234, v235
  v_cvt_pk_bf16_f32 v236, v236, v237
  v_cmp_nle_f32 vcc, s94, v124
  v_mul_f32 v242, v242, v122
  v_mul_f32 v243, v243, v122
  v_mul_f32 v244, v244, v122
  v_mul_f32 v245, v245, v122
  v_cvt_pk_bf16_f32 v237, v238, v239
  v_cvt_pk_bf16_f32 v240, v240, v241
  v_rcp_f32 v124, v124
  v_max_f32 v16, v16, v17
  v_max_f32 v20, v20, v21
  v_max_f32 v24, v24, v25
  v_max_f32 v28, v28, v29
  v_mul_f32 v246, v246, v122
  v_mul_f32 v247, v247, v122
  v_mul_f32 v248, v248, v122
  v_mul_f32 v249, v249, v122
  v_cvt_pk_bf16_f32 v241, v242, v243
  v_cvt_pk_bf16_f32 v244, v244, v245
  v_accvgpr_read_b32 v108, a168
  v_accvgpr_read_b32 v109, a169
  v_mul_f32 v250, v250, v122
  v_mul_f32 v251, v251, v122
  v_mul_f32 v252, v252, v122
  v_mul_f32 v253, v253, v122
  v_mov_b32 v17, v16
  v_mov_b32 v21, v20
  v_mov_b32 v25, v24
  v_mov_b32 v29, v28
  v_cvt_pk_bf16_f32 v245, v246, v247
  v_cvt_pk_bf16_f32 v248, v248, v249
  v_accvgpr_read_b32 v110, a170
  v_accvgpr_read_b32 v111, a171
  v_accvgpr_read_b32 v112, a172
  v_accvgpr_read_b32 v113, a173
  v_mul_f32 v254, v254, v122
  v_mul_f32 v255, v255, v122
  v_mul_f32 v108, v108, v124
  v_mul_f32 v109, v109, v124
  v_cvt_pk_bf16_f32 v249, v250, v251
  v_cvt_pk_bf16_f32 v252, v252, v253
  v_accvgpr_read_b32 v114, a174
  v_accvgpr_read_b32 v115, a175
  v_permlane16_swap_b32 v16, v17
  v_permlane16_swap_b32 v20, v21
  v_permlane16_swap_b32 v24, v25
  v_permlane16_swap_b32 v28, v29
  v_mul_f32 v110, v110, v124
  v_mul_f32 v111, v111, v124
  v_mul_f32 v112, v112, v124
  v_mul_f32 v113, v113, v124
  v_cvt_pk_bf16_f32 v253, v254, v255
  v_cvt_pk_bf16_f32 v108, v108, v109
  v_mul_f32 v114, v114, v124
  v_mul_f32 v115, v115, v124
  v_max_f32 v16, v16, v17
  v_max_f32 v20, v20, v21
  v_max_f32 v24, v24, v25
  v_max_f32 v28, v28, v29
  v_cvt_pk_bf16_f32 v109, v110, v111
  v_cvt_pk_bf16_f32 v112, v112, v113
  v_cvt_pk_bf16_f32 v113, v114, v115
  v_sub_f32 v19, 0, v16
  v_sub_f32 v18, 0, v16
  v_sub_f32 v17, 0, v16
  v_sub_f32 v23, 0, v20
  v_sub_f32 v22, 0, v20
  v_sub_f32 v21, 0, v20
  v_sub_f32 v27, 0, v24
  v_sub_f32 v26, 0, v24
  v_sub_f32 v25, 0, v24
  v_sub_f32 v31, 0, v28
  v_sub_f32 v30, 0, v28
  v_sub_f32 v29, 0, v28
  v_sub_f32 v16, 0, v16
  v_sub_f32 v20, 0, v20
  v_sub_f32 v24, 0, v24
  v_mfma_f32_16x16x32_bf16 v[36:39], a[80:83], a[0:3], v[16:19]
  ds_write_b64 v15, v[228:229] offset:13088
  v_mfma_f32_16x16x32_bf16 v[40:43], a[96:99], a[0:3], v[16:19]
  ds_write_b64 v15, v[232:233] offset:13120
  v_mfma_f32_16x16x32_bf16 v[44:47], a[80:83], a[16:19], v[20:23]
  ds_write_b64 v15, v[236:237] offset:13152
  v_mfma_f32_16x16x32_bf16 v[48:51], a[96:99], a[16:19], v[20:23]
  ds_write_b64 v15, v[240:241] offset:13184
  v_mfma_f32_16x16x32_bf16 v[52:55], a[80:83], a[32:35], v[24:27]
  ds_write_b64 v15, v[244:245] offset:13216
  v_mfma_f32_16x16x32_bf16 v[56:59], a[96:99], a[32:35], v[24:27]
  ds_write_b64 v15, v[248:249] offset:13248
  v_mfma_f32_16x16x32_bf16 v[36:39], a[84:87], a[4:7], v[36:39]
  ds_write_b64 v15, v[252:253] offset:13280
  v_mfma_f32_16x16x32_bf16 v[40:43], a[100:103], a[4:7], v[40:43]
  ds_write_b64 v15, v[108:109] offset:17408
  v_mfma_f32_16x16x32_bf16 v[44:47], a[84:87], a[20:23], v[44:47]
  v_sub_f32 v28, 0, v28
  v_accvgpr_read_b32 v108, a176
  v_mfma_f32_16x16x32_bf16 v[48:51], a[100:103], a[20:23], v[48:51]
  ds_write_b64 v15, v[112:113] offset:17440
  v_mfma_f32_16x16x32_bf16 v[60:63], a[80:83], a[48:51], v[28:31]
  v_accvgpr_read_b32 v109, a177
  v_accvgpr_read_b32 v110, a178
  v_mfma_f32_16x16x32_bf16 v[64:67], a[96:99], a[48:51], v[28:31]
  v_accvgpr_read_b32 v111, a179
  v_accvgpr_read_b32 v112, a180
  v_mfma_f32_16x16x32_bf16 v[52:55], a[84:87], a[36:39], v[52:55]
  v_accvgpr_read_b32 v113, a181
  v_mul_f32 v108, v108, v124
  v_mfma_f32_16x16x32_bf16 v[56:59], a[100:103], a[36:39], v[56:59]
  v_mul_f32 v109, v109, v124
  v_accvgpr_read_b32 v114, a182
  v_mfma_f32_16x16x32_bf16 v[60:63], a[84:87], a[52:55], v[60:63]
  v_accvgpr_read_b32 v115, a183
  v_mul_f32 v110, v110, v124
  v_mfma_f32_16x16x32_bf16 v[64:67], a[100:103], a[52:55], v[64:67]
  v_mul_f32 v111, v111, v124
  v_mul_f32 v112, v112, v124
  v_mfma_f32_16x16x32_bf16 v[36:39], a[88:91], a[8:11], v[36:39]
  v_mul_f32 v113, v113, v124
  v_cvt_pk_bf16_f32 v108, v108, v109
  v_mfma_f32_16x16x32_bf16 v[40:43], a[104:107], a[8:11], v[40:43]
  v_mul_f32 v114, v114, v124
  v_mul_f32 v115, v115, v124
  v_mfma_f32_16x16x32_bf16 v[44:47], a[88:91], a[24:27], v[44:47]
  v_cvt_pk_bf16_f32 v109, v110, v111
  v_cvt_pk_bf16_f32 v112, v112, v113
  v_mfma_f32_16x16x32_bf16 v[48:51], a[104:107], a[24:27], v[48:51]
  v_cvt_pk_bf16_f32 v113, v114, v115
  v_accvgpr_read_b32 v110, a186
  v_mfma_f32_16x16x32_bf16 v[52:55], a[88:91], a[40:43], v[52:55]
  ds_write_b64 v15, v[108:109] offset:17472
  v_mfma_f32_16x16x32_bf16 v[56:59], a[104:107], a[40:43], v[56:59]
  ds_write_b64 v15, v[112:113] offset:17504
  v_mfma_f32_16x16x32_bf16 v[60:63], a[88:91], a[56:59], v[60:63]
  v_accvgpr_read_b32 v108, a184
  v_accvgpr_read_b32 v109, a185
  v_mfma_f32_16x16x32_bf16 v[64:67], a[104:107], a[56:59], v[64:67]
  v_accvgpr_read_b32 v111, a187
  v_accvgpr_read_b32 v112, a188
  v_mfma_f32_16x16x32_bf16 v[36:39], a[92:95], a[12:15], v[36:39]
  v_accvgpr_read_b32 v113, a189
  v_mul_f32 v108, v108, v124
  v_mfma_f32_16x16x32_bf16 v[40:43], a[108:111], a[12:15], v[40:43]
  v_mul_f32 v109, v109, v124
  v_accvgpr_read_b32 v114, a190
  v_mfma_f32_16x16x32_bf16 v[44:47], a[92:95], a[28:31], v[44:47]
  v_accvgpr_read_b32 v115, a191
  v_mul_f32 v110, v110, v124
  v_mfma_f32_16x16x32_bf16 v[48:51], a[108:111], a[28:31], v[48:51]
  v_mul_f32 v111, v111, v124
  v_mul_f32 v112, v112, v124
  v_mfma_f32_16x16x32_bf16 v[52:55], a[92:95], a[44:47], v[52:55]
  v_mul_f32 v113, v113, v124
  v_cvt_pk_bf16_f32 v108, v108, v109
  v_mfma_f32_16x16x32_bf16 v[56:59], a[108:111], a[44:47], v[56:59]
  v_mul_f32 v114, v114, v124
  v_mul_f32 v115, v115, v124
  v_mfma_f32_16x16x32_bf16 v[60:63], a[92:95], a[60:63], v[60:63]
  v_cvt_pk_bf16_f32 v109, v110, v111
  v_cvt_pk_bf16_f32 v112, v112, v113
  v_mfma_f32_16x16x32_bf16 v[64:67], a[108:111], a[60:63], v[64:67]
  v_cvt_pk_bf16_f32 v113, v114, v115
  v_accvgpr_read_b32 v110, a194
  v_accvgpr_read_b32 v111, a195
  v_accvgpr_read_b32 v114, a198
  v_accvgpr_read_b32 v115, a199
  v_mul_f32 v110, v110, v124
  v_mul_f32 v111, v111, v124
  v_mul_f32 v114, v114, v124
  v_mul_f32 v115, v115, v124
  s_mov_b32 m0, 152576
  ds_write_b64 v15, v[108:109] offset:17536
  ds_write_b64 v15, v[112:113] offset:17568
  v_accvgpr_read_b32 v108, a192
  v_accvgpr_read_b32 v109, a193
  v_accvgpr_read_b32 v112, a196
  v_accvgpr_read_b32 v113, a197
  v_mul_f32 v108, v108, v124
  v_mul_f32 v109, v109, v124
  v_mul_f32 v112, v112, v124
  v_mul_f32 v113, v113, v124
  v_cvt_pk_bf16_f32 v108, v108, v109
  v_exp_f32 v36, v36
  v_exp_f32 v37, v37
  v_exp_f32 v38, v38
  v_exp_f32 v39, v39
  v_exp_f32 v40, v40
  v_exp_f32 v41, v41
  v_exp_f32 v42, v42
  v_exp_f32 v43, v43
  v_exp_f32 v44, v44
  v_exp_f32 v45, v45
  v_exp_f32 v46, v46
  v_exp_f32 v47, v47
  v_exp_f32 v48, v48
  v_exp_f32 v49, v49
  v_exp_f32 v50, v50
  v_exp_f32 v51, v51
  v_exp_f32 v52, v52
  v_exp_f32 v53, v53
  v_exp_f32 v54, v54
  v_exp_f32 v55, v55
  v_exp_f32 v56, v56
  v_exp_f32 v57, v57
  v_exp_f32 v58, v58
  v_exp_f32 v59, v59
  v_exp_f32 v60, v60
  v_exp_f32 v61, v61
  v_exp_f32 v62, v62
  v_exp_f32 v63, v63
  v_cvt_pk_bf16_f32 v109, v110, v111
  v_cvt_pk_bf16_f32 v112, v112, v113
  v_cvt_pk_bf16_f32 v113, v114, v115
  s_mov_b32 s34, s30
  buffer_load_dwordx4 v14, s[12:15], s83 offen lds
  ds_write_b64 v15, v[108:109] offset:17600
  ds_read_b128 a[80:83], v4 offset:8192
  ds_read_b128 a[84:87], v5 offset:8192
  ds_read_b128 a[88:91], v4 offset:9216
  ds_read_b128 a[92:95], v5 offset:9216
  ds_read_b128 a[96:99], v4 offset:12288
  ds_read_b128 a[100:103], v5 offset:12288
  ds_read_b128 a[104:107], v4 offset:13312
  ds_read_b128 a[108:111], v5 offset:13312
  s_mov_b32 s95, s30
  v_exp_f32 v64, v64
  s_add_u32 s25, s25, 8192
  s_mov_b32 m0, s32
  v_cvt_pk_bf16_f32 v76, v36, v37
  v_cvt_pk_bf16_f32 v77, v38, v39
  v_cvt_pk_bf16_f32 v78, v40, v41
  v_cvt_pk_bf16_f32 v79, v42, v43
  v_cvt_pk_bf16_f32 v84, v44, v45
  v_cvt_pk_bf16_f32 v85, v46, v47
  v_cvt_pk_bf16_f32 v86, v48, v49
  v_cvt_pk_bf16_f32 v87, v50, v51
  v_cvt_pk_bf16_f32 v92, v52, v53
  v_cvt_pk_bf16_f32 v93, v54, v55
  v_cvt_pk_bf16_f32 v94, v56, v57
  v_cvt_pk_bf16_f32 v95, v58, v59
  v_cvt_pk_bf16_f32 v100, v60, v61
  v_cvt_pk_bf16_f32 v101, v62, v63
  s_or_b64 s[96:97], s[96:97], vcc
  ds_write_b64 v15, v[112:113] offset:17632
  v_accvgpr_write_b32 a144, 0
  v_accvgpr_write_b32 a145, 0
  v_accvgpr_write_b32 a146, 0
  v_accvgpr_write_b32 a147, 0
  v_accvgpr_write_b32 a148, 0
  v_accvgpr_write_b32 a149, 0
  v_accvgpr_write_b32 a150, 0
  v_accvgpr_write_b32 a151, 0
  v_accvgpr_write_b32 a152, 0
  v_accvgpr_write_b32 a153, 0
  v_accvgpr_write_b32 a154, 0
  v_accvgpr_write_b32 a155, 0
  v_accvgpr_write_b32 a156, 0
  v_accvgpr_write_b32 a157, 0
  v_accvgpr_write_b32 a158, 0
  v_accvgpr_write_b32 a159, 0
  v_xor_b32 v4, 0x4000, v4
  v_xor_b32 v5, 0x4000, v5
  s_mov_b32 s36, 2048
  s_mov_b32 s37, 2176
  s_mov_b32 s28, 1
  s_mov_b32 s29, s85
  s_mov_b32 s30, s31
  v_lshrrev_b32 v124, 4, v0
  v_mul_u32_u24 v124, 272, v124
  v_and_b32 v125, 15, v0
  v_lshl_add_u32 v124, v125, 4, v124
  v_add_u32 v120, s33, v124
  s_waitcnt lgkmcnt(0)
  s_add_u32 s26, s25, 172032
  s_add_u32 s27, s25, 253952
  v_mfma_f32_16x16x32_bf16 v[36:39], a[80:83], a[0:3], v[16:19]
  v_exp_f32 v65, v65
  v_mfma_f32_16x16x32_bf16 v[36:39], a[84:87], a[4:7], v[36:39]
  v_cvt_pk_bf16_f32 v102, v64, v65
  v_mfma_f32_16x16x32_bf16 v[36:39], a[88:91], a[8:11], v[36:39]
  v_exp_f32 v66, v66
  v_mfma_f32_16x16x32_bf16 v[36:39], a[92:95], a[12:15], v[36:39]
  ds_read_b64_tr_b16 a[112:113], v6 offset:8192
  ds_read_b64_tr_b16 a[114:115], v6 offset:12288
  v_mfma_f32_16x16x32_bf16 v[40:43], a[96:99], a[0:3], v[16:19]
  v_exp_f32 v67, v67
  v_mfma_f32_16x16x32_bf16 v[40:43], a[100:103], a[4:7], v[40:43]
  ds_read_b64_tr_b16 a[116:117], v7 offset:8192
  v_cvt_pk_bf16_f32 v103, v66, v67
  v_mfma_f32_16x16x32_bf16 v[40:43], a[104:107], a[8:11], v[40:43]
  v_exp_f32 v36, v36
  v_mfma_f32_16x16x32_bf16 v[40:43], a[108:111], a[12:15], v[40:43]
  ds_read_b64_tr_b16 a[118:119], v7 offset:12288
  ds_read_b64_tr_b16 a[120:121], v8 offset:8192
  v_mfma_f32_16x16x32_bf16 v[44:47], a[80:83], a[16:19], v[20:23]
  v_exp_f32 v37, v37
  v_mfma_f32_16x16x32_bf16 v[44:47], a[84:87], a[20:23], v[44:47]
  ds_read_b64_tr_b16 a[122:123], v8 offset:12288
  v_cvt_pk_bf16_f32 v80, v36, v37
  v_mfma_f32_16x16x32_bf16 v[44:47], a[88:91], a[24:27], v[44:47]
  v_exp_f32 v38, v38
  v_mfma_f32_16x16x32_bf16 v[44:47], a[92:95], a[28:31], v[44:47]
  ds_read_b64_tr_b16 a[124:125], v9 offset:8192
  ds_read_b64_tr_b16 a[126:127], v9 offset:12288
  v_mfma_f32_16x16x32_bf16 v[48:51], a[96:99], a[16:19], v[20:23]
  v_exp_f32 v39, v39
  v_mfma_f32_16x16x32_bf16 v[48:51], a[100:103], a[20:23], v[48:51]
  ds_read_b64_tr_b16 a[128:129], v6 offset:9216
  v_cvt_pk_bf16_f32 v81, v38, v39
  v_mfma_f32_16x16x32_bf16 v[48:51], a[104:107], a[24:27], v[48:51]
  v_exp_f32 v40, v40
  v_mfma_f32_16x16x32_bf16 v[48:51], a[108:111], a[28:31], v[48:51]
  ds_read_b64_tr_b16 a[130:131], v6 offset:13312
  ds_read_b64_tr_b16 a[132:133], v7 offset:9216
  v_mfma_f32_16x16x32_bf16 v[52:55], a[80:83], a[32:35], v[24:27]
  v_exp_f32 v41, v41
  v_mfma_f32_16x16x32_bf16 v[52:55], a[84:87], a[36:39], v[52:55]
  ds_read_b64_tr_b16 a[134:135], v7 offset:13312
  v_cvt_pk_bf16_f32 v82, v40, v41
  v_mfma_f32_16x16x32_bf16 v[52:55], a[88:91], a[40:43], v[52:55]
  v_exp_f32 v42, v42
  v_mfma_f32_16x16x32_bf16 v[52:55], a[92:95], a[44:47], v[52:55]
  ds_read_b64_tr_b16 a[136:137], v8 offset:9216
  ds_read_b64_tr_b16 a[138:139], v8 offset:13312
  v_mfma_f32_16x16x32_bf16 v[56:59], a[96:99], a[32:35], v[24:27]
  v_exp_f32 v43, v43
  v_mfma_f32_16x16x32_bf16 v[56:59], a[100:103], a[36:39], v[56:59]
  ds_read_b64_tr_b16 a[140:141], v9 offset:9216
  v_cvt_pk_bf16_f32 v83, v42, v43
  v_mfma_f32_16x16x32_bf16 v[56:59], a[104:107], a[40:43], v[56:59]
  v_exp_f32 v44, v44
  v_mfma_f32_16x16x32_bf16 v[56:59], a[108:111], a[44:47], v[56:59]
  ds_read_b64_tr_b16 a[142:143], v9 offset:13312
  v_mfma_f32_16x16x32_bf16 v[60:63], a[80:83], a[48:51], v[28:31]
  v_exp_f32 v45, v45
  v_mfma_f32_16x16x32_bf16 v[60:63], a[84:87], a[52:55], v[60:63]
  v_cvt_pk_bf16_f32 v88, v44, v45
  v_xor_b32 v6, 0x4000, v6
  v_mfma_f32_16x16x32_bf16 v[60:63], a[88:91], a[56:59], v[60:63]
  v_exp_f32 v46, v46
  v_mfma_f32_16x16x32_bf16 v[60:63], a[92:95], a[60:63], v[60:63]
  v_xor_b32 v7, 0x4000, v7
  v_xor_b32 v8, 0x4000, v8
  v_mfma_f32_16x16x32_bf16 v[64:67], a[96:99], a[48:51], v[28:31]
  v_exp_f32 v47, v47
  v_mfma_f32_16x16x32_bf16 v[64:67], a[100:103], a[52:55], v[64:67]
  v_cvt_pk_bf16_f32 v89, v46, v47
  s_waitcnt vmcnt(10) lgkmcnt(0)
  v_mfma_f32_16x16x32_bf16 v[64:67], a[104:107], a[56:59], v[64:67]
  s_barrier
  v_mfma_f32_16x16x32_bf16 v[64:67], a[108:111], a[60:63], v[64:67]
  v_exp_f32 v48, v48
  v_mfma_f32_16x16x32_bf16 v[128:131], a[112:115], v[76:79], 0
  s_xor_b32 m0, m0, 0x2000
  ds_read_b128 a[80:83], v4 offset:0
  v_mfma_f32_16x16x32_bf16 v[160:163], a[112:115], v[84:87], 0
  v_exp_f32 v49, v49
  v_mfma_f32_16x16x32_bf16 v[192:195], a[112:115], v[92:95], 0
  ds_read_b128 a[84:87], v5 offset:0
  v_cvt_pk_bf16_f32 v90, v48, v49
  v_mfma_f32_16x16x32_bf16 v[224:227], a[112:115], v[100:103], 0
  v_exp_f32 v50, v50
  v_mfma_f32_16x16x32_bf16 v[132:135], a[116:119], v[76:79], 0
  buffer_load_dwordx4 v10, s[16:19], s25 offen offset:0  lds
  v_mfma_f32_16x16x32_bf16 v[164:167], a[116:119], v[84:87], 0
  v_exp_f32 v51, v51
  v_mfma_f32_16x16x32_bf16 v[196:199], a[116:119], v[92:95], 0
  ds_read_b128 a[88:91], v4 offset:1024
  v_cvt_pk_bf16_f32 v91, v50, v51
  v_mfma_f32_16x16x32_bf16 v[228:231], a[116:119], v[100:103], 0
  v_exp_f32 v52, v52
  v_mfma_f32_16x16x32_bf16 v[136:139], a[120:123], v[76:79], 0
  buffer_load_dwordx4 v11, s[16:19], s25 offen offset:1024  lds
  v_mfma_f32_16x16x32_bf16 v[168:171], a[120:123], v[84:87], 0
  v_exp_f32 v53, v53
  v_mfma_f32_16x16x32_bf16 v[200:203], a[120:123], v[92:95], 0
  ds_read_b128 a[92:95], v5 offset:1024
  v_cvt_pk_bf16_f32 v96, v52, v53
  v_mfma_f32_16x16x32_bf16 v[232:235], a[120:123], v[100:103], 0
  v_exp_f32 v54, v54
  v_mfma_f32_16x16x32_bf16 v[140:143], a[124:127], v[76:79], 0
  buffer_load_dwordx4 v12, s[16:19], s25 offen offset:2048  lds
  v_mfma_f32_16x16x32_bf16 v[172:175], a[124:127], v[84:87], 0
  v_exp_f32 v55, v55
  v_mfma_f32_16x16x32_bf16 v[204:207], a[124:127], v[92:95], 0
  ds_read_b128 a[96:99], v4 offset:4096
  v_cvt_pk_bf16_f32 v97, v54, v55
  v_mfma_f32_16x16x32_bf16 v[236:239], a[124:127], v[100:103], 0
  v_exp_f32 v56, v56
  v_mfma_f32_16x16x32_bf16 v[144:147], a[128:131], v[76:79], 0
  ds_read_b128 a[100:103], v5 offset:4096
  ds_read_b128 a[104:107], v4 offset:5120
  v_mfma_f32_16x16x32_bf16 v[176:179], a[128:131], v[84:87], 0
  v_exp_f32 v57, v57
  v_mfma_f32_16x16x32_bf16 v[208:211], a[128:131], v[92:95], 0
  ds_read_b128 a[108:111], v5 offset:5120
  v_cvt_pk_bf16_f32 v98, v56, v57
  v_mfma_f32_16x16x32_bf16 v[240:243], a[128:131], v[100:103], 0
  v_exp_f32 v58, v58
  v_mfma_f32_16x16x32_bf16 v[148:151], a[132:135], v[76:79], 0
  buffer_load_dwordx4 v13, s[16:19], s25 offen offset:3072  lds
  v_mfma_f32_16x16x32_bf16 v[180:183], a[132:135], v[84:87], 0
  v_exp_f32 v59, v59
  v_mfma_f32_16x16x32_bf16 v[212:215], a[132:135], v[92:95], 0
  s_add_u32 s25, s25, 8192
  v_cvt_pk_bf16_f32 v99, v58, v59
  v_mfma_f32_16x16x32_bf16 v[244:247], a[132:135], v[100:103], 0
  v_exp_f32 v60, v60
  v_mfma_f32_16x16x32_bf16 v[152:155], a[136:139], v[76:79], 0
  buffer_store_dwordx4 v[116:119], v14, s[20:23], s83 offen offset:1024 sc1
  v_mfma_f32_16x16x32_bf16 v[184:187], a[136:139], v[84:87], 0
  v_exp_f32 v61, v61
  v_mfma_f32_16x16x32_bf16 v[216:219], a[136:139], v[92:95], 0
  v_cvt_pk_bf16_f32 v104, v60, v61
  v_mfma_f32_16x16x32_bf16 v[248:251], a[136:139], v[100:103], 0
  v_exp_f32 v62, v62
  v_mfma_f32_16x16x32_bf16 v[156:159], a[140:143], v[76:79], 0
  v_xor_b32 v9, 0x4000, v9
  v_mfma_f32_16x16x32_bf16 v[188:191], a[140:143], v[84:87], 0
  v_exp_f32 v63, v63
  v_mfma_f32_16x16x32_bf16 v[220:223], a[140:143], v[92:95], 0
  v_cvt_pk_bf16_f32 v105, v62, v63
  s_waitcnt lgkmcnt(0)
  v_mfma_f32_16x16x32_bf16 v[252:255], a[140:143], v[100:103], 0
L_odd_r0b:
  v_smfmac_f32_16x16x64_bf16 a[144:147], a[164:167], v[76:83], v1
  v_exp_f32 v64, v64
  v_mfma_f32_16x16x32_bf16 v[36:39], a[80:83], a[0:3], v[16:19]
  ds_read_b128 v[116:119], v120 offset:0
  ds_read_b64_tr_b16 a[112:113], v6 offset:0
  v_mfma_f32_16x16x32_bf16 v[36:39], a[84:87], a[4:7], v[36:39]
  v_exp_f32 v65, v65
  v_mfma_f32_16x16x32_bf16 v[36:39], a[88:91], a[8:11], v[36:39]
  ds_read_b64_tr_b16 a[114:115], v6 offset:4096
  v_cvt_pk_bf16_f32 v106, v64, v65
  v_mfma_f32_16x16x32_bf16 v[36:39], a[92:95], a[12:15], v[36:39]
  v_exp_f32 v66, v66
  v_mfma_f32_16x16x32_bf16 v[40:43], a[96:99], a[0:3], v[16:19]
  ds_read_b64_tr_b16 a[116:117], v7 offset:0
  ds_read_b64_tr_b16 a[118:119], v7 offset:4096
  v_mfma_f32_16x16x32_bf16 v[40:43], a[100:103], a[4:7], v[40:43]
  v_exp_f32 v67, v67
  v_mfma_f32_16x16x32_bf16 v[40:43], a[104:107], a[8:11], v[40:43]
  ds_read_b64_tr_b16 a[120:121], v8 offset:0
  v_cvt_pk_bf16_f32 v107, v66, v67
  v_mfma_f32_16x16x32_bf16 v[40:43], a[108:111], a[12:15], v[40:43]
  v_exp_f32 v36, v36
  v_smfmac_f32_16x16x64_bf16 a[148:151], a[164:167], v[84:91], v1
  ds_read_b64_tr_b16 a[122:123], v8 offset:4096
  ds_read_b64_tr_b16 a[124:125], v9 offset:0
  v_mfma_f32_16x16x32_bf16 v[44:47], a[80:83], a[16:19], v[20:23]
  v_exp_f32 v37, v37
  v_mfma_f32_16x16x32_bf16 v[44:47], a[84:87], a[20:23], v[44:47]
  ds_read_b64_tr_b16 a[126:127], v9 offset:4096
  v_cvt_pk_bf16_f32 v76, v36, v37
  v_mfma_f32_16x16x32_bf16 v[44:47], a[88:91], a[24:27], v[44:47]
  v_exp_f32 v38, v38
  v_mfma_f32_16x16x32_bf16 v[44:47], a[92:95], a[28:31], v[44:47]
  ds_read_b64_tr_b16 a[128:129], v6 offset:1024
  ds_read_b64_tr_b16 a[130:131], v6 offset:5120
  v_mfma_f32_16x16x32_bf16 v[48:51], a[96:99], a[16:19], v[20:23]
  v_exp_f32 v39, v39
  v_mfma_f32_16x16x32_bf16 v[48:51], a[100:103], a[20:23], v[48:51]
  ds_read_b64_tr_b16 a[132:133], v7 offset:1024
  v_cvt_pk_bf16_f32 v77, v38, v39
  v_mfma_f32_16x16x32_bf16 v[48:51], a[104:107], a[24:27], v[48:51]
  v_exp_f32 v40, v40
  v_mfma_f32_16x16x32_bf16 v[48:51], a[108:111], a[28:31], v[48:51]
  ds_read_b64_tr_b16 a[134:135], v7 offset:5120
  ds_read_b64_tr_b16 a[136:137], v8 offset:1024
  v_smfmac_f32_16x16x64_bf16 a[152:155], a[164:167], v[92:99], v1
  v_exp_f32 v41, v41
  v_mfma_f32_16x16x32_bf16 v[52:55], a[80:83], a[32:35], v[24:27]
  ds_read_b64_tr_b16 a[138:139], v8 offset:5120
  v_cvt_pk_bf16_f32 v78, v40, v41
  v_mfma_f32_16x16x32_bf16 v[52:55], a[84:87], a[36:39], v[52:55]
  v_exp_f32 v42, v42
  v_mfma_f32_16x16x32_bf16 v[52:55], a[88:91], a[40:43], v[52:55]
  ds_read_b64_tr_b16 a[140:141], v9 offset:1024
  ds_read_b64_tr_b16 a[142:143], v9 offset:5120
  v_mfma_f32_16x16x32_bf16 v[52:55], a[92:95], a[44:47], v[52:55]
  v_exp_f32 v43, v43
  v_mfma_f32_16x16x32_bf16 v[56:59], a[96:99], a[32:35], v[24:27]
  v_cvt_pk_bf16_f32 v79, v42, v43
  v_mfma_f32_16x16x32_bf16 v[56:59], a[100:103], a[36:39], v[56:59]
  v_exp_f32 v44, v44
  v_mfma_f32_16x16x32_bf16 v[56:59], a[104:107], a[40:43], v[56:59]
  v_mfma_f32_16x16x32_bf16 v[56:59], a[108:111], a[44:47], v[56:59]
  v_exp_f32 v45, v45
  v_smfmac_f32_16x16x64_bf16 a[156:159], a[164:167], v[100:107], v1
  v_cvt_pk_bf16_f32 v84, v44, v45
  v_mfma_f32_16x16x32_bf16 v[60:63], a[80:83], a[48:51], v[28:31]
  v_exp_f32 v46, v46
  v_mfma_f32_16x16x32_bf16 v[60:63], a[84:87], a[52:55], v[60:63]
  v_mfma_f32_16x16x32_bf16 v[60:63], a[88:91], a[56:59], v[60:63]
  v_exp_f32 v47, v47
  v_mfma_f32_16x16x32_bf16 v[60:63], a[92:95], a[60:63], v[60:63]
  v_cvt_pk_bf16_f32 v85, v46, v47
  v_mfma_f32_16x16x32_bf16 v[64:67], a[96:99], a[48:51], v[28:31]
  s_waitcnt vmcnt(10) lgkmcnt(0)
  v_mfma_f32_16x16x32_bf16 v[64:67], a[100:103], a[52:55], v[64:67]
  v_exp_f32 v48, v48
  v_mfma_f32_16x16x32_bf16 v[64:67], a[104:107], a[56:59], v[64:67]
  s_barrier
  v_mfma_f32_16x16x32_bf16 v[64:67], a[108:111], a[60:63], v[64:67]
  v_exp_f32 v49, v49
  v_mfma_f32_16x16x32_bf16 v[128:131], a[112:115], v[80:83], v[128:131]
  s_xor_b32 m0, m0, 0x6000
  v_cvt_pk_bf16_f32 v86, v48, v49
  v_mfma_f32_16x16x32_bf16 v[160:163], a[112:115], v[88:91], v[160:163]
  v_exp_f32 v50, v50
  v_mfma_f32_16x16x32_bf16 v[192:195], a[112:115], v[96:99], v[192:195]
  buffer_load_dwordx4 v10, s[16:19], s25 offen offset:0  lds
  v_mfma_f32_16x16x32_bf16 v[224:227], a[112:115], v[104:107], v[224:227]
  v_exp_f32 v51, v51
  v_mfma_f32_16x16x32_bf16 v[132:135], a[116:119], v[80:83], v[132:135]
  ds_read_b128 a[80:83], v4 offset:8192
  v_cvt_pk_bf16_f32 v87, v50, v51
  v_mfma_f32_16x16x32_bf16 v[164:167], a[116:119], v[88:91], v[164:167]
  v_exp_f32 v52, v52
  v_mfma_f32_16x16x32_bf16 v[196:199], a[116:119], v[96:99], v[196:199]
  ds_read_b128 a[84:87], v5 offset:8192
  ds_read_b128 a[88:91], v4 offset:9216
  v_mfma_f32_16x16x32_bf16 v[228:231], a[116:119], v[104:107], v[228:231]
  v_exp_f32 v53, v53
  v_mfma_f32_16x16x32_bf16 v[136:139], a[120:123], v[80:83], v[136:139]
  ds_read_b128 a[92:95], v5 offset:9216
  v_cvt_pk_bf16_f32 v92, v52, v53
  v_mfma_f32_16x16x32_bf16 v[168:171], a[120:123], v[88:91], v[168:171]
  v_exp_f32 v54, v54
  v_mfma_f32_16x16x32_bf16 v[200:203], a[120:123], v[96:99], v[200:203]
  buffer_load_dwordx4 v11, s[16:19], s25 offen offset:1024  lds
  v_mfma_f32_16x16x32_bf16 v[232:235], a[120:123], v[104:107], v[232:235]
  v_exp_f32 v55, v55
  v_mfma_f32_16x16x32_bf16 v[140:143], a[124:127], v[80:83], v[140:143]
  ds_read_b128 a[96:99], v4 offset:12288
  v_cvt_pk_bf16_f32 v93, v54, v55
  v_mfma_f32_16x16x32_bf16 v[172:175], a[124:127], v[88:91], v[172:175]
  v_exp_f32 v56, v56
  v_mfma_f32_16x16x32_bf16 v[204:207], a[124:127], v[96:99], v[204:207]
  buffer_load_dwordx4 v12, s[16:19], s25 offen offset:2048  lds
  v_mfma_f32_16x16x32_bf16 v[236:239], a[124:127], v[104:107], v[236:239]
  v_exp_f32 v57, v57
  v_mfma_f32_16x16x32_bf16 v[144:147], a[128:131], v[80:83], v[144:147]
  ds_read_b128 a[100:103], v5 offset:12288
  v_cvt_pk_bf16_f32 v94, v56, v57
  v_mfma_f32_16x16x32_bf16 v[176:179], a[128:131], v[88:91], v[176:179]
  v_exp_f32 v58, v58
  v_mfma_f32_16x16x32_bf16 v[208:211], a[128:131], v[96:99], v[208:211]
  buffer_load_dwordx4 v13, s[16:19], s25 offen offset:3072  lds
  v_mfma_f32_16x16x32_bf16 v[240:243], a[128:131], v[104:107], v[240:243]
  v_exp_f32 v59, v59
  v_mfma_f32_16x16x32_bf16 v[148:151], a[132:135], v[80:83], v[148:151]
  ds_read_b128 a[104:107], v4 offset:13312
  v_cvt_pk_bf16_f32 v95, v58, v59
  v_mfma_f32_16x16x32_bf16 v[180:183], a[132:135], v[88:91], v[180:183]
  v_exp_f32 v60, v60
  v_mfma_f32_16x16x32_bf16 v[212:215], a[132:135], v[96:99], v[212:215]
  ds_read_b128 a[108:111], v5 offset:13312
  s_add_u32 s25, s25, 8192
  v_mfma_f32_16x16x32_bf16 v[244:247], a[132:135], v[104:107], v[244:247]
  v_exp_f32 v61, v61
  v_mfma_f32_16x16x32_bf16 v[152:155], a[136:139], v[80:83], v[152:155]
  v_cvt_pk_bf16_f32 v100, v60, v61
  v_xor_b32 v4, 0x4000, v4
  v_mfma_f32_16x16x32_bf16 v[184:187], a[136:139], v[88:91], v[184:187]
  v_exp_f32 v62, v62
  v_mfma_f32_16x16x32_bf16 v[216:219], a[136:139], v[96:99], v[216:219]
  buffer_store_dwordx4 v[116:119], v14, s[20:23], s34 offen offset:0 sc1
  v_mfma_f32_16x16x32_bf16 v[248:251], a[136:139], v[104:107], v[248:251]
  v_exp_f32 v63, v63
  v_mfma_f32_16x16x32_bf16 v[156:159], a[140:143], v[80:83], v[156:159]
  v_cvt_pk_bf16_f32 v101, v62, v63
  v_xor_b32 v5, 0x4000, v5
  v_mfma_f32_16x16x32_bf16 v[188:191], a[140:143], v[88:91], v[188:191]
  v_mfma_f32_16x16x32_bf16 v[220:223], a[140:143], v[96:99], v[220:223]
  v_exp_f32 v64, v64
  v_mfma_f32_16x16x32_bf16 v[252:255], a[140:143], v[104:107], v[252:255]
  s_waitcnt lgkmcnt(0)
  v_mfma_f32_16x16x32_bf16 v[36:39], a[80:83], a[0:3], v[16:19]
  v_exp_f32 v65, v65
  v_mfma_f32_16x16x32_bf16 v[36:39], a[84:87], a[4:7], v[36:39]
  ds_read_b128 v[116:119], v120 offset:1088
  v_cvt_pk_bf16_f32 v102, v64, v65
  v_mfma_f32_16x16x32_bf16 v[36:39], a[88:91], a[8:11], v[36:39]
  v_exp_f32 v66, v66
  v_mfma_f32_16x16x32_bf16 v[36:39], a[92:95], a[12:15], v[36:39]
  ds_read_b64_tr_b16 a[112:113], v6 offset:8192
  ds_read_b64_tr_b16 a[114:115], v6 offset:12288
  v_mfma_f32_16x16x32_bf16 v[40:43], a[96:99], a[0:3], v[16:19]
  v_exp_f32 v67, v67
  v_mfma_f32_16x16x32_bf16 v[40:43], a[100:103], a[4:7], v[40:43]
  ds_read_b64_tr_b16 a[116:117], v7 offset:8192
  v_cvt_pk_bf16_f32 v103, v66, v67
  v_mfma_f32_16x16x32_bf16 v[40:43], a[104:107], a[8:11], v[40:43]
  v_exp_f32 v36, v36
  v_mfma_f32_16x16x32_bf16 v[40:43], a[108:111], a[12:15], v[40:43]
  ds_read_b64_tr_b16 a[118:119], v7 offset:12288
  ds_read_b64_tr_b16 a[120:121], v8 offset:8192
  v_mfma_f32_16x16x32_bf16 v[44:47], a[80:83], a[16:19], v[20:23]
  v_exp_f32 v37, v37
  v_mfma_f32_16x16x32_bf16 v[44:47], a[84:87], a[20:23], v[44:47]
  ds_read_b64_tr_b16 a[122:123], v8 offset:12288
  v_cvt_pk_bf16_f32 v80, v36, v37
  v_mfma_f32_16x16x32_bf16 v[44:47], a[88:91], a[24:27], v[44:47]
  v_exp_f32 v38, v38
  v_mfma_f32_16x16x32_bf16 v[44:47], a[92:95], a[28:31], v[44:47]
  ds_read_b64_tr_b16 a[124:125], v9 offset:8192
  ds_read_b64_tr_b16 a[126:127], v9 offset:12288
  v_mfma_f32_16x16x32_bf16 v[48:51], a[96:99], a[16:19], v[20:23]
  v_exp_f32 v39, v39
  v_mfma_f32_16x16x32_bf16 v[48:51], a[100:103], a[20:23], v[48:51]
  ds_read_b64_tr_b16 a[128:129], v6 offset:9216
  v_cvt_pk_bf16_f32 v81, v38, v39
  v_mfma_f32_16x16x32_bf16 v[48:51], a[104:107], a[24:27], v[48:51]
  v_exp_f32 v40, v40
  v_mfma_f32_16x16x32_bf16 v[48:51], a[108:111], a[28:31], v[48:51]
  ds_read_b64_tr_b16 a[130:131], v6 offset:13312
  ds_read_b64_tr_b16 a[132:133], v7 offset:9216
  v_mfma_f32_16x16x32_bf16 v[52:55], a[80:83], a[32:35], v[24:27]
  v_exp_f32 v41, v41
  v_mfma_f32_16x16x32_bf16 v[52:55], a[84:87], a[36:39], v[52:55]
  ds_read_b64_tr_b16 a[134:135], v7 offset:13312
  v_cvt_pk_bf16_f32 v82, v40, v41
  v_mfma_f32_16x16x32_bf16 v[52:55], a[88:91], a[40:43], v[52:55]
  v_exp_f32 v42, v42
  v_mfma_f32_16x16x32_bf16 v[52:55], a[92:95], a[44:47], v[52:55]
  ds_read_b64_tr_b16 a[136:137], v8 offset:9216
  ds_read_b64_tr_b16 a[138:139], v8 offset:13312
  v_mfma_f32_16x16x32_bf16 v[56:59], a[96:99], a[32:35], v[24:27]
  v_exp_f32 v43, v43
  v_mfma_f32_16x16x32_bf16 v[56:59], a[100:103], a[36:39], v[56:59]
  ds_read_b64_tr_b16 a[140:141], v9 offset:9216
  v_cvt_pk_bf16_f32 v83, v42, v43
  v_mfma_f32_16x16x32_bf16 v[56:59], a[104:107], a[40:43], v[56:59]
  v_exp_f32 v44, v44
  v_mfma_f32_16x16x32_bf16 v[56:59], a[108:111], a[44:47], v[56:59]
  ds_read_b64_tr_b16 a[142:143], v9 offset:13312
  v_add_u32 v120, s37, v120
  v_mfma_f32_16x16x32_bf16 v[60:63], a[80:83], a[48:51], v[28:31]
  v_exp_f32 v45, v45
  v_mfma_f32_16x16x32_bf16 v[60:63], a[84:87], a[52:55], v[60:63]
  v_cvt_pk_bf16_f32 v88, v44, v45
  v_xor_b32 v6, 0x4000, v6
  v_mfma_f32_16x16x32_bf16 v[60:63], a[88:91], a[56:59], v[60:63]
  v_exp_f32 v46, v46
  v_mfma_f32_16x16x32_bf16 v[60:63], a[92:95], a[60:63], v[60:63]
  v_xor_b32 v7, 0x4000, v7
  v_xor_b32 v8, 0x4000, v8
  v_mfma_f32_16x16x32_bf16 v[64:67], a[96:99], a[48:51], v[28:31]
  v_exp_f32 v47, v47
  v_mfma_f32_16x16x32_bf16 v[64:67], a[100:103], a[52:55], v[64:67]
  v_cvt_pk_bf16_f32 v89, v46, v47
  s_waitcnt vmcnt(10) lgkmcnt(0)
  v_mfma_f32_16x16x32_bf16 v[64:67], a[104:107], a[56:59], v[64:67]
  s_barrier
  v_mfma_f32_16x16x32_bf16 v[64:67], a[108:111], a[60:63], v[64:67]
  v_exp_f32 v48, v48
  v_mfma_f32_16x16x32_bf16 v[128:131], a[112:115], v[76:79], v[128:131]
  s_xor_b32 m0, m0, 0x2000
  ds_read_b128 a[80:83], v4 offset:0
  v_mfma_f32_16x16x32_bf16 v[160:163], a[112:115], v[84:87], v[160:163]
  v_exp_f32 v49, v49
  v_mfma_f32_16x16x32_bf16 v[192:195], a[112:115], v[92:95], v[192:195]
  ds_read_b128 a[84:87], v5 offset:0
  v_cvt_pk_bf16_f32 v90, v48, v49
  v_mfma_f32_16x16x32_bf16 v[224:227], a[112:115], v[100:103], v[224:227]
  v_exp_f32 v50, v50
  v_mfma_f32_16x16x32_bf16 v[132:135], a[116:119], v[76:79], v[132:135]
  buffer_load_dwordx4 v10, s[16:19], s25 offen offset:0  lds
  v_mfma_f32_16x16x32_bf16 v[164:167], a[116:119], v[84:87], v[164:167]
  v_exp_f32 v51, v51
  v_mfma_f32_16x16x32_bf16 v[196:199], a[116:119], v[92:95], v[196:199]
  ds_read_b128 a[88:91], v4 offset:1024
  v_cvt_pk_bf16_f32 v91, v50, v51
  v_mfma_f32_16x16x32_bf16 v[228:231], a[116:119], v[100:103], v[228:231]
  v_exp_f32 v52, v52
  v_mfma_f32_16x16x32_bf16 v[136:139], a[120:123], v[76:79], v[136:139]
  buffer_load_dwordx4 v11, s[16:19], s25 offen offset:1024  lds
  v_mfma_f32_16x16x32_bf16 v[168:171], a[120:123], v[84:87], v[168:171]
  v_exp_f32 v53, v53
  v_mfma_f32_16x16x32_bf16 v[200:203], a[120:123], v[92:95], v[200:203]
  ds_read_b128 a[92:95], v5 offset:1024
  v_cvt_pk_bf16_f32 v96, v52, v53
  v_mfma_f32_16x16x32_bf16 v[232:235], a[120:123], v[100:103], v[232:235]
  v_exp_f32 v54, v54
  v_mfma_f32_16x16x32_bf16 v[140:143], a[124:127], v[76:79], v[140:143]
  buffer_load_dwordx4 v12, s[16:19], s25 offen offset:2048  lds
  v_mfma_f32_16x16x32_bf16 v[172:175], a[124:127], v[84:87], v[172:175]
  v_exp_f32 v55, v55
  v_mfma_f32_16x16x32_bf16 v[204:207], a[124:127], v[92:95], v[204:207]
  ds_read_b128 a[96:99], v4 offset:4096
  v_cvt_pk_bf16_f32 v97, v54, v55
  v_mfma_f32_16x16x32_bf16 v[236:239], a[124:127], v[100:103], v[236:239]
  v_exp_f32 v56, v56
  v_mfma_f32_16x16x32_bf16 v[144:147], a[128:131], v[76:79], v[144:147]
  ds_read_b128 a[100:103], v5 offset:4096
  ds_read_b128 a[104:107], v4 offset:5120
  v_mfma_f32_16x16x32_bf16 v[176:179], a[128:131], v[84:87], v[176:179]
  v_exp_f32 v57, v57
  v_mfma_f32_16x16x32_bf16 v[208:211], a[128:131], v[92:95], v[208:211]
  ds_read_b128 a[108:111], v5 offset:5120
  v_cvt_pk_bf16_f32 v98, v56, v57
  v_mfma_f32_16x16x32_bf16 v[240:243], a[128:131], v[100:103], v[240:243]
  v_exp_f32 v58, v58
  v_mfma_f32_16x16x32_bf16 v[148:151], a[132:135], v[76:79], v[148:151]
  buffer_load_dwordx4 v13, s[16:19], s25 offen offset:3072  lds
  v_mfma_f32_16x16x32_bf16 v[180:183], a[132:135], v[84:87], v[180:183]
  v_exp_f32 v59, v59
  v_mfma_f32_16x16x32_bf16 v[212:215], a[132:135], v[92:95], v[212:215]
  s_add_u32 s25, s25, 8192
  v_cvt_pk_bf16_f32 v99, v58, v59
  v_mfma_f32_16x16x32_bf16 v[244:247], a[132:135], v[100:103], v[244:247]
  v_exp_f32 v60, v60
  v_mfma_f32_16x16x32_bf16 v[152:155], a[136:139], v[76:79], v[152:155]
  buffer_store_dwordx4 v[116:119], v14, s[20:23], s34 offen offset:1024 sc1
  v_mfma_f32_16x16x32_bf16 v[184:187], a[136:139], v[84:87], v[184:187]
  v_exp_f32 v61, v61
  v_mfma_f32_16x16x32_bf16 v[216:219], a[136:139], v[92:95], v[216:219]
  s_add_u32 s34, s34, s36
  v_cvt_pk_bf16_f32 v104, v60, v61
  v_mfma_f32_16x16x32_bf16 v[248:251], a[136:139], v[100:103], v[248:251]
  v_exp_f32 v62, v62
  v_mfma_f32_16x16x32_bf16 v[156:159], a[140:143], v[76:79], v[156:159]
  v_xor_b32 v9, 0x4000, v9
  v_mfma_f32_16x16x32_bf16 v[188:191], a[140:143], v[84:87], v[188:191]
  v_exp_f32 v63, v63
  v_mfma_f32_16x16x32_bf16 v[220:223], a[140:143], v[92:95], v[220:223]
  v_cvt_pk_bf16_f32 v105, v62, v63
  s_waitcnt lgkmcnt(0)
  v_mfma_f32_16x16x32_bf16 v[252:255], a[140:143], v[100:103], v[252:255]
  s_cmp_eq_u32 s25, s26
  s_cbranch_scc0 L_odd_r0b
  s_cmp_eq_u32 s26, s27
  s_cbranch_scc1 L_exit_r0b
  s_mov_b32 s26, s27
  s_mov_b32 s34, s83
  s_mov_b32 s36, 0
  s_mov_b32 s37, 0
  s_branch L_odd_r0b
L_exit_r0b:
  v_smfmac_f32_16x16x64_bf16 a[144:147], a[164:167], v[76:83], v1
  s_add_u32 s40, s30, 0
  s_add_u32 s41, s30, 4096
  v_smfmac_f32_16x16x64_bf16 a[148:151], a[164:167], v[84:91], v1
  v_lshrrev_b32 v2, 4, v0
  v_mul_u32_u24 v2, 272, v2
  v_smfmac_f32_16x16x64_bf16 a[152:155], a[164:167], v[92:99], v1
  v_and_b32 v3, 15, v0
  v_accvgpr_read_b32 v116, a144
  v_accvgpr_read_b32 v126, a145
  v_add_f32 v116, v116, v126
  v_cmp_nge_f32 vcc, s84, v116
  v_accvgpr_read_b32 v118, a148
  v_accvgpr_read_b32 v127, a149
  s_or_b64 s[98:99], s[98:99], vcc
  v_cmp_nle_f32 vcc, s94, v116
  v_rcp_f32 v116, v116
  v_add_f32 v118, v118, v127
  s_or_b64 s[98:99], s[98:99], vcc
  v_cmp_nge_f32 vcc, s84, v118
  v_accvgpr_read_b32 v120, a152
  v_accvgpr_read_b32 v126, a153
  s_or_b64 s[98:99], s[98:99], vcc
  v_cmp_nle_f32 vcc, s94, v118
  v_rcp_f32 v118, v118
  v_add_f32 v120, v120, v126
  v_mov_b32 v119, v118
  s_or_b64 s[98:99], s[98:99], vcc
  v_cmp_nge_f32 vcc, s84, v120
  v_lshl_add_u32 v2, v3, 4, v2
  v_add_u32 v2, s33, v2
  s_or_b64 s[98:99], s[98:99], vcc
  v_cmp_nle_f32 vcc, s94, v120
  v_rcp_f32 v120, v120
  ds_read_b64_tr_b16 a[112:113], v6 offset:0
  s_or_b64 s[98:99], s[98:99], vcc
  v_mov_b32 v121, v120
  ds_read_b64_tr_b16 a[114:115], v6 offset:4096
  ds_read_b64_tr_b16 a[116:117], v7 offset:0
  ds_read_b64_tr_b16 a[118:119], v7 offset:4096
  ds_read_b64_tr_b16 a[120:121], v8 offset:0
  ds_read_b64_tr_b16 a[122:123], v8 offset:4096
  ds_read_b64_tr_b16 a[124:125], v9 offset:0
  ds_read_b64_tr_b16 a[126:127], v9 offset:4096
  ds_read_b64_tr_b16 a[128:129], v6 offset:1024
  ds_read_b64_tr_b16 a[130:131], v6 offset:5120
  ds_read_b64_tr_b16 a[132:133], v7 offset:1024
  ds_read_b64_tr_b16 a[134:135], v7 offset:5120
  ds_read_b64_tr_b16 a[136:137], v8 offset:1024
  ds_read_b64_tr_b16 a[138:139], v8 offset:5120
  ds_read_b64_tr_b16 a[140:141], v9 offset:1024
  ds_read_b64_tr_b16 a[142:143], v9 offset:5120
  v_exp_f32 v64, v64
  v_exp_f32 v65, v65
  v_exp_f32 v66, v66
  v_exp_f32 v67, v67
  v_cvt_pk_bf16_f32 v106, v64, v65
  v_cvt_pk_bf16_f32 v107, v66, v67
  s_nop 1
  v_smfmac_f32_16x16x64_bf16 a[156:159], a[164:167], v[100:107], v1
  s_waitcnt lgkmcnt(14)
  v_mfma_f32_16x16x32_bf16 v[128:131], a[112:115], v[80:83], v[128:131]
  s_waitcnt lgkmcnt(12)
  v_mfma_f32_16x16x32_bf16 v[132:135], a[116:119], v[80:83], v[132:135]
  s_nop 0
  v_accvgpr_read_b32 v122, a156
  s_waitcnt lgkmcnt(10)
  v_mfma_f32_16x16x32_bf16 v[136:139], a[120:123], v[80:83], v[136:139]
  v_mul_f32 v128, v128, v116
  v_mul_f32 v129, v129, v116
  s_waitcnt lgkmcnt(8)
  v_mfma_f32_16x16x32_bf16 v[140:143], a[124:127], v[80:83], v[140:143]
  v_mul_f32 v130, v130, v116
  v_mul_f32 v131, v131, v116
  s_waitcnt lgkmcnt(6)
  v_mfma_f32_16x16x32_bf16 v[144:147], a[128:131], v[80:83], v[144:147]
  v_mul_f32 v132, v132, v116
  v_mul_f32 v133, v133, v116
  s_waitcnt lgkmcnt(4)
  v_mfma_f32_16x16x32_bf16 v[148:151], a[132:135], v[80:83], v[148:151]
  v_cvt_pk_bf16_f32 v128, v128, v129
  v_mul_f32 v134, v134, v116
  s_waitcnt lgkmcnt(2)
  v_mfma_f32_16x16x32_bf16 v[152:155], a[136:139], v[80:83], v[152:155]
  v_mul_f32 v135, v135, v116
  v_mul_f32 v136, v136, v116
  v_mfma_f32_16x16x32_bf16 v[160:163], a[112:115], v[88:91], v[160:163]
  v_mul_f32 v137, v137, v116
  v_cvt_pk_bf16_f32 v129, v130, v131
  s_waitcnt lgkmcnt(0)
  v_mfma_f32_16x16x32_bf16 v[156:159], a[140:143], v[80:83], v[156:159]
  v_cvt_pk_bf16_f32 v132, v132, v133
  v_mul_f32 v138, v138, v116
  v_mfma_f32_16x16x32_bf16 v[164:167], a[116:119], v[88:91], v[164:167]
  v_mul_f32 v139, v139, v116
  v_mul_f32 v140, v140, v116
  v_mfma_f32_16x16x32_bf16 v[168:171], a[120:123], v[88:91], v[168:171]
  v_mul_f32 v141, v141, v116
  v_cvt_pk_bf16_f32 v133, v134, v135
  v_mfma_f32_16x16x32_bf16 v[172:175], a[124:127], v[88:91], v[172:175]
  v_cvt_pk_bf16_f32 v136, v136, v137
  v_mul_f32 v142, v142, v116
  v_mfma_f32_16x16x32_bf16 v[176:179], a[128:131], v[88:91], v[176:179]
  ds_write_b64 v15, v[128:129] offset:0
  v_mfma_f32_16x16x32_bf16 v[180:183], a[132:135], v[88:91], v[180:183]
  v_mul_f32 v143, v143, v116
  v_mul_f32 v144, v144, v116
  v_mfma_f32_16x16x32_bf16 v[184:187], a[136:139], v[88:91], v[184:187]
  v_mul_f32 v145, v145, v116
  v_cvt_pk_bf16_f32 v137, v138, v139
  v_mfma_f32_16x16x32_bf16 v[188:191], a[140:143], v[88:91], v[188:191]
  v_cvt_pk_bf16_f32 v140, v140, v141
  v_mul_f32 v146, v146, v116
  v_mfma_f32_16x16x32_bf16 v[192:195], a[112:115], v[96:99], v[192:195]
  ds_write_b64 v15, v[132:133] offset:32
  v_mfma_f32_16x16x32_bf16 v[196:199], a[116:119], v[96:99], v[196:199]
  v_mul_f32 v147, v147, v116
  v_mul_f32 v148, v148, v116
  v_mfma_f32_16x16x32_bf16 v[200:203], a[120:123], v[96:99], v[200:203]
  v_mul_f32 v149, v149, v116
  v_cvt_pk_bf16_f32 v141, v142, v143
  v_mfma_f32_16x16x32_bf16 v[204:207], a[124:127], v[96:99], v[204:207]
  v_cvt_pk_bf16_f32 v144, v144, v145
  v_mul_f32 v150, v150, v116
  v_mfma_f32_16x16x32_bf16 v[208:211], a[128:131], v[96:99], v[208:211]
  ds_write_b64 v15, v[136:137] offset:64
  v_mfma_f32_16x16x32_bf16 v[212:215], a[132:135], v[96:99], v[212:215]
  v_mul_f32 v151, v151, v116
  v_mul_f32 v152, v152, v116
  v_mfma_f32_16x16x32_bf16 v[216:219], a[136:139], v[96:99], v[216:219]
  v_mul_f32 v153, v153, v116
  v_cvt_pk_bf16_f32 v145, v146, v147
  v_mfma_f32_16x16x32_bf16 v[224:227], a[112:115], v[104:107], v[224:227]
  v_cvt_pk_bf16_f32 v148, v148, v149
  v_mul_f32 v154, v154, v116
  v_mfma_f32_16x16x32_bf16 v[220:223], a[140:143], v[96:99], v[220:223]
  ds_write_b64 v15, v[140:141] offset:96
  v_mfma_f32_16x16x32_bf16 v[228:231], a[116:119], v[104:107], v[228:231]
  v_mul_f32 v155, v155, v116
  v_mul_f32 v156, v156, v116
  v_mfma_f32_16x16x32_bf16 v[232:235], a[120:123], v[104:107], v[232:235]
  v_mul_f32 v157, v157, v116
  v_cvt_pk_bf16_f32 v149, v150, v151
  v_mfma_f32_16x16x32_bf16 v[236:239], a[124:127], v[104:107], v[236:239]
  v_cvt_pk_bf16_f32 v152, v152, v153
  v_mul_f32 v158, v158, v116
  v_mfma_f32_16x16x32_bf16 v[240:243], a[128:131], v[104:107], v[240:243]
  ds_write_b64 v15, v[144:145] offset:128
  v_mfma_f32_16x16x32_bf16 v[244:247], a[132:135], v[104:107], v[244:247]
  v_mul_f32 v159, v159, v116
  v_cvt_pk_bf16_f32 v153, v154, v155
  v_mfma_f32_16x16x32_bf16 v[248:251], a[136:139], v[104:107], v[248:251]
  v_cvt_pk_bf16_f32 v156, v156, v157
  v_cvt_pk_bf16_f32 v157, v158, v159
  v_mfma_f32_16x16x32_bf16 v[252:255], a[140:143], v[104:107], v[252:255]
  ds_write_b64 v15, v[148:149] offset:160
  ds_write_b64 v15, v[152:153] offset:192
  ds_write_b64 v15, v[156:157] offset:224
  ds_read_b128 v[36:39], v2 offset:0
  ds_read_b128 v[40:43], v2 offset:1088
  ds_read_b128 v[44:47], v2 offset:2176
  ds_read_b128 v[48:51], v2 offset:3264
  v_pk_mul_f32 v[160:161], v[160:161], v[118:119]
  v_pk_mul_f32 v[162:163], v[162:163], v[118:119]
  v_pk_mul_f32 v[164:165], v[164:165], v[118:119]
  v_cvt_pk_bf16_f32 v160, v160, v161
  v_pk_mul_f32 v[166:167], v[166:167], v[118:119]
  v_pk_mul_f32 v[168:169], v[168:169], v[118:119]
  v_cvt_pk_bf16_f32 v161, v162, v163
  v_cvt_pk_bf16_f32 v164, v164, v165
  v_pk_mul_f32 v[170:171], v[170:171], v[118:119]
  v_pk_mul_f32 v[172:173], v[172:173], v[118:119]
  v_cvt_pk_bf16_f32 v165, v166, v167
  v_cvt_pk_bf16_f32 v168, v168, v169
  v_pk_mul_f32 v[174:175], v[174:175], v[118:119]
  v_pk_mul_f32 v[176:177], v[176:177], v[118:119]
  v_cvt_pk_bf16_f32 v169, v170, v171
  v_cvt_pk_bf16_f32 v172, v172, v173
  v_pk_mul_f32 v[178:179], v[178:179], v[118:119]
  v_pk_mul_f32 v[180:181], v[180:181], v[118:119]
  v_cvt_pk_bf16_f32 v173, v174, v175
  v_cvt_pk_bf16_f32 v176, v176, v177
  v_pk_mul_f32 v[182:183], v[182:183], v[118:119]
  v_pk_mul_f32 v[184:185], v[184:185], v[118:119]
  v_cvt_pk_bf16_f32 v177, v178, v179
  v_cvt_pk_bf16_f32 v180, v180, v181
  s_waitcnt lgkmcnt(3)
  buffer_store_dwordx4 v[36:39], v14, s[20:23], s40 offen offset:0 sc1
  s_waitcnt lgkmcnt(2)
  buffer_store_dwordx4 v[40:43], v14, s[20:23], s40 offen offset:1024 sc1
  s_waitcnt lgkmcnt(1)
  buffer_store_dwordx4 v[44:47], v14, s[20:23], s40 offen offset:2048 sc1
  s_waitcnt lgkmcnt(0)
  buffer_store_dwordx4 v[48:51], v14, s[20:23], s40 offen offset:3072 sc1
  ds_write_b64 v15, v[160:161] offset:4352
  ds_write_b64 v15, v[164:165] offset:4384
  ds_write_b64 v15, v[168:169] offset:4416
  ds_write_b64 v15, v[172:173] offset:4448
  v_pk_mul_f32 v[186:187], v[186:187], v[118:119]
  v_pk_mul_f32 v[188:189], v[188:189], v[118:119]
  v_cvt_pk_bf16_f32 v181, v182, v183
  v_cvt_pk_bf16_f32 v184, v184, v185
  v_pk_mul_f32 v[190:191], v[190:191], v[118:119]
  v_cvt_pk_bf16_f32 v185, v186, v187
  v_cvt_pk_bf16_f32 v188, v188, v189
  v_cvt_pk_bf16_f32 v189, v190, v191
  ds_write_b64 v15, v[176:177] offset:4480
  ds_write_b64 v15, v[180:181] offset:4512
  ds_write_b64 v15, v[184:185] offset:4544
  ds_write_b64 v15, v[188:189] offset:4576
  ds_read_b128 v[52:55], v2 offset:4352
  ds_read_b128 v[56:59], v2 offset:5440
  ds_read_b128 v[60:63], v2 offset:6528
  ds_read_b128 v[64:67], v2 offset:7616
  v_pk_mul_f32 v[192:193], v[192:193], v[120:121]
  v_pk_mul_f32 v[194:195], v[194:195], v[120:121]
  v_pk_mul_f32 v[196:197], v[196:197], v[120:121]
  v_cvt_pk_bf16_f32 v192, v192, v193
  v_pk_mul_f32 v[198:199], v[198:199], v[120:121]
  v_pk_mul_f32 v[200:201], v[200:201], v[120:121]
  v_cvt_pk_bf16_f32 v193, v194, v195
  v_cvt_pk_bf16_f32 v196, v196, v197
  v_pk_mul_f32 v[202:203], v[202:203], v[120:121]
  v_pk_mul_f32 v[204:205], v[204:205], v[120:121]
  v_cvt_pk_bf16_f32 v197, v198, v199
  v_cvt_pk_bf16_f32 v200, v200, v201
  v_pk_mul_f32 v[206:207], v[206:207], v[120:121]
  v_pk_mul_f32 v[208:209], v[208:209], v[120:121]
  v_cvt_pk_bf16_f32 v201, v202, v203
  v_cvt_pk_bf16_f32 v204, v204, v205
  v_pk_mul_f32 v[210:211], v[210:211], v[120:121]
  v_pk_mul_f32 v[212:213], v[212:213], v[120:121]
  v_cvt_pk_bf16_f32 v205, v206, v207
  v_cvt_pk_bf16_f32 v208, v208, v209
  v_pk_mul_f32 v[214:215], v[214:215], v[120:121]
  v_pk_mul_f32 v[216:217], v[216:217], v[120:121]
  v_cvt_pk_bf16_f32 v209, v210, v211
  v_cvt_pk_bf16_f32 v212, v212, v213
  s_waitcnt lgkmcnt(3)
  buffer_store_dwordx4 v[52:55], v14, s[20:23], s41 offen offset:0 sc1
  s_waitcnt lgkmcnt(2)
  buffer_store_dwordx4 v[56:59], v14, s[20:23], s41 offen offset:1024 sc1
  s_waitcnt lgkmcnt(1)
  buffer_store_dwordx4 v[60:63], v14, s[20:23], s41 offen offset:2048 sc1
  s_waitcnt lgkmcnt(0)
  buffer_store_dwordx4 v[64:67], v14, s[20:23], s41 offen offset:3072 sc1
  ds_write_b64 v15, v[192:193] offset:8704
  ds_write_b64 v15, v[196:197] offset:8736
  ds_write_b64 v15, v[200:201] offset:8768
  ds_write_b64 v15, v[204:205] offset:8800
  v_pk_mul_f32 v[218:219], v[218:219], v[120:121]
  v_pk_mul_f32 v[220:221], v[220:221], v[120:121]
  v_cvt_pk_bf16_f32 v213, v214, v215
  v_cvt_pk_bf16_f32 v216, v216, v217
  v_pk_mul_f32 v[222:223], v[222:223], v[120:121]
  v_cvt_pk_bf16_f32 v217, v218, v219
  v_cvt_pk_bf16_f32 v220, v220, v221
  v_cvt_pk_bf16_f32 v221, v222, v223
  s_add_u32 s40, s30, 8192
  ds_write_b64 v15, v[208:209] offset:8832
  ds_write_b64 v15, v[212:213] offset:8864
  ds_write_b64 v15, v[216:217] offset:8896
  ds_write_b64 v15, v[220:221] offset:8928
  ds_read_b128 v[36:39], v2 offset:8704
  ds_read_b128 v[40:43], v2 offset:9792
  ds_read_b128 v[44:47], v2 offset:10880
  ds_read_b128 v[48:51], v2 offset:11968
  v_accvgpr_read_b32 v127, a157
  v_add_f32 v122, v122, v127
  v_cmp_nge_f32 vcc, s84, v122
  s_add_u32 s41, s30, 12288
  s_nop 0
  s_or_b64 s[98:99], s[98:99], vcc
  v_cmp_nle_f32 vcc, s94, v122
  v_rcp_f32 v122, v122
  s_nop 0
  v_mov_b32 v123, v122
  v_pk_mul_f32 v[224:225], v[224:225], v[122:123]
  v_pk_mul_f32 v[226:227], v[226:227], v[122:123]
  v_pk_mul_f32 v[228:229], v[228:229], v[122:123]
  v_cvt_pk_bf16_f32 v224, v224, v225
  v_pk_mul_f32 v[230:231], v[230:231], v[122:123]
  v_pk_mul_f32 v[232:233], v[232:233], v[122:123]
  v_cvt_pk_bf16_f32 v225, v226, v227
  v_cvt_pk_bf16_f32 v228, v228, v229
  v_pk_mul_f32 v[234:235], v[234:235], v[122:123]
  v_pk_mul_f32 v[236:237], v[236:237], v[122:123]
  v_cvt_pk_bf16_f32 v229, v230, v231
  v_cvt_pk_bf16_f32 v232, v232, v233
  v_pk_mul_f32 v[238:239], v[238:239], v[122:123]
  s_waitcnt lgkmcnt(3)
  buffer_store_dwordx4 v[36:39], v14, s[20:23], s40 offen offset:0 sc1
  s_waitcnt lgkmcnt(2)
  buffer_store_dwordx4 v[40:43], v14, s[20:23], s40 offen offset:1024 sc1
  s_waitcnt lgkmcnt(1)
  buffer_store_dwordx4 v[44:47], v14, s[20:23], s40 offen offset:2048 sc1
  s_waitcnt lgkmcnt(0)
  buffer_store_dwordx4 v[48:51], v14, s[20:23], s40 offen offset:3072 sc1
  ds_write_b64 v15, v[224:225] offset:13056
  v_pk_mul_f32 v[240:241], v[240:241], v[122:123]
  v_cvt_pk_bf16_f32 v233, v234, v235
  v_cvt_pk_bf16_f32 v236, v236, v237
  v_pk_mul_f32 v[242:243], v[242:243], v[122:123]
  v_pk_mul_f32 v[244:245], v[244:245], v[122:123]
  v_cvt_pk_bf16_f32 v237, v238, v239
  v_cvt_pk_bf16_f32 v240, v240, v241
  v_pk_mul_f32 v[246:247], v[246:247], v[122:123]
  v_pk_mul_f32 v[248:249], v[248:249], v[122:123]
  v_cvt_pk_bf16_f32 v241, v242, v243
  v_cvt_pk_bf16_f32 v244, v244, v245
  v_pk_mul_f32 v[250:251], v[250:251], v[122:123]
  v_pk_mul_f32 v[252:253], v[252:253], v[122:123]
  v_cvt_pk_bf16_f32 v245, v246, v247
  v_cvt_pk_bf16_f32 v248, v248, v249
  v_pk_mul_f32 v[254:255], v[254:255], v[122:123]
  v_cvt_pk_bf16_f32 v249, v250, v251
  v_cvt_pk_bf16_f32 v252, v252, v253
  v_cvt_pk_bf16_f32 v253, v254, v255
  s_or_b64 s[98:99], s[98:99], vcc
  ds_write_b64 v15, v[228:229] offset:13088
  ds_write_b64 v15, v[232:233] offset:13120
  ds_write_b64 v15, v[236:237] offset:13152
  ds_write_b64 v15, v[240:241] offset:13184
  ds_write_b64 v15, v[244:245] offset:13216
  ds_write_b64 v15, v[248:249] offset:13248
  ds_write_b64 v15, v[252:253] offset:13280
  ds_read_b128 v[52:55], v2 offset:13056
  ds_read_b128 v[56:59], v2 offset:14144
  ds_read_b128 v[60:63], v2 offset:15232
  ds_read_b128 v[64:67], v2 offset:16320
  s_waitcnt lgkmcnt(3)
  buffer_store_dwordx4 v[52:55], v14, s[20:23], s41 offen offset:0 sc1
  s_waitcnt lgkmcnt(2)
  buffer_store_dwordx4 v[56:59], v14, s[20:23], s41 offen offset:1024 sc1
  s_waitcnt lgkmcnt(1)
  buffer_store_dwordx4 v[60:63], v14, s[20:23], s41 offen offset:2048 sc1
  s_waitcnt lgkmcnt(0)
  buffer_store_dwordx4 v[64:67], v14, s[20:23], s41 offen offset:3072 sc1
  s_branch L_done
L_role1:
  s_add_u32 m0, s33, 8192
  s_add_u32 s42, s30, 8192
  s_add_u32 s43, s30, 8320
  v_and_b32 v1, 15, v0
  v_lshrrev_b32 v116, 3, v1
  v_lshlrev_b32 v116, 11, v116
  v_and_b32 v117, 7, v1
  v_lshrrev_b32 v2, 4, v0
  v_lshl_add_u32 v116, v117, 7, v116
  v_bfe_u32 v117, v1, 1, 3
  v_add_u32 v118, 0, v2
  v_xor_b32 v118, v118, v117
  v_bfe_u32 v228, v0, 2, 2
  v_and_b32 v229, 1, v2
  v_lshl_add_u32 v4, v118, 4, v116
  v_mul_u32_u24 v15, 272, v1
  v_bfe_u32 v241, v0, 2, 2
  v_lshl_add_u32 v228, v229, 2, v228
  v_add_u32 v118, 4, v2
  v_lshl_add_u32 v15, v2, 3, v15
  v_lshrrev_b32 v229, 1, v2
  v_cmp_eq_u32 vcc, v2, v241
  v_xor_b32 v118, v118, v117
  v_lshl_add_u32 v5, v118, 4, v116
  v_and_b32 v242, 1, v0
  v_lshlrev_b32 v242, 4, v242
  v_mov_b32 v244, 15875
  v_bfe_u32 v243, v0, 1, 1
  v_lshlrev_b32 v244, v242, v244
  v_sub_u32 v243, 0, v243
  v_cndmask_b32 v244, 0, v244, vcc
  v_mov_b32 v248, 47576
  v_and_b32 v245, v243, v244
  v_lshlrev_b32 v248, v242, v248
  v_xor_b32 v244, v245, v244
  v_cndmask_b32 v248, 0, v248, vcc
  v_accvgpr_write_b32 a200, 0
  v_accvgpr_write_b32 a201, 0
  v_accvgpr_write_b32 a204, 0
  v_accvgpr_write_b32 a205, 0
  v_accvgpr_write_b32 a202, v244
  v_accvgpr_write_b32 a203, v245
  v_and_b32 v249, v243, v248
  v_xor_b32 v248, v249, v248
  v_accvgpr_write_b32 a206, 0
  v_accvgpr_write_b32 a207, 0
  v_accvgpr_write_b32 a210, 0
  v_accvgpr_write_b32 a211, 0
  v_accvgpr_write_b32 a208, v248
  v_accvgpr_write_b32 a209, v249
  v_lshlrev_b32 v229, 11, v229
  v_lshl_add_u32 v229, v228, 7, v229
  v_and_b32 v230, 1, v0
  v_lshl_add_u32 v229, v230, 3, v229
  v_bfe_u32 v230, v228, 1, 2
  v_bfe_u32 v231, v0, 1, 1
  v_lshlrev_b32 v230, 1, v230
  v_add_u32 v232, 0, v231
  v_add_u32 v229, 32768, v229
  v_xor_b32 v232, v232, v230
  v_lshl_add_u32 v6, v232, 4, v229
  v_add_u32 v232, 2, v231
  v_xor_b32 v232, v232, v230
  v_lshl_add_u32 v7, v232, 4, v229
  v_add_u32 v232, 4, v231
  v_xor_b32 v232, v232, v230
  v_lshl_add_u32 v8, v232, 4, v229
  v_add_u32 v232, 6, v231
  v_and_b32 v252, 1, v0
  v_xor_b32 v232, v232, v230
  v_mov_b32 v238, 0x3f803f80
  v_cmp_eq_u32 vcc, 0, v252
  v_mov_b32 v253, 0xeeeeeeee
  v_mov_b32 v254, 0x44444444
  v_lshlrev_b32 v14, 4, v0
  v_add_u32 v15, s33, v15
  v_lshl_add_u32 v9, v232, 4, v229
  s_mov_b32 s44, 0x3e0293ee
  s_mov_b32 s45, 0x3e0293ee
  s_mov_b32 s83, 0x7ff00000
  s_mov_b32 s84, 0x5d800000
  s_mov_b32 s94, 0x35800000
  s_mov_b64 s[96:97], 0
  s_mov_b64 s[98:99], 0
  s_mov_b32 s28, 0
  s_mov_b32 s20, s10
  s_mov_b32 s21, s11
  s_mov_b32 s22, 37748736
  s_mov_b32 s23, 0x00020000
  v_accvgpr_write_b32 a164, v238
  v_accvgpr_write_b32 a165, v238
  v_accvgpr_write_b32 a166, v238
  v_accvgpr_write_b32 a167, v238
  v_cndmask_b32 v1, v253, v254, vcc
  v_add_u32 v2, s33, v4
  v_add_u32 v3, s33, v5
  v_accvgpr_write_b32 a144, 0
  v_accvgpr_write_b32 a145, 0
  v_accvgpr_write_b32 a146, 0
  v_accvgpr_write_b32 a147, 0
  v_accvgpr_write_b32 a148, 0
  v_accvgpr_write_b32 a149, 0
  v_accvgpr_write_b32 a150, 0
  v_accvgpr_write_b32 a151, 0
  v_accvgpr_write_b32 a152, 0
  v_accvgpr_write_b32 a153, 0
  v_accvgpr_write_b32 a154, 0
  v_accvgpr_write_b32 a155, 0
  v_accvgpr_write_b32 a156, 0
  v_accvgpr_write_b32 a157, 0
  v_accvgpr_write_b32 a158, 0
  v_accvgpr_write_b32 a159, 0
  s_waitcnt vmcnt(8)
  buffer_load_dwordx4 v122, s[12:15], s42 offen offset:0 nt lds
  buffer_load_dwordx4 v123, s[12:15], s42 offen offset:2048 nt lds
  s_add_u32 m0, s33, 9216
  s_add_u32 s42, s30, 12288
  buffer_load_dwordx4 v122, s[12:15], s43 offen offset:0 nt lds
  buffer_load_dwordx4 v123, s[12:15], s43 offen offset:2048 nt lds
  s_add_u32 m0, s33, 12288
  s_add_u32 s43, s30, 12416
  s_barrier
  ds_read_b128 a[80:83], v4 offset:0
  ds_read_b128 a[84:87], v5 offset:0
  ds_read_b128 a[88:91], v4 offset:1024
  ds_read_b128 a[92:95], v5 offset:1024
  ds_read_b128 a[96:99], v4 offset:4096
  ds_read_b128 a[100:103], v5 offset:4096
  ds_read_b128 a[104:107], v4 offset:5120
  ds_read_b128 a[108:111], v5 offset:5120
  s_waitcnt vmcnt(8)
  buffer_load_dwordx4 v122, s[12:15], s42 offen offset:0 nt lds
  buffer_load_dwordx4 v123, s[12:15], s42 offen offset:2048 nt lds
  s_add_u32 m0, s33, 13312
  ds_read_b128 a[0:3], v2 offset:0
  buffer_load_dwordx4 v122, s[12:15], s43 offen offset:0 nt lds
  buffer_load_dwordx4 v123, s[12:15], s43 offen offset:2048 nt lds
  s_add_u32 m0, s47, 8192
  ds_read_b128 a[4:7], v3 offset:0
  ds_read_b128 a[8:11], v2 offset:1024
  ds_read_b128 a[12:15], v3 offset:1024
  s_waitcnt lgkmcnt(3)
  v_mfma_f32_16x16x32_bf16 v[128:131], a[202:205], a[0:3], 0
  v_mfma_f32_16x16x32_bf16 v[132:135], a[200:203], a[0:3], 0
  v_mfma_f32_16x16x32_bf16 v[128:131], a[208:211], a[0:3], v[128:131]
  v_mfma_f32_16x16x32_bf16 v[132:135], a[206:209], a[0:3], v[132:135]
  s_waitcnt lgkmcnt(2)
  v_mfma_f32_16x16x32_bf16 v[136:139], a[202:205], a[4:7], 0
  s_nop 0
  v_cvt_pk_bf16_f32 v128, v128, v129
  v_mfma_f32_16x16x32_bf16 v[140:143], a[200:203], a[4:7], 0
  v_cvt_pk_bf16_f32 v130, v130, v131
  v_cvt_pk_bf16_f32 v132, v132, v133
  v_mfma_f32_16x16x32_bf16 v[136:139], a[208:211], a[4:7], v[136:139]
  v_cvt_pk_bf16_f32 v134, v134, v135
  v_accvgpr_write_b32 a0, v128
  v_mfma_f32_16x16x32_bf16 v[140:143], a[206:209], a[4:7], v[140:143]
  v_accvgpr_write_b32 a1, v130
  v_accvgpr_write_b32 a2, v132
  s_waitcnt lgkmcnt(1)
  v_mfma_f32_16x16x32_bf16 v[144:147], a[202:205], a[8:11], 0
  v_accvgpr_write_b32 a3, v134
  v_cvt_pk_bf16_f32 v136, v136, v137
  v_mfma_f32_16x16x32_bf16 v[148:151], a[200:203], a[8:11], 0
  v_cvt_pk_bf16_f32 v138, v138, v139
  v_cvt_pk_bf16_f32 v140, v140, v141
  v_mfma_f32_16x16x32_bf16 v[144:147], a[208:211], a[8:11], v[144:147]
  v_cvt_pk_bf16_f32 v142, v142, v143
  v_accvgpr_write_b32 a4, v136
  v_mfma_f32_16x16x32_bf16 v[148:151], a[206:209], a[8:11], v[148:151]
  v_accvgpr_write_b32 a5, v138
  v_accvgpr_write_b32 a6, v140
  s_waitcnt lgkmcnt(0)
  v_mfma_f32_16x16x32_bf16 v[152:155], a[202:205], a[12:15], 0
  v_accvgpr_write_b32 a7, v142
  v_cvt_pk_bf16_f32 v144, v144, v145
  v_mfma_f32_16x16x32_bf16 v[156:159], a[200:203], a[12:15], 0
  v_cvt_pk_bf16_f32 v146, v146, v147
  v_cvt_pk_bf16_f32 v148, v148, v149
  v_mfma_f32_16x16x32_bf16 v[152:155], a[208:211], a[12:15], v[152:155]
  v_cvt_pk_bf16_f32 v150, v150, v151
  v_accvgpr_write_b32 a8, v144
  v_mfma_f32_16x16x32_bf16 v[156:159], a[206:209], a[12:15], v[156:159]
  v_accvgpr_write_b32 a9, v146
  v_accvgpr_write_b32 a10, v148
  v_mfma_f32_16x16x32_bf16 v[36:39], a[80:83], a[0:3], 0
  v_accvgpr_write_b32 a11, v150
  v_cvt_pk_bf16_f32 v152, v152, v153
  v_mfma_f32_16x16x32_bf16 v[36:39], a[84:87], a[4:7], v[36:39]
  v_cvt_pk_bf16_f32 v154, v154, v155
  v_cvt_pk_bf16_f32 v156, v156, v157
  v_mfma_f32_16x16x32_bf16 v[36:39], a[88:91], a[8:11], v[36:39]
  v_cvt_pk_bf16_f32 v158, v158, v159
  v_accvgpr_write_b32 a12, v152
  v_accvgpr_write_b32 a13, v154
  v_accvgpr_write_b32 a14, v156
  v_accvgpr_write_b32 a15, v158
  s_nop 1
  v_mfma_f32_16x16x32_bf16 v[36:39], a[92:95], a[12:15], v[36:39]
  s_waitcnt vmcnt(8)
  buffer_load_dwordx4 v10, s[16:19], s25 offen offset:0  lds
  buffer_load_dwordx4 v11, s[16:19], s25 offen offset:1024  lds
  buffer_load_dwordx4 v12, s[16:19], s25 offen offset:2048  lds
  buffer_load_dwordx4 v13, s[16:19], s25 offen offset:3072  lds
  s_add_u32 m0, s47, 16384
  ds_read_b128 a[16:19], v2 offset:4096
  ds_read_b128 a[20:23], v3 offset:4096
  s_add_u32 s25, s25, 8192
  ds_read_b128 a[24:27], v2 offset:5120
  ds_read_b128 a[28:31], v3 offset:5120
  v_max3_f32 v192, v36, v37, v38
  v_max_f32 v192, v192, v39
  v_mov_b32 v193, v192
  s_nop 1
  v_permlane32_swap_b32 v192, v193
  v_max_f32 v192, v192, v193
  v_mov_b32 v193, v192
  s_nop 1
  v_permlane16_swap_b32 v192, v193
  v_max_f32 v192, v192, v193
  v_sub_f32 v19, 0, v192
  v_sub_f32 v18, 0, v192
  v_sub_f32 v17, 0, v192
  v_sub_f32 v16, 0, v192
  s_nop 1
  v_mfma_f32_16x16x32_bf16 v[36:39], a[80:83], a[0:3], v[16:19]
  v_mfma_f32_16x16x32_bf16 v[40:43], a[96:99], a[0:3], v[16:19]
  s_waitcnt lgkmcnt(3)
  v_mfma_f32_16x16x32_bf16 v[160:163], a[202:205], a[16:19], 0
  v_mfma_f32_16x16x32_bf16 v[164:167], a[200:203], a[16:19], 0
  v_mfma_f32_16x16x32_bf16 v[160:163], a[208:211], a[16:19], v[160:163]
  v_mfma_f32_16x16x32_bf16 v[164:167], a[206:209], a[16:19], v[164:167]
  s_waitcnt lgkmcnt(2)
  v_mfma_f32_16x16x32_bf16 v[168:171], a[202:205], a[20:23], 0
  s_nop 0
  v_cvt_pk_bf16_f32 v160, v160, v161
  v_mfma_f32_16x16x32_bf16 v[172:175], a[200:203], a[20:23], 0
  v_cvt_pk_bf16_f32 v162, v162, v163
  v_cvt_pk_bf16_f32 v164, v164, v165
  v_mfma_f32_16x16x32_bf16 v[168:171], a[208:211], a[20:23], v[168:171]
  v_cvt_pk_bf16_f32 v166, v166, v167
  v_accvgpr_write_b32 a16, v160
  v_mfma_f32_16x16x32_bf16 v[172:175], a[206:209], a[20:23], v[172:175]
  v_accvgpr_write_b32 a17, v162
  v_accvgpr_write_b32 a18, v164
  s_waitcnt lgkmcnt(1)
  v_mfma_f32_16x16x32_bf16 v[176:179], a[202:205], a[24:27], 0
  v_accvgpr_write_b32 a19, v166
  v_cvt_pk_bf16_f32 v168, v168, v169
  v_mfma_f32_16x16x32_bf16 v[180:183], a[200:203], a[24:27], 0
  v_cvt_pk_bf16_f32 v170, v170, v171
  v_cvt_pk_bf16_f32 v172, v172, v173
  v_mfma_f32_16x16x32_bf16 v[176:179], a[208:211], a[24:27], v[176:179]
  v_cvt_pk_bf16_f32 v174, v174, v175
  v_accvgpr_write_b32 a20, v168
  v_mfma_f32_16x16x32_bf16 v[180:183], a[206:209], a[24:27], v[180:183]
  v_accvgpr_write_b32 a21, v170
  v_accvgpr_write_b32 a22, v172
  s_waitcnt lgkmcnt(0)
  v_mfma_f32_16x16x32_bf16 v[184:187], a[202:205], a[28:31], 0
  v_accvgpr_write_b32 a23, v174
  v_cvt_pk_bf16_f32 v176, v176, v177
  v_mfma_f32_16x16x32_bf16 v[188:191], a[200:203], a[28:31], 0
  v_cvt_pk_bf16_f32 v178, v178, v179
  v_cvt_pk_bf16_f32 v180, v180, v181
  v_mfma_f32_16x16x32_bf16 v[184:187], a[208:211], a[28:31], v[184:187]
  v_cvt_pk_bf16_f32 v182, v182, v183
  v_accvgpr_write_b32 a24, v176
  v_mfma_f32_16x16x32_bf16 v[188:191], a[206:209], a[28:31], v[188:191]
  v_accvgpr_write_b32 a25, v178
  v_accvgpr_write_b32 a26, v180
  v_mfma_f32_16x16x32_bf16 v[44:47], a[80:83], a[16:19], 0
  v_accvgpr_write_b32 a27, v182
  v_cvt_pk_bf16_f32 v184, v184, v185
  v_mfma_f32_16x16x32_bf16 v[44:47], a[84:87], a[20:23], v[44:47]
  v_cvt_pk_bf16_f32 v186, v186, v187
  v_cvt_pk_bf16_f32 v188, v188, v189
  v_mfma_f32_16x16x32_bf16 v[44:47], a[88:91], a[24:27], v[44:47]
  v_cvt_pk_bf16_f32 v190, v190, v191
  v_accvgpr_write_b32 a28, v184
  v_mfma_f32_16x16x32_bf16 v[36:39], a[84:87], a[4:7], v[36:39]
  v_accvgpr_write_b32 a29, v186
  v_accvgpr_write_b32 a30, v188
  v_mfma_f32_16x16x32_bf16 v[40:43], a[100:103], a[4:7], v[40:43]
  s_waitcnt vmcnt(8)
  buffer_load_dwordx4 v10, s[16:19], s25 offen offset:0  lds
  v_mfma_f32_16x16x32_bf16 v[36:39], a[88:91], a[8:11], v[36:39]
  buffer_load_dwordx4 v11, s[16:19], s25 offen offset:1024  lds
  v_mfma_f32_16x16x32_bf16 v[40:43], a[104:107], a[8:11], v[40:43]
  buffer_load_dwordx4 v12, s[16:19], s25 offen offset:2048  lds
  v_mfma_f32_16x16x32_bf16 v[36:39], a[92:95], a[12:15], v[36:39]
  buffer_load_dwordx4 v13, s[16:19], s25 offen offset:3072  lds
  v_mfma_f32_16x16x32_bf16 v[40:43], a[108:111], a[12:15], v[40:43]
  s_add_u32 m0, s47, 24576
  ds_read_b128 a[32:35], v2 offset:8192
  ds_read_b128 a[36:39], v3 offset:8192
  ds_read_b128 a[40:43], v2 offset:9216
  ds_read_b128 a[44:47], v3 offset:9216
  v_accvgpr_write_b32 a31, v190
  s_add_u32 s25, s25, 8192
  v_exp_f32 v36, v36
  v_mfma_f32_16x16x32_bf16 v[44:47], a[92:95], a[28:31], v[44:47]
  v_exp_f32 v37, v37
  v_exp_f32 v38, v38
  v_exp_f32 v39, v39
  v_exp_f32 v40, v40
  v_exp_f32 v41, v41
  v_max3_f32 v194, v44, v45, v46
  v_max_f32 v194, v194, v47
  v_mov_b32 v195, v194
  v_exp_f32 v42, v42
  v_exp_f32 v43, v43
  v_permlane32_swap_b32 v194, v195
  s_waitcnt lgkmcnt(3)
  v_mfma_f32_16x16x32_bf16 v[128:131], a[202:205], a[32:35], 0
  v_max_f32 v194, v194, v195
  v_mov_b32 v195, v194
  v_mfma_f32_16x16x32_bf16 v[132:135], a[200:203], a[32:35], 0
  v_cvt_pk_bf16_f32 v76, v36, v37
  v_permlane16_swap_b32 v194, v195
  v_mfma_f32_16x16x32_bf16 v[128:131], a[208:211], a[32:35], v[128:131]
  v_max_f32 v194, v194, v195
  v_sub_f32 v23, 0, v194
  v_mfma_f32_16x16x32_bf16 v[132:135], a[206:209], a[32:35], v[132:135]
  v_sub_f32 v22, 0, v194
  v_sub_f32 v21, 0, v194
  s_waitcnt lgkmcnt(2)
  v_mfma_f32_16x16x32_bf16 v[136:139], a[202:205], a[36:39], 0
  v_cvt_pk_bf16_f32 v128, v128, v129
  v_cvt_pk_bf16_f32 v130, v130, v131
  v_mfma_f32_16x16x32_bf16 v[140:143], a[200:203], a[36:39], 0
  v_cvt_pk_bf16_f32 v132, v132, v133
  v_cvt_pk_bf16_f32 v134, v134, v135
  v_mfma_f32_16x16x32_bf16 v[136:139], a[208:211], a[36:39], v[136:139]
  v_accvgpr_write_b32 a32, v128
  v_accvgpr_write_b32 a33, v130
  v_mfma_f32_16x16x32_bf16 v[140:143], a[206:209], a[36:39], v[140:143]
  v_accvgpr_write_b32 a34, v132
  v_accvgpr_write_b32 a35, v134
  s_waitcnt lgkmcnt(1)
  v_mfma_f32_16x16x32_bf16 v[144:147], a[202:205], a[40:43], 0
  v_cvt_pk_bf16_f32 v136, v136, v137
  v_cvt_pk_bf16_f32 v138, v138, v139
  v_mfma_f32_16x16x32_bf16 v[148:151], a[200:203], a[40:43], 0
  v_cvt_pk_bf16_f32 v140, v140, v141
  v_cvt_pk_bf16_f32 v142, v142, v143
  v_mfma_f32_16x16x32_bf16 v[144:147], a[208:211], a[40:43], v[144:147]
  v_accvgpr_write_b32 a36, v136
  v_accvgpr_write_b32 a37, v138
  v_mfma_f32_16x16x32_bf16 v[148:151], a[206:209], a[40:43], v[148:151]
  v_accvgpr_write_b32 a38, v140
  v_accvgpr_write_b32 a39, v142
  s_waitcnt lgkmcnt(0)
  v_mfma_f32_16x16x32_bf16 v[152:155], a[202:205], a[44:47], 0
  v_cvt_pk_bf16_f32 v144, v144, v145
  v_cvt_pk_bf16_f32 v146, v146, v147
  v_mfma_f32_16x16x32_bf16 v[156:159], a[200:203], a[44:47], 0
  v_cvt_pk_bf16_f32 v148, v148, v149
  v_cvt_pk_bf16_f32 v150, v150, v151
  v_mfma_f32_16x16x32_bf16 v[152:155], a[208:211], a[44:47], v[152:155]
  v_accvgpr_write_b32 a40, v144
  v_accvgpr_write_b32 a41, v146
  v_mfma_f32_16x16x32_bf16 v[156:159], a[206:209], a[44:47], v[156:159]
  v_accvgpr_write_b32 a42, v148
  v_accvgpr_write_b32 a43, v150
  v_mfma_f32_16x16x32_bf16 v[52:55], a[80:83], a[32:35], 0
  v_sub_f32 v20, 0, v194
  v_cvt_pk_bf16_f32 v152, v152, v153
  v_mfma_f32_16x16x32_bf16 v[52:55], a[84:87], a[36:39], v[52:55]
  v_cvt_pk_bf16_f32 v154, v154, v155
  v_cvt_pk_bf16_f32 v156, v156, v157
  v_mfma_f32_16x16x32_bf16 v[52:55], a[88:91], a[40:43], v[52:55]
  v_cvt_pk_bf16_f32 v158, v158, v159
  s_waitcnt vmcnt(8)
  v_mfma_f32_16x16x32_bf16 v[44:47], a[80:83], a[16:19], v[20:23]
  buffer_load_dwordx4 v10, s[16:19], s25 offen offset:0  lds
  v_mfma_f32_16x16x32_bf16 v[48:51], a[96:99], a[16:19], v[20:23]
  buffer_load_dwordx4 v11, s[16:19], s25 offen offset:1024  lds
  v_mfma_f32_16x16x32_bf16 v[44:47], a[84:87], a[20:23], v[44:47]
  buffer_load_dwordx4 v12, s[16:19], s25 offen offset:2048  lds
  v_mfma_f32_16x16x32_bf16 v[48:51], a[100:103], a[20:23], v[48:51]
  buffer_load_dwordx4 v13, s[16:19], s25 offen offset:3072  lds
  v_mfma_f32_16x16x32_bf16 v[44:47], a[88:91], a[24:27], v[44:47]
  ds_read_b128 a[48:51], v2 offset:12288
  ds_read_b128 a[52:55], v3 offset:12288
  v_mfma_f32_16x16x32_bf16 v[48:51], a[104:107], a[24:27], v[48:51]
  ds_read_b128 a[56:59], v2 offset:13312
  ds_read_b128 a[60:63], v3 offset:13312
  v_mfma_f32_16x16x32_bf16 v[44:47], a[92:95], a[28:31], v[44:47]
  v_accvgpr_write_b32 a44, v152
  v_accvgpr_write_b32 a45, v154
  v_mfma_f32_16x16x32_bf16 v[48:51], a[108:111], a[28:31], v[48:51]
  v_accvgpr_write_b32 a46, v156
  v_accvgpr_write_b32 a47, v158
  v_cvt_pk_bf16_f32 v77, v38, v39
  v_cvt_pk_bf16_f32 v78, v40, v41
  v_mfma_f32_16x16x32_bf16 v[52:55], a[92:95], a[44:47], v[52:55]
  v_exp_f32 v44, v44
  v_exp_f32 v45, v45
  v_exp_f32 v46, v46
  v_exp_f32 v47, v47
  v_exp_f32 v48, v48
  s_waitcnt lgkmcnt(3)
  v_mfma_f32_16x16x32_bf16 v[160:163], a[202:205], a[48:51], 0
  v_max3_f32 v196, v52, v53, v54
  v_max_f32 v196, v196, v55
  v_mfma_f32_16x16x32_bf16 v[164:167], a[200:203], a[48:51], 0
  v_mov_b32 v197, v196
  v_exp_f32 v49, v49
  v_mfma_f32_16x16x32_bf16 v[160:163], a[208:211], a[48:51], v[160:163]
  v_permlane32_swap_b32 v196, v197
  v_max_f32 v196, v196, v197
  v_mfma_f32_16x16x32_bf16 v[164:167], a[206:209], a[48:51], v[164:167]
  v_mov_b32 v197, v196
  v_exp_f32 v50, v50
  s_waitcnt lgkmcnt(2)
  v_mfma_f32_16x16x32_bf16 v[168:171], a[202:205], a[52:55], 0
  v_cvt_pk_bf16_f32 v160, v160, v161
  v_cvt_pk_bf16_f32 v162, v162, v163
  v_mfma_f32_16x16x32_bf16 v[172:175], a[200:203], a[52:55], 0
  v_cvt_pk_bf16_f32 v164, v164, v165
  v_cvt_pk_bf16_f32 v166, v166, v167
  v_mfma_f32_16x16x32_bf16 v[168:171], a[208:211], a[52:55], v[168:171]
  v_accvgpr_write_b32 a48, v160
  v_accvgpr_write_b32 a49, v162
  v_mfma_f32_16x16x32_bf16 v[172:175], a[206:209], a[52:55], v[172:175]
  v_accvgpr_write_b32 a50, v164
  v_accvgpr_write_b32 a51, v166
  s_waitcnt lgkmcnt(1)
  v_mfma_f32_16x16x32_bf16 v[176:179], a[202:205], a[56:59], 0
  v_cvt_pk_bf16_f32 v168, v168, v169
  v_cvt_pk_bf16_f32 v170, v170, v171
  v_mfma_f32_16x16x32_bf16 v[180:183], a[200:203], a[56:59], 0
  v_cvt_pk_bf16_f32 v172, v172, v173
  v_cvt_pk_bf16_f32 v174, v174, v175
  v_mfma_f32_16x16x32_bf16 v[176:179], a[208:211], a[56:59], v[176:179]
  v_accvgpr_write_b32 a52, v168
  v_accvgpr_write_b32 a53, v170
  v_mfma_f32_16x16x32_bf16 v[180:183], a[206:209], a[56:59], v[180:183]
  v_accvgpr_write_b32 a54, v172
  v_accvgpr_write_b32 a55, v174
  s_waitcnt lgkmcnt(0)
  v_mfma_f32_16x16x32_bf16 v[184:187], a[202:205], a[60:63], 0
  v_cvt_pk_bf16_f32 v176, v176, v177
  v_cvt_pk_bf16_f32 v178, v178, v179
  v_mfma_f32_16x16x32_bf16 v[188:191], a[200:203], a[60:63], 0
  v_cvt_pk_bf16_f32 v180, v180, v181
  v_cvt_pk_bf16_f32 v182, v182, v183
  v_mfma_f32_16x16x32_bf16 v[184:187], a[208:211], a[60:63], v[184:187]
  v_accvgpr_write_b32 a56, v176
  v_accvgpr_write_b32 a57, v178
  v_mfma_f32_16x16x32_bf16 v[188:191], a[206:209], a[60:63], v[188:191]
  v_accvgpr_write_b32 a58, v180
  v_accvgpr_write_b32 a59, v182
  v_mfma_f32_16x16x32_bf16 v[60:63], a[80:83], a[48:51], 0
  v_permlane16_swap_b32 v196, v197
  v_cvt_pk_bf16_f32 v184, v184, v185
  v_mfma_f32_16x16x32_bf16 v[60:63], a[84:87], a[52:55], v[60:63]
  v_cvt_pk_bf16_f32 v186, v186, v187
  v_cvt_pk_bf16_f32 v188, v188, v189
  v_mfma_f32_16x16x32_bf16 v[60:63], a[88:91], a[56:59], v[60:63]
  v_cvt_pk_bf16_f32 v190, v190, v191
  v_accvgpr_write_b32 a60, v184
  v_accvgpr_write_b32 a61, v186
  v_accvgpr_write_b32 a62, v188
  v_accvgpr_write_b32 a63, v190
  v_max_f32 v196, v196, v197
  v_sub_f32 v27, 0, v196
  v_mfma_f32_16x16x32_bf16 v[60:63], a[92:95], a[60:63], v[60:63]
  v_sub_f32 v26, 0, v196
  v_sub_f32 v25, 0, v196
  v_sub_f32 v24, 0, v196
  v_exp_f32 v51, v51
  v_cvt_pk_bf16_f32 v79, v42, v43
  v_mfma_f32_16x16x32_bf16 v[52:55], a[80:83], a[32:35], v[24:27]
  v_cvt_pk_bf16_f32 v84, v44, v45
  v_max3_f32 v198, v60, v61, v62
  v_mfma_f32_16x16x32_bf16 v[56:59], a[96:99], a[32:35], v[24:27]
  v_max_f32 v198, v198, v63
  v_mov_b32 v199, v198
  v_mfma_f32_16x16x32_bf16 v[52:55], a[84:87], a[36:39], v[52:55]
  v_cvt_pk_bf16_f32 v85, v46, v47
  v_permlane32_swap_b32 v198, v199
  v_mfma_f32_16x16x32_bf16 v[56:59], a[100:103], a[36:39], v[56:59]
  v_max_f32 v198, v198, v199
  v_mov_b32 v199, v198
  v_mfma_f32_16x16x32_bf16 v[52:55], a[88:91], a[40:43], v[52:55]
  v_cvt_pk_bf16_f32 v86, v48, v49
  v_permlane16_swap_b32 v198, v199
  v_mfma_f32_16x16x32_bf16 v[56:59], a[104:107], a[40:43], v[56:59]
  v_max_f32 v198, v198, v199
  v_sub_f32 v31, 0, v198
  v_mfma_f32_16x16x32_bf16 v[52:55], a[92:95], a[44:47], v[52:55]
  v_sub_f32 v30, 0, v198
  v_sub_f32 v29, 0, v198
  v_mfma_f32_16x16x32_bf16 v[56:59], a[108:111], a[44:47], v[56:59]
  v_sub_f32 v28, 0, v198
  v_cvt_pk_bf16_f32 v87, v50, v51
  s_add_u32 s25, s25, 8192
  v_mfma_f32_16x16x32_bf16 v[60:63], a[80:83], a[48:51], v[28:31]
  v_exp_f32 v52, v52
  v_mfma_f32_16x16x32_bf16 v[64:67], a[96:99], a[48:51], v[28:31]
  v_exp_f32 v53, v53
  v_mfma_f32_16x16x32_bf16 v[60:63], a[84:87], a[52:55], v[60:63]
  v_exp_f32 v54, v54
  v_mfma_f32_16x16x32_bf16 v[64:67], a[100:103], a[52:55], v[64:67]
  v_exp_f32 v55, v55
  v_mfma_f32_16x16x32_bf16 v[60:63], a[88:91], a[56:59], v[60:63]
  v_exp_f32 v56, v56
  v_mfma_f32_16x16x32_bf16 v[64:67], a[104:107], a[56:59], v[64:67]
  v_exp_f32 v57, v57
  v_mfma_f32_16x16x32_bf16 v[60:63], a[92:95], a[60:63], v[60:63]
  v_exp_f32 v58, v58
  v_mfma_f32_16x16x32_bf16 v[64:67], a[108:111], a[60:63], v[64:67]
  v_exp_f32 v59, v59
  v_cvt_pk_bf16_f32 v92, v52, v53
  v_cvt_pk_bf16_f32 v93, v54, v55
  v_cvt_pk_bf16_f32 v94, v56, v57
  v_exp_f32 v60, v60
  v_exp_f32 v61, v61
  v_exp_f32 v62, v62
  v_exp_f32 v63, v63
  v_exp_f32 v64, v64
  v_cvt_pk_bf16_f32 v95, v58, v59
  v_cvt_pk_bf16_f32 v100, v60, v61
  v_cvt_pk_bf16_f32 v101, v62, v63
  s_add_u32 s85, s29, 1
  s_mul_i32 s31, s85, 147456
  s_mul_i32 s40, s24, 20480
  s_add_u32 s31, s31, s40
  s_add_u32 s31, s31, 0
  s_sub_u32 s34, s31, 3968
  s_sub_u32 s35, s33, 3072
  s_mov_b32 s36, 3968
  s_mov_b32 s38, 3840
  s_mov_b32 s37, 3072
  s_mov_b32 s39, 2048
  s_waitcnt vmcnt(8) lgkmcnt(0)
  s_barrier
  s_mov_b32 m0, s32
  ds_read_b128 a[80:83], v4 offset:8192
  ds_read_b128 a[84:87], v5 offset:8192
  ds_read_b128 a[88:91], v4 offset:9216
  ds_read_b128 a[92:95], v5 offset:9216
  ds_read_b128 a[96:99], v4 offset:12288
  ds_read_b128 a[100:103], v5 offset:12288
  ds_read_b128 a[104:107], v4 offset:13312
  ds_read_b128 a[108:111], v5 offset:13312
  buffer_load_dwordx4 v10, s[16:19], s25 offen offset:0  lds
  buffer_load_dwordx4 v11, s[16:19], s25 offen offset:1024  lds
  buffer_load_dwordx4 v12, s[16:19], s25 offen offset:2048  lds
  buffer_load_dwordx4 v13, s[16:19], s25 offen offset:3072  lds
  s_add_u32 s25, s25, 8192
  s_mov_b32 m0, 152576
  v_xor_b32 v4, 0x4000, v4
  v_xor_b32 v5, 0x4000, v5
  buffer_load_dwordx4 v14, s[12:15], s83 offen lds
  s_waitcnt lgkmcnt(0)
  s_add_u32 s26, s25, 172032
  s_add_u32 s27, s25, 253952
  v_mfma_f32_16x16x32_bf16 v[36:39], a[80:83], a[0:3], v[16:19]
  v_exp_f32 v65, v65
  v_mfma_f32_16x16x32_bf16 v[36:39], a[84:87], a[4:7], v[36:39]
  ds_read_b64_tr_b16 a[112:113], v6 offset:8192
  v_cvt_pk_bf16_f32 v102, v64, v65
  v_mfma_f32_16x16x32_bf16 v[36:39], a[88:91], a[8:11], v[36:39]
  v_exp_f32 v66, v66
  v_mfma_f32_16x16x32_bf16 v[36:39], a[92:95], a[12:15], v[36:39]
  ds_read_b64_tr_b16 a[114:115], v6 offset:12288
  ds_read_b64_tr_b16 a[116:117], v7 offset:8192
  v_mfma_f32_16x16x32_bf16 v[40:43], a[96:99], a[0:3], v[16:19]
  v_exp_f32 v67, v67
  v_mfma_f32_16x16x32_bf16 v[40:43], a[100:103], a[4:7], v[40:43]
  ds_read_b64_tr_b16 a[118:119], v7 offset:12288
  v_cvt_pk_bf16_f32 v103, v66, v67
  v_mfma_f32_16x16x32_bf16 v[40:43], a[104:107], a[8:11], v[40:43]
  v_exp_f32 v36, v36
  v_mfma_f32_16x16x32_bf16 v[40:43], a[108:111], a[12:15], v[40:43]
  ds_read_b64_tr_b16 a[120:121], v8 offset:8192
  ds_read_b64_tr_b16 a[122:123], v8 offset:12288
  v_mfma_f32_16x16x32_bf16 v[44:47], a[80:83], a[16:19], v[20:23]
  v_exp_f32 v37, v37
  v_mfma_f32_16x16x32_bf16 v[44:47], a[84:87], a[20:23], v[44:47]
  ds_read_b64_tr_b16 a[124:125], v9 offset:8192
  v_cvt_pk_bf16_f32 v80, v36, v37
  v_mfma_f32_16x16x32_bf16 v[44:47], a[88:91], a[24:27], v[44:47]
  v_exp_f32 v38, v38
  v_mfma_f32_16x16x32_bf16 v[44:47], a[92:95], a[28:31], v[44:47]
  ds_read_b64_tr_b16 a[126:127], v9 offset:12288
  ds_read_b64_tr_b16 a[128:129], v6 offset:9216
  v_mfma_f32_16x16x32_bf16 v[48:51], a[96:99], a[16:19], v[20:23]
  v_exp_f32 v39, v39
  v_mfma_f32_16x16x32_bf16 v[48:51], a[100:103], a[20:23], v[48:51]
  ds_read_b64_tr_b16 a[130:131], v6 offset:13312
  v_cvt_pk_bf16_f32 v81, v38, v39
  v_mfma_f32_16x16x32_bf16 v[48:51], a[104:107], a[24:27], v[48:51]
  v_exp_f32 v40, v40
  v_mfma_f32_16x16x32_bf16 v[48:51], a[108:111], a[28:31], v[48:51]
  ds_read_b64_tr_b16 a[132:133], v7 offset:9216
  ds_read_b64_tr_b16 a[134:135], v7 offset:13312
  v_mfma_f32_16x16x32_bf16 v[52:55], a[80:83], a[32:35], v[24:27]
  v_exp_f32 v41, v41
  v_mfma_f32_16x16x32_bf16 v[52:55], a[84:87], a[36:39], v[52:55]
  ds_read_b64_tr_b16 a[136:137], v8 offset:9216
  v_cvt_pk_bf16_f32 v82, v40, v41
  v_mfma_f32_16x16x32_bf16 v[52:55], a[88:91], a[40:43], v[52:55]
  v_exp_f32 v42, v42
  v_mfma_f32_16x16x32_bf16 v[52:55], a[92:95], a[44:47], v[52:55]
  ds_read_b64_tr_b16 a[138:139], v8 offset:13312
  ds_read_b64_tr_b16 a[140:141], v9 offset:9216
  v_mfma_f32_16x16x32_bf16 v[56:59], a[96:99], a[32:35], v[24:27]
  v_exp_f32 v43, v43
  v_mfma_f32_16x16x32_bf16 v[56:59], a[100:103], a[36:39], v[56:59]
  ds_read_b64_tr_b16 a[142:143], v9 offset:13312
  v_cvt_pk_bf16_f32 v83, v42, v43
  v_mfma_f32_16x16x32_bf16 v[56:59], a[104:107], a[40:43], v[56:59]
  v_exp_f32 v44, v44
  v_mfma_f32_16x16x32_bf16 v[56:59], a[108:111], a[44:47], v[56:59]
  v_xor_b32 v6, 0x4000, v6
  v_xor_b32 v7, 0x4000, v7
  v_mfma_f32_16x16x32_bf16 v[60:63], a[80:83], a[48:51], v[28:31]
  v_exp_f32 v45, v45
  v_mfma_f32_16x16x32_bf16 v[60:63], a[84:87], a[52:55], v[60:63]
  v_cvt_pk_bf16_f32 v88, v44, v45
  v_xor_b32 v8, 0x4000, v8
  v_mfma_f32_16x16x32_bf16 v[60:63], a[88:91], a[56:59], v[60:63]
  v_exp_f32 v46, v46
  v_mfma_f32_16x16x32_bf16 v[60:63], a[92:95], a[60:63], v[60:63]
  v_xor_b32 v9, 0x4000, v9
  v_mfma_f32_16x16x32_bf16 v[64:67], a[96:99], a[48:51], v[28:31]
  v_exp_f32 v47, v47
  v_mfma_f32_16x16x32_bf16 v[64:67], a[100:103], a[52:55], v[64:67]
  v_cvt_pk_bf16_f32 v89, v46, v47
  s_waitcnt vmcnt(9) lgkmcnt(0)
  v_mfma_f32_16x16x32_bf16 v[64:67], a[104:107], a[56:59], v[64:67]
  s_barrier
  v_mfma_f32_16x16x32_bf16 v[64:67], a[108:111], a[60:63], v[64:67]
  v_exp_f32 v48, v48
  v_mfma_f32_16x16x32_bf16 v[128:131], a[112:115], v[76:79], 0
  s_xor_b32 m0, s32, 0x2000
  ds_read_b128 a[80:83], v4 offset:0
  v_mfma_f32_16x16x32_bf16 v[160:163], a[112:115], v[84:87], 0
  v_exp_f32 v49, v49
  v_mfma_f32_16x16x32_bf16 v[192:195], a[112:115], v[92:95], 0
  ds_read_b128 a[84:87], v5 offset:0
  v_cvt_pk_bf16_f32 v90, v48, v49
  v_mfma_f32_16x16x32_bf16 v[224:227], a[112:115], v[100:103], 0
  v_exp_f32 v50, v50
  v_mfma_f32_16x16x32_bf16 v[132:135], a[116:119], v[76:79], 0
  buffer_load_dwordx4 v10, s[16:19], s25 offen offset:0  lds
  v_mfma_f32_16x16x32_bf16 v[164:167], a[116:119], v[84:87], 0
  v_exp_f32 v51, v51
  v_mfma_f32_16x16x32_bf16 v[196:199], a[116:119], v[92:95], 0
  ds_read_b128 a[88:91], v4 offset:1024
  v_cvt_pk_bf16_f32 v91, v50, v51
  v_mfma_f32_16x16x32_bf16 v[228:231], a[116:119], v[100:103], 0
  v_exp_f32 v52, v52
  v_mfma_f32_16x16x32_bf16 v[136:139], a[120:123], v[76:79], 0
  buffer_load_dwordx4 v11, s[16:19], s25 offen offset:1024  lds
  v_mfma_f32_16x16x32_bf16 v[168:171], a[120:123], v[84:87], 0
  v_exp_f32 v53, v53
  v_mfma_f32_16x16x32_bf16 v[200:203], a[120:123], v[92:95], 0
  ds_read_b128 a[92:95], v5 offset:1024
  v_cvt_pk_bf16_f32 v96, v52, v53
  v_mfma_f32_16x16x32_bf16 v[232:235], a[120:123], v[100:103], 0
  v_exp_f32 v54, v54
  v_mfma_f32_16x16x32_bf16 v[140:143], a[124:127], v[76:79], 0
  buffer_load_dwordx4 v12, s[16:19], s25 offen offset:2048  lds
  v_mfma_f32_16x16x32_bf16 v[172:175], a[124:127], v[84:87], 0
  v_exp_f32 v55, v55
  v_mfma_f32_16x16x32_bf16 v[204:207], a[124:127], v[92:95], 0
  ds_read_b128 a[96:99], v4 offset:4096
  v_cvt_pk_bf16_f32 v97, v54, v55
  v_mfma_f32_16x16x32_bf16 v[236:239], a[124:127], v[100:103], 0
  v_exp_f32 v56, v56
  v_mfma_f32_16x16x32_bf16 v[144:147], a[128:131], v[76:79], 0
  ds_read_b128 a[100:103], v5 offset:4096
  ds_read_b128 a[104:107], v4 offset:5120
  v_mfma_f32_16x16x32_bf16 v[176:179], a[128:131], v[84:87], 0
  v_exp_f32 v57, v57
  v_mfma_f32_16x16x32_bf16 v[208:211], a[128:131], v[92:95], 0
  ds_read_b128 a[108:111], v5 offset:5120
  v_cvt_pk_bf16_f32 v98, v56, v57
  v_mfma_f32_16x16x32_bf16 v[240:243], a[128:131], v[100:103], 0
  v_exp_f32 v58, v58
  v_mfma_f32_16x16x32_bf16 v[148:151], a[132:135], v[76:79], 0
  buffer_load_dwordx4 v13, s[16:19], s25 offen offset:3072  lds
  v_mfma_f32_16x16x32_bf16 v[180:183], a[132:135], v[84:87], 0
  v_exp_f32 v59, v59
  v_mfma_f32_16x16x32_bf16 v[212:215], a[132:135], v[92:95], 0
  s_add_u32 s25, s25, 8192
  v_cvt_pk_bf16_f32 v99, v58, v59
  v_mfma_f32_16x16x32_bf16 v[244:247], a[132:135], v[100:103], 0
  v_exp_f32 v60, v60
  v_mfma_f32_16x16x32_bf16 v[152:155], a[136:139], v[76:79], 0
  s_xor_b32 s32, s32, 0x4000
  s_mov_b32 m0, 152576
  v_mfma_f32_16x16x32_bf16 v[184:187], a[136:139], v[84:87], 0
  v_exp_f32 v61, v61
  v_mfma_f32_16x16x32_bf16 v[216:219], a[136:139], v[92:95], 0
  v_cvt_pk_bf16_f32 v104, v60, v61
  v_mfma_f32_16x16x32_bf16 v[248:251], a[136:139], v[100:103], 0
  v_exp_f32 v62, v62
  v_mfma_f32_16x16x32_bf16 v[156:159], a[140:143], v[76:79], 0
  buffer_load_dwordx4 v123, s[12:15], s83 offen offset:2048 nt lds
  v_mfma_f32_16x16x32_bf16 v[188:191], a[140:143], v[84:87], 0
  v_exp_f32 v63, v63
  v_mfma_f32_16x16x32_bf16 v[220:223], a[140:143], v[92:95], 0
  v_cvt_pk_bf16_f32 v105, v62, v63
  s_waitcnt lgkmcnt(0)
  v_mfma_f32_16x16x32_bf16 v[252:255], a[140:143], v[100:103], 0
L_odd_r1a:
  v_smfmac_f32_16x16x64_bf16 a[144:147], a[164:167], v[76:83], v1
  v_exp_f32 v64, v64
  v_mfma_f32_16x16x32_bf16 v[36:39], a[80:83], a[0:3], v[16:19]
  ds_read_b64_tr_b16 a[112:113], v6 offset:0
  ds_read_b64_tr_b16 a[114:115], v6 offset:4096
  v_mfma_f32_16x16x32_bf16 v[36:39], a[84:87], a[4:7], v[36:39]
  v_exp_f32 v65, v65
  v_mfma_f32_16x16x32_bf16 v[36:39], a[88:91], a[8:11], v[36:39]
  ds_read_b64_tr_b16 a[116:117], v7 offset:0
  v_cvt_pk_bf16_f32 v106, v64, v65
  v_mfma_f32_16x16x32_bf16 v[36:39], a[92:95], a[12:15], v[36:39]
  v_exp_f32 v66, v66
  v_mfma_f32_16x16x32_bf16 v[40:43], a[96:99], a[0:3], v[16:19]
  ds_read_b64_tr_b16 a[118:119], v7 offset:4096
  ds_read_b64_tr_b16 a[120:121], v8 offset:0
  v_mfma_f32_16x16x32_bf16 v[40:43], a[100:103], a[4:7], v[40:43]
  v_exp_f32 v67, v67
  v_mfma_f32_16x16x32_bf16 v[40:43], a[104:107], a[8:11], v[40:43]
  ds_read_b64_tr_b16 a[122:123], v8 offset:4096
  v_cvt_pk_bf16_f32 v107, v66, v67
  v_mfma_f32_16x16x32_bf16 v[40:43], a[108:111], a[12:15], v[40:43]
  v_exp_f32 v36, v36
  v_smfmac_f32_16x16x64_bf16 a[148:151], a[164:167], v[84:91], v1
  ds_read_b64_tr_b16 a[124:125], v9 offset:0
  ds_read_b64_tr_b16 a[126:127], v9 offset:4096
  v_mfma_f32_16x16x32_bf16 v[44:47], a[80:83], a[16:19], v[20:23]
  v_exp_f32 v37, v37
  v_mfma_f32_16x16x32_bf16 v[44:47], a[84:87], a[20:23], v[44:47]
  ds_read_b64_tr_b16 a[128:129], v6 offset:1024
  v_cvt_pk_bf16_f32 v76, v36, v37
  v_mfma_f32_16x16x32_bf16 v[44:47], a[88:91], a[24:27], v[44:47]
  v_exp_f32 v38, v38
  v_mfma_f32_16x16x32_bf16 v[44:47], a[92:95], a[28:31], v[44:47]
  ds_read_b64_tr_b16 a[130:131], v6 offset:5120
  ds_read_b64_tr_b16 a[132:133], v7 offset:1024
  v_mfma_f32_16x16x32_bf16 v[48:51], a[96:99], a[16:19], v[20:23]
  v_exp_f32 v39, v39
  v_mfma_f32_16x16x32_bf16 v[48:51], a[100:103], a[20:23], v[48:51]
  ds_read_b64_tr_b16 a[134:135], v7 offset:5120
  v_cvt_pk_bf16_f32 v77, v38, v39
  v_mfma_f32_16x16x32_bf16 v[48:51], a[104:107], a[24:27], v[48:51]
  v_exp_f32 v40, v40
  v_mfma_f32_16x16x32_bf16 v[48:51], a[108:111], a[28:31], v[48:51]
  ds_read_b64_tr_b16 a[136:137], v8 offset:1024
  ds_read_b64_tr_b16 a[138:139], v8 offset:5120
  v_smfmac_f32_16x16x64_bf16 a[152:155], a[164:167], v[92:99], v1
  v_exp_f32 v41, v41
  v_mfma_f32_16x16x32_bf16 v[52:55], a[80:83], a[32:35], v[24:27]
  ds_read_b64_tr_b16 a[140:141], v9 offset:1024
  v_cvt_pk_bf16_f32 v78, v40, v41
  v_mfma_f32_16x16x32_bf16 v[52:55], a[84:87], a[36:39], v[52:55]
  v_exp_f32 v42, v42
  v_mfma_f32_16x16x32_bf16 v[52:55], a[88:91], a[40:43], v[52:55]
  ds_read_b64_tr_b16 a[142:143], v9 offset:5120
  s_add_u32 s34, s34, s36
  v_mfma_f32_16x16x32_bf16 v[52:55], a[92:95], a[44:47], v[52:55]
  v_exp_f32 v43, v43
  v_mfma_f32_16x16x32_bf16 v[56:59], a[96:99], a[32:35], v[24:27]
  s_add_u32 s35, s35, s37
  v_cvt_pk_bf16_f32 v79, v42, v43
  v_mfma_f32_16x16x32_bf16 v[56:59], a[100:103], a[36:39], v[56:59]
  v_exp_f32 v44, v44
  v_mfma_f32_16x16x32_bf16 v[56:59], a[104:107], a[40:43], v[56:59]
  s_xor_b32 s36, s36, s38
  s_xor_b32 s37, s37, s39
  v_mfma_f32_16x16x32_bf16 v[56:59], a[108:111], a[44:47], v[56:59]
  v_exp_f32 v45, v45
  v_smfmac_f32_16x16x64_bf16 a[156:159], a[164:167], v[100:107], v1
  v_cvt_pk_bf16_f32 v84, v44, v45
  v_mfma_f32_16x16x32_bf16 v[60:63], a[80:83], a[48:51], v[28:31]
  v_exp_f32 v46, v46
  v_mfma_f32_16x16x32_bf16 v[60:63], a[84:87], a[52:55], v[60:63]
  v_mfma_f32_16x16x32_bf16 v[60:63], a[88:91], a[56:59], v[60:63]
  v_exp_f32 v47, v47
  v_mfma_f32_16x16x32_bf16 v[60:63], a[92:95], a[60:63], v[60:63]
  v_cvt_pk_bf16_f32 v85, v46, v47
  v_mfma_f32_16x16x32_bf16 v[64:67], a[96:99], a[48:51], v[28:31]
  s_waitcnt vmcnt(10) lgkmcnt(0)
  v_mfma_f32_16x16x32_bf16 v[64:67], a[100:103], a[52:55], v[64:67]
  v_exp_f32 v48, v48
  v_mfma_f32_16x16x32_bf16 v[64:67], a[104:107], a[56:59], v[64:67]
  s_barrier
  v_mfma_f32_16x16x32_bf16 v[64:67], a[108:111], a[60:63], v[64:67]
  v_exp_f32 v49, v49
  v_mfma_f32_16x16x32_bf16 v[128:131], a[112:115], v[80:83], v[128:131]
  s_mov_b32 m0, s32
  v_cvt_pk_bf16_f32 v86, v48, v49
  v_mfma_f32_16x16x32_bf16 v[160:163], a[112:115], v[88:91], v[160:163]
  v_exp_f32 v50, v50
  v_mfma_f32_16x16x32_bf16 v[192:195], a[112:115], v[96:99], v[192:195]
  buffer_load_dwordx4 v10, s[16:19], s25 offen offset:0  lds
  v_mfma_f32_16x16x32_bf16 v[224:227], a[112:115], v[104:107], v[224:227]
  v_exp_f32 v51, v51
  v_mfma_f32_16x16x32_bf16 v[132:135], a[116:119], v[80:83], v[132:135]
  ds_read_b128 a[80:83], v4 offset:8192
  v_cvt_pk_bf16_f32 v87, v50, v51
  v_mfma_f32_16x16x32_bf16 v[164:167], a[116:119], v[88:91], v[164:167]
  v_exp_f32 v52, v52
  v_mfma_f32_16x16x32_bf16 v[196:199], a[116:119], v[96:99], v[196:199]
  ds_read_b128 a[84:87], v5 offset:8192
  ds_read_b128 a[88:91], v4 offset:9216
  v_mfma_f32_16x16x32_bf16 v[228:231], a[116:119], v[104:107], v[228:231]
  v_exp_f32 v53, v53
  v_mfma_f32_16x16x32_bf16 v[136:139], a[120:123], v[80:83], v[136:139]
  ds_read_b128 a[92:95], v5 offset:9216
  v_cvt_pk_bf16_f32 v92, v52, v53
  v_mfma_f32_16x16x32_bf16 v[168:171], a[120:123], v[88:91], v[168:171]
  v_exp_f32 v54, v54
  v_mfma_f32_16x16x32_bf16 v[200:203], a[120:123], v[96:99], v[200:203]
  buffer_load_dwordx4 v11, s[16:19], s25 offen offset:1024  lds
  v_mfma_f32_16x16x32_bf16 v[232:235], a[120:123], v[104:107], v[232:235]
  v_exp_f32 v55, v55
  v_mfma_f32_16x16x32_bf16 v[140:143], a[124:127], v[80:83], v[140:143]
  ds_read_b128 a[96:99], v4 offset:12288
  v_cvt_pk_bf16_f32 v93, v54, v55
  v_mfma_f32_16x16x32_bf16 v[172:175], a[124:127], v[88:91], v[172:175]
  v_exp_f32 v56, v56
  v_mfma_f32_16x16x32_bf16 v[204:207], a[124:127], v[96:99], v[204:207]
  buffer_load_dwordx4 v12, s[16:19], s25 offen offset:2048  lds
  v_mfma_f32_16x16x32_bf16 v[236:239], a[124:127], v[104:107], v[236:239]
  v_exp_f32 v57, v57
  v_mfma_f32_16x16x32_bf16 v[144:147], a[128:131], v[80:83], v[144:147]
  ds_read_b128 a[100:103], v5 offset:12288
  v_cvt_pk_bf16_f32 v94, v56, v57
  v_mfma_f32_16x16x32_bf16 v[176:179], a[128:131], v[88:91], v[176:179]
  v_exp_f32 v58, v58
  v_mfma_f32_16x16x32_bf16 v[208:211], a[128:131], v[96:99], v[208:211]
  buffer_load_dwordx4 v13, s[16:19], s25 offen offset:3072  lds
  v_mfma_f32_16x16x32_bf16 v[240:243], a[128:131], v[104:107], v[240:243]
  v_exp_f32 v59, v59
  v_mfma_f32_16x16x32_bf16 v[148:151], a[132:135], v[80:83], v[148:151]
  ds_read_b128 a[104:107], v4 offset:13312
  v_cvt_pk_bf16_f32 v95, v58, v59
  v_mfma_f32_16x16x32_bf16 v[180:183], a[132:135], v[88:91], v[180:183]
  v_exp_f32 v60, v60
  v_mfma_f32_16x16x32_bf16 v[212:215], a[132:135], v[96:99], v[212:215]
  ds_read_b128 a[108:111], v5 offset:13312
  s_add_u32 s25, s25, 8192
  v_mfma_f32_16x16x32_bf16 v[244:247], a[132:135], v[104:107], v[244:247]
  v_exp_f32 v61, v61
  v_mfma_f32_16x16x32_bf16 v[152:155], a[136:139], v[80:83], v[152:155]
  s_mov_b32 m0, s35
  v_cvt_pk_bf16_f32 v100, v60, v61
  v_mfma_f32_16x16x32_bf16 v[184:187], a[136:139], v[88:91], v[184:187]
  v_exp_f32 v62, v62
  v_mfma_f32_16x16x32_bf16 v[216:219], a[136:139], v[96:99], v[216:219]
  buffer_load_dwordx4 v122, s[12:15], s34 offen offset:0 nt lds
  v_mfma_f32_16x16x32_bf16 v[248:251], a[136:139], v[104:107], v[248:251]
  v_exp_f32 v63, v63
  v_mfma_f32_16x16x32_bf16 v[156:159], a[140:143], v[80:83], v[156:159]
  v_cvt_pk_bf16_f32 v101, v62, v63
  v_xor_b32 v4, 0x4000, v4
  v_mfma_f32_16x16x32_bf16 v[188:191], a[140:143], v[88:91], v[188:191]
  v_xor_b32 v5, 0x4000, v5
  v_mfma_f32_16x16x32_bf16 v[220:223], a[140:143], v[96:99], v[220:223]
  v_exp_f32 v64, v64
  v_mfma_f32_16x16x32_bf16 v[252:255], a[140:143], v[104:107], v[252:255]
  s_waitcnt lgkmcnt(0)
  v_mfma_f32_16x16x32_bf16 v[36:39], a[80:83], a[0:3], v[16:19]
  v_exp_f32 v65, v65
  v_mfma_f32_16x16x32_bf16 v[36:39], a[84:87], a[4:7], v[36:39]
  ds_read_b64_tr_b16 a[112:113], v6 offset:8192
  v_cvt_pk_bf16_f32 v102, v64, v65
  v_mfma_f32_16x16x32_bf16 v[36:39], a[88:91], a[8:11], v[36:39]
  v_exp_f32 v66, v66
  v_mfma_f32_16x16x32_bf16 v[36:39], a[92:95], a[12:15], v[36:39]
  ds_read_b64_tr_b16 a[114:115], v6 offset:12288
  ds_read_b64_tr_b16 a[116:117], v7 offset:8192
  v_mfma_f32_16x16x32_bf16 v[40:43], a[96:99], a[0:3], v[16:19]
  v_exp_f32 v67, v67
  v_mfma_f32_16x16x32_bf16 v[40:43], a[100:103], a[4:7], v[40:43]
  ds_read_b64_tr_b16 a[118:119], v7 offset:12288
  v_cvt_pk_bf16_f32 v103, v66, v67
  v_mfma_f32_16x16x32_bf16 v[40:43], a[104:107], a[8:11], v[40:43]
  v_exp_f32 v36, v36
  v_mfma_f32_16x16x32_bf16 v[40:43], a[108:111], a[12:15], v[40:43]
  ds_read_b64_tr_b16 a[120:121], v8 offset:8192
  ds_read_b64_tr_b16 a[122:123], v8 offset:12288
  v_mfma_f32_16x16x32_bf16 v[44:47], a[80:83], a[16:19], v[20:23]
  v_exp_f32 v37, v37
  v_mfma_f32_16x16x32_bf16 v[44:47], a[84:87], a[20:23], v[44:47]
  ds_read_b64_tr_b16 a[124:125], v9 offset:8192
  v_cvt_pk_bf16_f32 v80, v36, v37
  v_mfma_f32_16x16x32_bf16 v[44:47], a[88:91], a[24:27], v[44:47]
  v_exp_f32 v38, v38
  v_mfma_f32_16x16x32_bf16 v[44:47], a[92:95], a[28:31], v[44:47]
  ds_read_b64_tr_b16 a[126:127], v9 offset:12288
  ds_read_b64_tr_b16 a[128:129], v6 offset:9216
  v_mfma_f32_16x16x32_bf16 v[48:51], a[96:99], a[16:19], v[20:23]
  v_exp_f32 v39, v39
  v_mfma_f32_16x16x32_bf16 v[48:51], a[100:103], a[20:23], v[48:51]
  ds_read_b64_tr_b16 a[130:131], v6 offset:13312
  v_cvt_pk_bf16_f32 v81, v38, v39
  v_mfma_f32_16x16x32_bf16 v[48:51], a[104:107], a[24:27], v[48:51]
  v_exp_f32 v40, v40
  v_mfma_f32_16x16x32_bf16 v[48:51], a[108:111], a[28:31], v[48:51]
  ds_read_b64_tr_b16 a[132:133], v7 offset:9216
  ds_read_b64_tr_b16 a[134:135], v7 offset:13312
  v_mfma_f32_16x16x32_bf16 v[52:55], a[80:83], a[32:35], v[24:27]
  v_exp_f32 v41, v41
  v_mfma_f32_16x16x32_bf16 v[52:55], a[84:87], a[36:39], v[52:55]
  ds_read_b64_tr_b16 a[136:137], v8 offset:9216
  v_cvt_pk_bf16_f32 v82, v40, v41
  v_mfma_f32_16x16x32_bf16 v[52:55], a[88:91], a[40:43], v[52:55]
  v_exp_f32 v42, v42
  v_mfma_f32_16x16x32_bf16 v[52:55], a[92:95], a[44:47], v[52:55]
  ds_read_b64_tr_b16 a[138:139], v8 offset:13312
  ds_read_b64_tr_b16 a[140:141], v9 offset:9216
  v_mfma_f32_16x16x32_bf16 v[56:59], a[96:99], a[32:35], v[24:27]
  v_exp_f32 v43, v43
  v_mfma_f32_16x16x32_bf16 v[56:59], a[100:103], a[36:39], v[56:59]
  ds_read_b64_tr_b16 a[142:143], v9 offset:13312
  v_cvt_pk_bf16_f32 v83, v42, v43
  v_mfma_f32_16x16x32_bf16 v[56:59], a[104:107], a[40:43], v[56:59]
  v_exp_f32 v44, v44
  v_mfma_f32_16x16x32_bf16 v[56:59], a[108:111], a[44:47], v[56:59]
  v_xor_b32 v6, 0x4000, v6
  v_xor_b32 v7, 0x4000, v7
  v_mfma_f32_16x16x32_bf16 v[60:63], a[80:83], a[48:51], v[28:31]
  v_exp_f32 v45, v45
  v_mfma_f32_16x16x32_bf16 v[60:63], a[84:87], a[52:55], v[60:63]
  v_cvt_pk_bf16_f32 v88, v44, v45
  v_xor_b32 v8, 0x4000, v8
  v_mfma_f32_16x16x32_bf16 v[60:63], a[88:91], a[56:59], v[60:63]
  v_exp_f32 v46, v46
  v_mfma_f32_16x16x32_bf16 v[60:63], a[92:95], a[60:63], v[60:63]
  v_xor_b32 v9, 0x4000, v9
  v_mfma_f32_16x16x32_bf16 v[64:67], a[96:99], a[48:51], v[28:31]
  v_exp_f32 v47, v47
  v_mfma_f32_16x16x32_bf16 v[64:67], a[100:103], a[52:55], v[64:67]
  v_cvt_pk_bf16_f32 v89, v46, v47
  s_waitcnt vmcnt(10) lgkmcnt(0)
  v_mfma_f32_16x16x32_bf16 v[64:67], a[104:107], a[56:59], v[64:67]
  s_barrier
  v_mfma_f32_16x16x32_bf16 v[64:67], a[108:111], a[60:63], v[64:67]
  v_exp_f32 v48, v48
  v_mfma_f32_16x16x32_bf16 v[128:131], a[112:115], v[76:79], v[128:131]
  s_xor_b32 m0, s32, 0x2000
  ds_read_b128 a[80:83], v4 offset:0
  v_mfma_f32_16x16x32_bf16 v[160:163], a[112:115], v[84:87], v[160:163]
  v_exp_f32 v49, v49
  v_mfma_f32_16x16x32_bf16 v[192:195], a[112:115], v[92:95], v[192:195]
  ds_read_b128 a[84:87], v5 offset:0
  v_cvt_pk_bf16_f32 v90, v48, v49
  v_mfma_f32_16x16x32_bf16 v[224:227], a[112:115], v[100:103], v[224:227]
  v_exp_f32 v50, v50
  v_mfma_f32_16x16x32_bf16 v[132:135], a[116:119], v[76:79], v[132:135]
  buffer_load_dwordx4 v10, s[16:19], s25 offen offset:0  lds
  v_mfma_f32_16x16x32_bf16 v[164:167], a[116:119], v[84:87], v[164:167]
  v_exp_f32 v51, v51
  v_mfma_f32_16x16x32_bf16 v[196:199], a[116:119], v[92:95], v[196:199]
  ds_read_b128 a[88:91], v4 offset:1024
  v_cvt_pk_bf16_f32 v91, v50, v51
  v_mfma_f32_16x16x32_bf16 v[228:231], a[116:119], v[100:103], v[228:231]
  v_exp_f32 v52, v52
  v_mfma_f32_16x16x32_bf16 v[136:139], a[120:123], v[76:79], v[136:139]
  buffer_load_dwordx4 v11, s[16:19], s25 offen offset:1024  lds
  v_mfma_f32_16x16x32_bf16 v[168:171], a[120:123], v[84:87], v[168:171]
  v_exp_f32 v53, v53
  v_mfma_f32_16x16x32_bf16 v[200:203], a[120:123], v[92:95], v[200:203]
  ds_read_b128 a[92:95], v5 offset:1024
  v_cvt_pk_bf16_f32 v96, v52, v53
  v_mfma_f32_16x16x32_bf16 v[232:235], a[120:123], v[100:103], v[232:235]
  v_exp_f32 v54, v54
  v_mfma_f32_16x16x32_bf16 v[140:143], a[124:127], v[76:79], v[140:143]
  buffer_load_dwordx4 v12, s[16:19], s25 offen offset:2048  lds
  v_mfma_f32_16x16x32_bf16 v[172:175], a[124:127], v[84:87], v[172:175]
  v_exp_f32 v55, v55
  v_mfma_f32_16x16x32_bf16 v[204:207], a[124:127], v[92:95], v[204:207]
  ds_read_b128 a[96:99], v4 offset:4096
  v_cvt_pk_bf16_f32 v97, v54, v55
  v_mfma_f32_16x16x32_bf16 v[236:239], a[124:127], v[100:103], v[236:239]
  v_exp_f32 v56, v56
  v_mfma_f32_16x16x32_bf16 v[144:147], a[128:131], v[76:79], v[144:147]
  ds_read_b128 a[100:103], v5 offset:4096
  ds_read_b128 a[104:107], v4 offset:5120
  v_mfma_f32_16x16x32_bf16 v[176:179], a[128:131], v[84:87], v[176:179]
  v_exp_f32 v57, v57
  v_mfma_f32_16x16x32_bf16 v[208:211], a[128:131], v[92:95], v[208:211]
  ds_read_b128 a[108:111], v5 offset:5120
  v_cvt_pk_bf16_f32 v98, v56, v57
  v_mfma_f32_16x16x32_bf16 v[240:243], a[128:131], v[100:103], v[240:243]
  v_exp_f32 v58, v58
  v_mfma_f32_16x16x32_bf16 v[148:151], a[132:135], v[76:79], v[148:151]
  buffer_load_dwordx4 v13, s[16:19], s25 offen offset:3072  lds
  v_mfma_f32_16x16x32_bf16 v[180:183], a[132:135], v[84:87], v[180:183]
  v_exp_f32 v59, v59
  v_mfma_f32_16x16x32_bf16 v[212:215], a[132:135], v[92:95], v[212:215]
  s_add_u32 s25, s25, 8192
  v_cvt_pk_bf16_f32 v99, v58, v59
  v_mfma_f32_16x16x32_bf16 v[244:247], a[132:135], v[100:103], v[244:247]
  v_exp_f32 v60, v60
  v_mfma_f32_16x16x32_bf16 v[152:155], a[136:139], v[76:79], v[152:155]
  s_xor_b32 s32, s32, 0x4000
  s_mov_b32 m0, s35
  v_mfma_f32_16x16x32_bf16 v[184:187], a[136:139], v[84:87], v[184:187]
  v_exp_f32 v61, v61
  v_mfma_f32_16x16x32_bf16 v[216:219], a[136:139], v[92:95], v[216:219]
  v_cvt_pk_bf16_f32 v104, v60, v61
  v_mfma_f32_16x16x32_bf16 v[248:251], a[136:139], v[100:103], v[248:251]
  v_exp_f32 v62, v62
  v_mfma_f32_16x16x32_bf16 v[156:159], a[140:143], v[76:79], v[156:159]
  buffer_load_dwordx4 v123, s[12:15], s34 offen offset:2048 nt lds
  v_mfma_f32_16x16x32_bf16 v[188:191], a[140:143], v[84:87], v[188:191]
  v_exp_f32 v63, v63
  v_mfma_f32_16x16x32_bf16 v[220:223], a[140:143], v[92:95], v[220:223]
  v_cvt_pk_bf16_f32 v105, v62, v63
  s_waitcnt lgkmcnt(0)
  v_mfma_f32_16x16x32_bf16 v[252:255], a[140:143], v[100:103], v[252:255]
  s_cmp_eq_u32 s25, s26
  s_cbranch_scc0 L_odd_r1a
  s_cmp_eq_u32 s26, s27
  s_cbranch_scc1 L_exit_r1a
  s_mov_b32 s26, s27
  s_mov_b32 s34, s83
  s_mov_b32 s36, 0
  s_mov_b32 s37, 0
  s_mov_b32 s35, 152576
  s_mov_b32 s38, 0
  s_mov_b32 s39, 0
  s_branch L_odd_r1a
L_exit_r1a:
  v_smfmac_f32_16x16x64_bf16 a[144:147], a[164:167], v[76:83], v1
  v_add_u32 v2, s33, v4
  v_add_u32 v3, s33, v5
  v_smfmac_f32_16x16x64_bf16 a[148:151], a[164:167], v[84:91], v1
  ds_read_b64_tr_b16 a[112:113], v6 offset:0
  ds_read_b64_tr_b16 a[114:115], v6 offset:4096
  v_smfmac_f32_16x16x64_bf16 a[152:155], a[164:167], v[92:99], v1
  ds_read_b64_tr_b16 a[116:117], v7 offset:0
  ds_read_b64_tr_b16 a[118:119], v7 offset:4096
  ds_read_b64_tr_b16 a[120:121], v8 offset:0
  ds_read_b64_tr_b16 a[122:123], v8 offset:4096
  ds_read_b64_tr_b16 a[124:125], v9 offset:0
  ds_read_b64_tr_b16 a[126:127], v9 offset:4096
  ds_read_b64_tr_b16 a[128:129], v6 offset:1024
  ds_read_b64_tr_b16 a[130:131], v6 offset:5120
  ds_read_b64_tr_b16 a[132:133], v7 offset:1024
  ds_read_b64_tr_b16 a[134:135], v7 offset:5120
  ds_read_b64_tr_b16 a[136:137], v8 offset:1024
  ds_read_b64_tr_b16 a[138:139], v8 offset:5120
  ds_read_b64_tr_b16 a[140:141], v9 offset:1024
  ds_read_b64_tr_b16 a[142:143], v9 offset:5120
  s_waitcnt vmcnt(10)
  s_waitcnt lgkmcnt(0)
  s_barrier
  v_mfma_f32_16x16x32_bf16 v[128:131], a[112:115], v[80:83], v[128:131]
  ds_read_b128 a[0:3], v2 offset:0
  ds_read_b128 a[16:19], v2 offset:4096
  v_mfma_f32_16x16x32_bf16 v[132:135], a[116:119], v[80:83], v[132:135]
  ds_read_b128 a[32:35], v2 offset:8192
  ds_read_b128 a[48:51], v2 offset:12288
  v_mfma_f32_16x16x32_bf16 v[136:139], a[120:123], v[80:83], v[136:139]
  ds_read_b128 a[64:67], v2 offset:16384
  ds_read_b128 a[4:7], v3 offset:0
  v_mfma_f32_16x16x32_bf16 v[140:143], a[124:127], v[80:83], v[140:143]
  ds_read_b128 a[20:23], v3 offset:4096
  ds_read_b128 a[36:39], v3 offset:8192
  v_mfma_f32_16x16x32_bf16 v[144:147], a[128:131], v[80:83], v[144:147]
  ds_read_b128 a[52:55], v3 offset:12288
  ds_read_b128 a[68:71], v3 offset:16384
  v_mfma_f32_16x16x32_bf16 v[148:151], a[132:135], v[80:83], v[148:151]
  ds_read_b128 a[8:11], v2 offset:1024
  ds_read_b128 a[24:27], v2 offset:5120
  v_mfma_f32_16x16x32_bf16 v[152:155], a[136:139], v[80:83], v[152:155]
  ds_read_b128 a[40:43], v2 offset:9216
  ds_read_b128 a[56:59], v2 offset:13312
  v_mfma_f32_16x16x32_bf16 v[156:159], a[140:143], v[80:83], v[156:159]
  ds_read_b128 a[72:75], v2 offset:17408
  ds_read_b128 a[12:15], v3 offset:1024
  s_waitcnt lgkmcnt(15)
  v_mfma_f32_16x16x32_bf16 v[36:39], a[202:205], a[0:3], 0
  ds_read_b128 a[28:31], v3 offset:5120
  ds_read_b128 a[44:47], v3 offset:9216
  s_waitcnt lgkmcnt(15)
  v_mfma_f32_16x16x32_bf16 v[44:47], a[202:205], a[16:19], 0
  ds_read_b128 a[60:63], v3 offset:13312
  ds_read_b128 a[76:79], v3 offset:17408
  v_mfma_f32_16x16x32_bf16 v[52:55], a[202:205], a[32:35], 0
  s_mov_b32 m0, s32
  v_exp_f32 v64, v64
  s_waitcnt lgkmcnt(15)
  v_mfma_f32_16x16x32_bf16 v[60:63], a[202:205], a[48:51], 0
  buffer_load_dwordx4 v10, s[16:19], s25 offen offset:0  lds
  v_mfma_f32_16x16x32_bf16 v[68:71], a[202:205], a[64:67], 0
  buffer_load_dwordx4 v11, s[16:19], s25 offen offset:1024  lds
  v_mfma_f32_16x16x32_bf16 v[36:39], a[208:211], a[0:3], v[36:39]
  buffer_load_dwordx4 v12, s[16:19], s25 offen offset:2048  lds
  v_mfma_f32_16x16x32_bf16 v[44:47], a[208:211], a[16:19], v[44:47]
  buffer_load_dwordx4 v13, s[16:19], s25 offen offset:3072  lds
  v_mfma_f32_16x16x32_bf16 v[52:55], a[208:211], a[32:35], v[52:55]
  v_exp_f32 v65, v65
  v_mfma_f32_16x16x32_bf16 v[60:63], a[208:211], a[48:51], v[60:63]
  v_exp_f32 v66, v66
  v_mfma_f32_16x16x32_bf16 v[68:71], a[208:211], a[64:67], v[68:71]
  v_exp_f32 v67, v67
  v_mfma_f32_16x16x32_bf16 v[40:43], a[200:203], a[0:3], 0
  v_cvt_pk_bf16_f32 v106, v64, v65
  v_cvt_pk_bf16_f32 v107, v66, v67
  v_mfma_f32_16x16x32_bf16 v[48:51], a[200:203], a[16:19], 0
  v_cvt_pk_bf16_f32 v36, v36, v37
  v_cvt_pk_bf16_f32 v38, v38, v39
  v_mfma_f32_16x16x32_bf16 v[56:59], a[200:203], a[32:35], 0
  v_cvt_pk_bf16_f32 v44, v44, v45
  v_cvt_pk_bf16_f32 v46, v46, v47
  v_mfma_f32_16x16x32_bf16 v[64:67], a[200:203], a[48:51], 0
  v_cvt_pk_bf16_f32 v52, v52, v53
  v_cvt_pk_bf16_f32 v54, v54, v55
  v_mfma_f32_16x16x32_bf16 v[72:75], a[200:203], a[64:67], 0
  v_cvt_pk_bf16_f32 v60, v60, v61
  v_cvt_pk_bf16_f32 v62, v62, v63
  v_mfma_f32_16x16x32_bf16 v[40:43], a[206:209], a[0:3], v[40:43]
  v_cvt_pk_bf16_f32 v68, v68, v69
  v_cvt_pk_bf16_f32 v70, v70, v71
  v_mfma_f32_16x16x32_bf16 v[48:51], a[206:209], a[16:19], v[48:51]
  v_accvgpr_write_b32 a0, v36
  v_accvgpr_write_b32 a1, v38
  v_mfma_f32_16x16x32_bf16 v[56:59], a[206:209], a[32:35], v[56:59]
  v_accvgpr_write_b32 a16, v44
  v_accvgpr_write_b32 a17, v46
  v_mfma_f32_16x16x32_bf16 v[64:67], a[206:209], a[48:51], v[64:67]
  v_accvgpr_write_b32 a32, v52
  v_accvgpr_write_b32 a33, v54
  v_mfma_f32_16x16x32_bf16 v[72:75], a[206:209], a[64:67], v[72:75]
  v_accvgpr_write_b32 a48, v60
  v_accvgpr_write_b32 a49, v62
  s_waitcnt lgkmcnt(14)
  v_mfma_f32_16x16x32_bf16 v[36:39], a[202:205], a[4:7], 0
  v_accvgpr_write_b32 a64, v68
  v_accvgpr_write_b32 a65, v70
  s_waitcnt lgkmcnt(13)
  v_mfma_f32_16x16x32_bf16 v[44:47], a[202:205], a[20:23], 0
  v_cvt_pk_bf16_f32 v40, v40, v41
  v_cvt_pk_bf16_f32 v42, v42, v43
  s_waitcnt lgkmcnt(12)
  v_mfma_f32_16x16x32_bf16 v[52:55], a[202:205], a[36:39], 0
  v_cvt_pk_bf16_f32 v48, v48, v49
  v_cvt_pk_bf16_f32 v50, v50, v51
  s_waitcnt lgkmcnt(11)
  v_mfma_f32_16x16x32_bf16 v[60:63], a[202:205], a[52:55], 0
  v_cvt_pk_bf16_f32 v56, v56, v57
  v_cvt_pk_bf16_f32 v58, v58, v59
  s_waitcnt lgkmcnt(10)
  v_mfma_f32_16x16x32_bf16 v[68:71], a[202:205], a[68:71], 0
  v_cvt_pk_bf16_f32 v64, v64, v65
  v_cvt_pk_bf16_f32 v66, v66, v67
  v_mfma_f32_16x16x32_bf16 v[36:39], a[208:211], a[4:7], v[36:39]
  v_cvt_pk_bf16_f32 v72, v72, v73
  v_cvt_pk_bf16_f32 v74, v74, v75
  v_mfma_f32_16x16x32_bf16 v[44:47], a[208:211], a[20:23], v[44:47]
  v_accvgpr_write_b32 a2, v40
  v_accvgpr_write_b32 a3, v42
  v_mfma_f32_16x16x32_bf16 v[52:55], a[208:211], a[36:39], v[52:55]
  v_accvgpr_write_b32 a18, v48
  v_accvgpr_write_b32 a19, v50
  v_mfma_f32_16x16x32_bf16 v[60:63], a[208:211], a[52:55], v[60:63]
  v_accvgpr_write_b32 a34, v56
  v_accvgpr_write_b32 a35, v58
  v_mfma_f32_16x16x32_bf16 v[68:71], a[208:211], a[68:71], v[68:71]
  v_accvgpr_write_b32 a50, v64
  v_accvgpr_write_b32 a51, v66
  v_mfma_f32_16x16x32_bf16 v[40:43], a[200:203], a[4:7], 0
  v_accvgpr_write_b32 a66, v72
  v_accvgpr_write_b32 a67, v74
  v_mfma_f32_16x16x32_bf16 v[48:51], a[200:203], a[20:23], 0
  v_cvt_pk_bf16_f32 v36, v36, v37
  v_cvt_pk_bf16_f32 v38, v38, v39
  v_mfma_f32_16x16x32_bf16 v[56:59], a[200:203], a[36:39], 0
  v_cvt_pk_bf16_f32 v44, v44, v45
  v_cvt_pk_bf16_f32 v46, v46, v47
  v_mfma_f32_16x16x32_bf16 v[64:67], a[200:203], a[52:55], 0
  v_cvt_pk_bf16_f32 v52, v52, v53
  v_cvt_pk_bf16_f32 v54, v54, v55
  v_mfma_f32_16x16x32_bf16 v[72:75], a[200:203], a[68:71], 0
  v_cvt_pk_bf16_f32 v60, v60, v61
  v_cvt_pk_bf16_f32 v62, v62, v63
  v_mfma_f32_16x16x32_bf16 v[40:43], a[206:209], a[4:7], v[40:43]
  v_cvt_pk_bf16_f32 v68, v68, v69
  v_cvt_pk_bf16_f32 v70, v70, v71
  v_mfma_f32_16x16x32_bf16 v[48:51], a[206:209], a[20:23], v[48:51]
  v_accvgpr_write_b32 a4, v36
  v_accvgpr_write_b32 a5, v38
  v_mfma_f32_16x16x32_bf16 v[56:59], a[206:209], a[36:39], v[56:59]
  v_accvgpr_write_b32 a20, v44
  v_accvgpr_write_b32 a21, v46
  v_mfma_f32_16x16x32_bf16 v[64:67], a[206:209], a[52:55], v[64:67]
  v_accvgpr_write_b32 a36, v52
  v_accvgpr_write_b32 a37, v54
  v_mfma_f32_16x16x32_bf16 v[72:75], a[206:209], a[68:71], v[72:75]
  v_accvgpr_write_b32 a52, v60
  v_accvgpr_write_b32 a53, v62
  s_waitcnt lgkmcnt(9)
  v_mfma_f32_16x16x32_bf16 v[36:39], a[202:205], a[8:11], 0
  v_accvgpr_write_b32 a68, v68
  v_accvgpr_write_b32 a69, v70
  s_waitcnt lgkmcnt(8)
  v_mfma_f32_16x16x32_bf16 v[44:47], a[202:205], a[24:27], 0
  v_cvt_pk_bf16_f32 v40, v40, v41
  v_cvt_pk_bf16_f32 v42, v42, v43
  s_waitcnt lgkmcnt(7)
  v_mfma_f32_16x16x32_bf16 v[52:55], a[202:205], a[40:43], 0
  v_cvt_pk_bf16_f32 v48, v48, v49
  v_cvt_pk_bf16_f32 v50, v50, v51
  s_waitcnt lgkmcnt(6)
  v_mfma_f32_16x16x32_bf16 v[60:63], a[202:205], a[56:59], 0
  v_cvt_pk_bf16_f32 v56, v56, v57
  v_cvt_pk_bf16_f32 v58, v58, v59
  s_waitcnt lgkmcnt(5)
  v_mfma_f32_16x16x32_bf16 v[68:71], a[202:205], a[72:75], 0
  v_cvt_pk_bf16_f32 v64, v64, v65
  v_cvt_pk_bf16_f32 v66, v66, v67
  v_mfma_f32_16x16x32_bf16 v[36:39], a[208:211], a[8:11], v[36:39]
  v_cvt_pk_bf16_f32 v72, v72, v73
  v_cvt_pk_bf16_f32 v74, v74, v75
  v_mfma_f32_16x16x32_bf16 v[44:47], a[208:211], a[24:27], v[44:47]
  v_accvgpr_write_b32 a6, v40
  v_accvgpr_write_b32 a7, v42
  v_mfma_f32_16x16x32_bf16 v[52:55], a[208:211], a[40:43], v[52:55]
  v_accvgpr_write_b32 a22, v48
  v_accvgpr_write_b32 a23, v50
  v_mfma_f32_16x16x32_bf16 v[60:63], a[208:211], a[56:59], v[60:63]
  v_accvgpr_write_b32 a38, v56
  v_accvgpr_write_b32 a39, v58
  v_mfma_f32_16x16x32_bf16 v[68:71], a[208:211], a[72:75], v[68:71]
  v_accvgpr_write_b32 a54, v64
  v_accvgpr_write_b32 a55, v66
  v_mfma_f32_16x16x32_bf16 v[40:43], a[200:203], a[8:11], 0
  v_accvgpr_write_b32 a70, v72
  v_accvgpr_write_b32 a71, v74
  v_mfma_f32_16x16x32_bf16 v[48:51], a[200:203], a[24:27], 0
  v_cvt_pk_bf16_f32 v36, v36, v37
  v_cvt_pk_bf16_f32 v38, v38, v39
  v_mfma_f32_16x16x32_bf16 v[56:59], a[200:203], a[40:43], 0
  v_cvt_pk_bf16_f32 v44, v44, v45
  v_cvt_pk_bf16_f32 v46, v46, v47
  v_mfma_f32_16x16x32_bf16 v[64:67], a[200:203], a[56:59], 0
  v_cvt_pk_bf16_f32 v52, v52, v53
  v_cvt_pk_bf16_f32 v54, v54, v55
  v_mfma_f32_16x16x32_bf16 v[72:75], a[200:203], a[72:75], 0
  v_cvt_pk_bf16_f32 v60, v60, v61
  v_cvt_pk_bf16_f32 v62, v62, v63
  v_mfma_f32_16x16x32_bf16 v[40:43], a[206:209], a[8:11], v[40:43]
  v_cvt_pk_bf16_f32 v68, v68, v69
  v_cvt_pk_bf16_f32 v70, v70, v71
  v_mfma_f32_16x16x32_bf16 v[48:51], a[206:209], a[24:27], v[48:51]
  v_accvgpr_write_b32 a8, v36
  v_accvgpr_write_b32 a9, v38
  v_mfma_f32_16x16x32_bf16 v[56:59], a[206:209], a[40:43], v[56:59]
  v_accvgpr_write_b32 a24, v44
  v_accvgpr_write_b32 a25, v46
  v_mfma_f32_16x16x32_bf16 v[64:67], a[206:209], a[56:59], v[64:67]
  v_accvgpr_write_b32 a40, v52
  v_accvgpr_write_b32 a41, v54
  v_mfma_f32_16x16x32_bf16 v[72:75], a[206:209], a[72:75], v[72:75]
  v_accvgpr_write_b32 a56, v60
  v_accvgpr_write_b32 a57, v62
  s_waitcnt lgkmcnt(4)
  v_mfma_f32_16x16x32_bf16 v[36:39], a[202:205], a[12:15], 0
  v_accvgpr_write_b32 a72, v68
  v_accvgpr_write_b32 a73, v70
  s_waitcnt lgkmcnt(3)
  v_mfma_f32_16x16x32_bf16 v[44:47], a[202:205], a[28:31], 0
  v_cvt_pk_bf16_f32 v40, v40, v41
  v_cvt_pk_bf16_f32 v42, v42, v43
  s_waitcnt lgkmcnt(2)
  v_mfma_f32_16x16x32_bf16 v[52:55], a[202:205], a[44:47], 0
  v_cvt_pk_bf16_f32 v48, v48, v49
  v_cvt_pk_bf16_f32 v50, v50, v51
  s_waitcnt lgkmcnt(1)
  v_mfma_f32_16x16x32_bf16 v[60:63], a[202:205], a[60:63], 0
  v_cvt_pk_bf16_f32 v56, v56, v57
  v_cvt_pk_bf16_f32 v58, v58, v59
  s_waitcnt lgkmcnt(0)
  v_mfma_f32_16x16x32_bf16 v[68:71], a[202:205], a[76:79], 0
  v_cvt_pk_bf16_f32 v64, v64, v65
  v_cvt_pk_bf16_f32 v66, v66, v67
  v_mfma_f32_16x16x32_bf16 v[36:39], a[208:211], a[12:15], v[36:39]
  v_cvt_pk_bf16_f32 v72, v72, v73
  v_cvt_pk_bf16_f32 v74, v74, v75
  v_mfma_f32_16x16x32_bf16 v[44:47], a[208:211], a[28:31], v[44:47]
  v_accvgpr_write_b32 a10, v40
  v_accvgpr_write_b32 a11, v42
  v_mfma_f32_16x16x32_bf16 v[52:55], a[208:211], a[44:47], v[52:55]
  v_accvgpr_write_b32 a26, v48
  v_accvgpr_write_b32 a27, v50
  v_mfma_f32_16x16x32_bf16 v[60:63], a[208:211], a[60:63], v[60:63]
  v_accvgpr_write_b32 a42, v56
  v_accvgpr_write_b32 a43, v58
  v_mfma_f32_16x16x32_bf16 v[68:71], a[208:211], a[76:79], v[68:71]
  v_accvgpr_write_b32 a58, v64
  v_accvgpr_write_b32 a59, v66
  v_mfma_f32_16x16x32_bf16 v[40:43], a[200:203], a[12:15], 0
  v_accvgpr_write_b32 a74, v72
  v_accvgpr_write_b32 a75, v74
  v_mfma_f32_16x16x32_bf16 v[48:51], a[200:203], a[28:31], 0
  v_cvt_pk_bf16_f32 v36, v36, v37
  v_cvt_pk_bf16_f32 v38, v38, v39
  v_mfma_f32_16x16x32_bf16 v[56:59], a[200:203], a[44:47], 0
  v_cvt_pk_bf16_f32 v44, v44, v45
  v_cvt_pk_bf16_f32 v46, v46, v47
  v_mfma_f32_16x16x32_bf16 v[64:67], a[200:203], a[60:63], 0
  v_cvt_pk_bf16_f32 v52, v52, v53
  v_cvt_pk_bf16_f32 v54, v54, v55
  v_mfma_f32_16x16x32_bf16 v[72:75], a[200:203], a[76:79], 0
  v_cvt_pk_bf16_f32 v60, v60, v61
  v_cvt_pk_bf16_f32 v62, v62, v63
  v_mfma_f32_16x16x32_bf16 v[40:43], a[206:209], a[12:15], v[40:43]
  v_cvt_pk_bf16_f32 v68, v68, v69
  v_cvt_pk_bf16_f32 v70, v70, v71
  v_mfma_f32_16x16x32_bf16 v[48:51], a[206:209], a[28:31], v[48:51]
  v_accvgpr_write_b32 a12, v36
  v_accvgpr_write_b32 a13, v38
  v_mfma_f32_16x16x32_bf16 v[56:59], a[206:209], a[44:47], v[56:59]
  v_accvgpr_write_b32 a28, v44
  v_accvgpr_write_b32 a29, v46
  v_mfma_f32_16x16x32_bf16 v[64:67], a[206:209], a[60:63], v[64:67]
  v_accvgpr_write_b32 a44, v52
  v_accvgpr_write_b32 a45, v54
  v_mfma_f32_16x16x32_bf16 v[72:75], a[206:209], a[76:79], v[72:75]
  v_accvgpr_write_b32 a60, v60
  v_accvgpr_write_b32 a61, v62
  v_mfma_f32_16x16x32_bf16 v[36:39], a[80:83], a[0:3], 0
  v_accvgpr_write_b32 a76, v68
  v_accvgpr_write_b32 a77, v70
  v_mfma_f32_16x16x32_bf16 v[44:47], a[80:83], a[16:19], 0
  v_accvgpr_read_b32 v116, a144
  v_accvgpr_read_b32 v126, a145
  v_mfma_f32_16x16x32_bf16 v[52:55], a[80:83], a[32:35], 0
  v_add_f32 v116, v116, v126
  v_cvt_pk_bf16_f32 v40, v40, v41
  v_mfma_f32_16x16x32_bf16 v[60:63], a[80:83], a[48:51], 0
  v_cvt_pk_bf16_f32 v42, v42, v43
  v_cvt_pk_bf16_f32 v48, v48, v49
  v_mfma_f32_16x16x32_bf16 v[68:71], a[80:83], a[64:67], 0
  v_cvt_pk_bf16_f32 v50, v50, v51
  v_cvt_pk_bf16_f32 v56, v56, v57
  v_mfma_f32_16x16x32_bf16 v[36:39], a[84:87], a[4:7], v[36:39]
  v_cvt_pk_bf16_f32 v58, v58, v59
  v_cvt_pk_bf16_f32 v64, v64, v65
  v_mfma_f32_16x16x32_bf16 v[44:47], a[84:87], a[20:23], v[44:47]
  v_cvt_pk_bf16_f32 v66, v66, v67
  v_cvt_pk_bf16_f32 v72, v72, v73
  v_mfma_f32_16x16x32_bf16 v[52:55], a[84:87], a[36:39], v[52:55]
  v_cvt_pk_bf16_f32 v74, v74, v75
  v_cmp_nge_f32 vcc, s84, v116
  v_mfma_f32_16x16x32_bf16 v[60:63], a[84:87], a[52:55], v[60:63]
  v_accvgpr_write_b32 a14, v40
  v_accvgpr_write_b32 a15, v42
  v_mfma_f32_16x16x32_bf16 v[68:71], a[84:87], a[68:71], v[68:71]
  v_accvgpr_write_b32 a30, v48
  v_accvgpr_write_b32 a31, v50
  v_mfma_f32_16x16x32_bf16 v[36:39], a[88:91], a[8:11], v[36:39]
  v_accvgpr_write_b32 a46, v56
  v_accvgpr_write_b32 a47, v58
  v_mfma_f32_16x16x32_bf16 v[44:47], a[88:91], a[24:27], v[44:47]
  v_accvgpr_write_b32 a62, v64
  v_accvgpr_write_b32 a63, v66
  v_mfma_f32_16x16x32_bf16 v[52:55], a[88:91], a[40:43], v[52:55]
  v_accvgpr_write_b32 a78, v72
  v_accvgpr_write_b32 a79, v74
  v_mfma_f32_16x16x32_bf16 v[60:63], a[88:91], a[56:59], v[60:63]
  s_or_b64 s[96:97], s[96:97], vcc
  v_cmp_nle_f32 vcc, s94, v116
  v_mfma_f32_16x16x32_bf16 v[68:71], a[88:91], a[72:75], v[68:71]
  v_rcp_f32 v116, v116
  v_mfma_f32_16x16x32_bf16 v[36:39], a[92:95], a[12:15], v[36:39]
  v_accvgpr_read_b32 v118, a148
  v_accvgpr_read_b32 v127, a149
  v_mfma_f32_16x16x32_bf16 v[44:47], a[92:95], a[28:31], v[44:47]
  v_mul_f32 v128, v128, v116
  v_mul_f32 v129, v129, v116
  v_mfma_f32_16x16x32_bf16 v[52:55], a[92:95], a[44:47], v[52:55]
  v_add_f32 v118, v118, v127
  s_or_b64 s[96:97], s[96:97], vcc
  v_mfma_f32_16x16x32_bf16 v[60:63], a[92:95], a[60:63], v[60:63]
  v_mul_f32 v130, v130, v116
  v_mul_f32 v131, v131, v116
  v_mfma_f32_16x16x32_bf16 v[68:71], a[92:95], a[76:79], v[68:71]
  v_mul_f32 v132, v132, v116
  v_mul_f32 v133, v133, v116
  v_mfma_f32_16x16x32_bf16 v[160:163], a[112:115], v[88:91], v[160:163]
  v_cvt_pk_bf16_f32 v128, v128, v129
  v_mul_f32 v134, v134, v116
  v_mfma_f32_16x16x32_bf16 v[164:167], a[116:119], v[88:91], v[164:167]
  v_mul_f32 v135, v135, v116
  v_mul_f32 v136, v136, v116
  v_mfma_f32_16x16x32_bf16 v[168:171], a[120:123], v[88:91], v[168:171]
  v_mul_f32 v137, v137, v116
  v_cmp_nge_f32 vcc, s84, v118
  v_mfma_f32_16x16x32_bf16 v[172:175], a[124:127], v[88:91], v[172:175]
  v_max3_f32 v16, v36, v37, v38
  v_max3_f32 v20, v44, v45, v46
  v_mfma_f32_16x16x32_bf16 v[176:179], a[128:131], v[88:91], v[176:179]
  v_max3_f32 v24, v52, v53, v54
  v_max3_f32 v28, v60, v61, v62
  v_mfma_f32_16x16x32_bf16 v[180:183], a[132:135], v[88:91], v[180:183]
  v_max3_f32 v32, v68, v69, v70
  v_cvt_pk_bf16_f32 v129, v130, v131
  v_mfma_f32_16x16x32_bf16 v[184:187], a[136:139], v[88:91], v[184:187]
  v_cvt_pk_bf16_f32 v132, v132, v133
  v_mul_f32 v138, v138, v116
  v_mfma_f32_16x16x32_bf16 v[188:191], a[140:143], v[88:91], v[188:191]
  v_mul_f32 v139, v139, v116
  v_mul_f32 v140, v140, v116
  v_smfmac_f32_16x16x64_bf16 a[156:159], a[164:167], v[100:107], v1
  v_mul_f32 v141, v141, v116
  v_cvt_pk_bf16_f32 v133, v134, v135
  v_mfma_f32_16x16x32_bf16 v[192:195], a[112:115], v[96:99], v[192:195]
  v_cvt_pk_bf16_f32 v136, v136, v137
  s_or_b64 s[96:97], s[96:97], vcc
  v_mfma_f32_16x16x32_bf16 v[196:199], a[116:119], v[96:99], v[196:199]
  v_max_f32 v16, v16, v39
  v_max_f32 v20, v20, v47
  v_mfma_f32_16x16x32_bf16 v[200:203], a[120:123], v[96:99], v[200:203]
  v_max_f32 v24, v24, v55
  v_max_f32 v28, v28, v63
  v_mfma_f32_16x16x32_bf16 v[204:207], a[124:127], v[96:99], v[204:207]
  v_max_f32 v32, v32, v71
  v_mul_f32 v142, v142, v116
  v_mfma_f32_16x16x32_bf16 v[208:211], a[128:131], v[96:99], v[208:211]
  ds_write_b64 v15, v[128:129] offset:0
  v_mfma_f32_16x16x32_bf16 v[212:215], a[132:135], v[96:99], v[212:215]
  v_mul_f32 v143, v143, v116
  v_mul_f32 v144, v144, v116
  v_mfma_f32_16x16x32_bf16 v[216:219], a[136:139], v[96:99], v[216:219]
  v_mul_f32 v145, v145, v116
  v_cvt_pk_bf16_f32 v137, v138, v139
  v_mfma_f32_16x16x32_bf16 v[220:223], a[140:143], v[96:99], v[220:223]
  v_cvt_pk_bf16_f32 v140, v140, v141
  v_cmp_nle_f32 vcc, s94, v118
  v_mfma_f32_16x16x32_bf16 v[224:227], a[112:115], v[104:107], v[224:227]
  ds_write_b64 v15, v[132:133] offset:32
  v_mfma_f32_16x16x32_bf16 v[228:231], a[116:119], v[104:107], v[228:231]
  v_mul_f32 v146, v146, v116
  v_mul_f32 v147, v147, v116
  v_mfma_f32_16x16x32_bf16 v[232:235], a[120:123], v[104:107], v[232:235]
  v_mul_f32 v148, v148, v116
  v_mul_f32 v149, v149, v116
  v_mfma_f32_16x16x32_bf16 v[236:239], a[124:127], v[104:107], v[236:239]
  v_mov_b32 v17, v16
  v_mov_b32 v21, v20
  v_mfma_f32_16x16x32_bf16 v[240:243], a[128:131], v[104:107], v[240:243]
  v_mov_b32 v25, v24
  v_mov_b32 v29, v28
  v_mfma_f32_16x16x32_bf16 v[244:247], a[132:135], v[104:107], v[244:247]
  v_mov_b32 v33, v32
  v_cvt_pk_bf16_f32 v141, v142, v143
  v_mfma_f32_16x16x32_bf16 v[248:251], a[136:139], v[104:107], v[248:251]
  v_cvt_pk_bf16_f32 v144, v144, v145
  v_rcp_f32 v118, v118
  v_mfma_f32_16x16x32_bf16 v[252:255], a[140:143], v[104:107], v[252:255]
  ds_write_b64 v15, v[136:137] offset:64
  v_mul_f32 v150, v150, v116
  v_mul_f32 v151, v151, v116
  v_mul_f32 v152, v152, v116
  v_mul_f32 v153, v153, v116
  v_cvt_pk_bf16_f32 v145, v146, v147
  v_cvt_pk_bf16_f32 v148, v148, v149
  v_permlane32_swap_b32 v16, v17
  v_permlane32_swap_b32 v20, v21
  v_permlane32_swap_b32 v24, v25
  v_permlane32_swap_b32 v28, v29
  v_permlane32_swap_b32 v32, v33
  v_mul_f32 v154, v154, v116
  v_mul_f32 v155, v155, v116
  v_mul_f32 v156, v156, v116
  v_mul_f32 v157, v157, v116
  v_accvgpr_read_b32 v120, a152
  v_accvgpr_read_b32 v126, a153
  v_cvt_pk_bf16_f32 v149, v150, v151
  v_cvt_pk_bf16_f32 v152, v152, v153
  v_mul_f32 v158, v158, v116
  v_mul_f32 v159, v159, v116
  v_mul_f32 v160, v160, v118
  v_mul_f32 v161, v161, v118
  v_max_f32 v16, v16, v17
  v_max_f32 v20, v20, v21
  v_max_f32 v24, v24, v25
  v_max_f32 v28, v28, v29
  v_max_f32 v32, v32, v33
  v_cvt_pk_bf16_f32 v153, v154, v155
  v_cvt_pk_bf16_f32 v156, v156, v157
  v_add_f32 v120, v120, v126
  s_or_b64 s[96:97], s[96:97], vcc
  ds_write_b64 v15, v[140:141] offset:96
  ds_write_b64 v15, v[144:145] offset:128
  ds_write_b64 v15, v[148:149] offset:160
  v_mul_f32 v162, v162, v118
  v_mul_f32 v163, v163, v118
  v_mul_f32 v164, v164, v118
  v_mul_f32 v165, v165, v118
  v_cvt_pk_bf16_f32 v157, v158, v159
  v_cvt_pk_bf16_f32 v160, v160, v161
  v_mov_b32 v17, v16
  v_mov_b32 v21, v20
  v_mov_b32 v25, v24
  v_mov_b32 v29, v28
  v_mov_b32 v33, v32
  v_mul_f32 v166, v166, v118
  v_mul_f32 v167, v167, v118
  v_mul_f32 v168, v168, v118
  v_mul_f32 v169, v169, v118
  v_cmp_nge_f32 vcc, s84, v120
  v_cvt_pk_bf16_f32 v161, v162, v163
  v_cvt_pk_bf16_f32 v164, v164, v165
  v_mul_f32 v170, v170, v118
  v_mul_f32 v171, v171, v118
  v_mul_f32 v172, v172, v118
  v_mul_f32 v173, v173, v118
  v_permlane16_swap_b32 v16, v17
  v_permlane16_swap_b32 v20, v21
  v_permlane16_swap_b32 v24, v25
  v_permlane16_swap_b32 v28, v29
  v_permlane16_swap_b32 v32, v33
  v_cvt_pk_bf16_f32 v165, v166, v167
  v_cvt_pk_bf16_f32 v168, v168, v169
  s_or_b64 s[96:97], s[96:97], vcc
  ds_write_b64 v15, v[152:153] offset:192
  ds_write_b64 v15, v[156:157] offset:224
  ds_write_b64 v15, v[160:161] offset:4352
  v_mul_f32 v174, v174, v118
  v_mul_f32 v175, v175, v118
  v_mul_f32 v176, v176, v118
  v_mul_f32 v177, v177, v118
  v_cvt_pk_bf16_f32 v169, v170, v171
  v_cvt_pk_bf16_f32 v172, v172, v173
  v_cmp_nle_f32 vcc, s94, v120
  v_max_f32 v16, v16, v17
  v_max_f32 v20, v20, v21
  v_max_f32 v24, v24, v25
  v_max_f32 v28, v28, v29
  v_max_f32 v32, v32, v33
  v_mul_f32 v178, v178, v118
  v_mul_f32 v179, v179, v118
  v_mul_f32 v180, v180, v118
  v_mul_f32 v181, v181, v118
  v_cvt_pk_bf16_f32 v173, v174, v175
  v_cvt_pk_bf16_f32 v176, v176, v177
  v_rcp_f32 v120, v120
  v_mul_f32 v182, v182, v118
  v_mul_f32 v183, v183, v118
  v_mul_f32 v184, v184, v118
  v_mul_f32 v185, v185, v118
  v_sub_f32 v19, 0, v16
  v_sub_f32 v18, 0, v16
  v_sub_f32 v17, 0, v16
  v_sub_f32 v23, 0, v20
  v_sub_f32 v22, 0, v20
  v_sub_f32 v21, 0, v20
  v_sub_f32 v27, 0, v24
  v_sub_f32 v26, 0, v24
  v_sub_f32 v25, 0, v24
  v_sub_f32 v31, 0, v28
  v_sub_f32 v30, 0, v28
  v_sub_f32 v29, 0, v28
  v_sub_f32 v35, 0, v32
  v_sub_f32 v34, 0, v32
  v_sub_f32 v33, 0, v32
  v_cvt_pk_bf16_f32 v177, v178, v179
  v_cvt_pk_bf16_f32 v180, v180, v181
  v_mul_f32 v186, v186, v118
  v_mul_f32 v187, v187, v118
  v_mul_f32 v188, v188, v118
  v_mul_f32 v189, v189, v118
  v_accvgpr_read_b32 v122, a156
  v_accvgpr_read_b32 v127, a157
  v_sub_f32 v16, 0, v16
  v_sub_f32 v20, 0, v20
  v_sub_f32 v24, 0, v24
  v_mfma_f32_16x16x32_bf16 v[36:39], a[80:83], a[0:3], v[16:19]
  ds_write_b64 v15, v[164:165] offset:4384
  v_mfma_f32_16x16x32_bf16 v[40:43], a[96:99], a[0:3], v[16:19]
  ds_write_b64 v15, v[168:169] offset:4416
  v_mfma_f32_16x16x32_bf16 v[44:47], a[80:83], a[16:19], v[20:23]
  ds_write_b64 v15, v[172:173] offset:4448
  v_mfma_f32_16x16x32_bf16 v[48:51], a[96:99], a[16:19], v[20:23]
  v_sub_f32 v28, 0, v28
  v_sub_f32 v32, 0, v32
  v_mfma_f32_16x16x32_bf16 v[52:55], a[80:83], a[32:35], v[24:27]
  v_cvt_pk_bf16_f32 v181, v182, v183
  v_cvt_pk_bf16_f32 v184, v184, v185
  v_mfma_f32_16x16x32_bf16 v[56:59], a[96:99], a[32:35], v[24:27]
  ds_write_b64 v15, v[176:177] offset:4480
  v_mfma_f32_16x16x32_bf16 v[60:63], a[80:83], a[48:51], v[28:31]
  v_mul_f32 v190, v190, v118
  v_mul_f32 v191, v191, v118
  v_mfma_f32_16x16x32_bf16 v[64:67], a[96:99], a[48:51], v[28:31]
  v_mul_f32 v192, v192, v120
  v_mul_f32 v193, v193, v120
  v_mfma_f32_16x16x32_bf16 v[68:71], a[80:83], a[64:67], v[32:35]
  v_cvt_pk_bf16_f32 v185, v186, v187
  v_cvt_pk_bf16_f32 v188, v188, v189
  v_mfma_f32_16x16x32_bf16 v[72:75], a[96:99], a[64:67], v[32:35]
  v_add_f32 v122, v122, v127
  s_or_b64 s[96:97], s[96:97], vcc
  v_mfma_f32_16x16x32_bf16 v[36:39], a[84:87], a[4:7], v[36:39]
  ds_write_b64 v15, v[180:181] offset:4512
  v_mfma_f32_16x16x32_bf16 v[40:43], a[100:103], a[4:7], v[40:43]
  v_mul_f32 v194, v194, v120
  v_mul_f32 v195, v195, v120
  v_mfma_f32_16x16x32_bf16 v[44:47], a[84:87], a[20:23], v[44:47]
  v_mul_f32 v196, v196, v120
  v_mul_f32 v197, v197, v120
  v_mfma_f32_16x16x32_bf16 v[48:51], a[100:103], a[20:23], v[48:51]
  v_cvt_pk_bf16_f32 v189, v190, v191
  v_cvt_pk_bf16_f32 v192, v192, v193
  v_mfma_f32_16x16x32_bf16 v[52:55], a[84:87], a[36:39], v[52:55]
  ds_write_b64 v15, v[184:185] offset:4544
  v_mfma_f32_16x16x32_bf16 v[56:59], a[100:103], a[36:39], v[56:59]
  v_mul_f32 v198, v198, v120
  v_mul_f32 v199, v199, v120
  v_mfma_f32_16x16x32_bf16 v[60:63], a[84:87], a[52:55], v[60:63]
  v_mul_f32 v200, v200, v120
  v_mul_f32 v201, v201, v120
  v_mfma_f32_16x16x32_bf16 v[64:67], a[100:103], a[52:55], v[64:67]
  v_cmp_nge_f32 vcc, s84, v122
  v_cvt_pk_bf16_f32 v193, v194, v195
  v_mfma_f32_16x16x32_bf16 v[68:71], a[84:87], a[68:71], v[68:71]
  v_cvt_pk_bf16_f32 v196, v196, v197
  v_mul_f32 v202, v202, v120
  v_mfma_f32_16x16x32_bf16 v[72:75], a[100:103], a[68:71], v[72:75]
  ds_write_b64 v15, v[188:189] offset:4576
  v_mfma_f32_16x16x32_bf16 v[36:39], a[88:91], a[8:11], v[36:39]
  v_mul_f32 v203, v203, v120
  v_mul_f32 v204, v204, v120
  v_mfma_f32_16x16x32_bf16 v[40:43], a[104:107], a[8:11], v[40:43]
  v_mul_f32 v205, v205, v120
  v_cvt_pk_bf16_f32 v197, v198, v199
  v_mfma_f32_16x16x32_bf16 v[44:47], a[88:91], a[24:27], v[44:47]
  v_cvt_pk_bf16_f32 v200, v200, v201
  s_or_b64 s[96:97], s[96:97], vcc
  v_mfma_f32_16x16x32_bf16 v[48:51], a[104:107], a[24:27], v[48:51]
  ds_write_b64 v15, v[192:193] offset:8704
  v_mfma_f32_16x16x32_bf16 v[52:55], a[88:91], a[40:43], v[52:55]
  v_mul_f32 v206, v206, v120
  v_mul_f32 v207, v207, v120
  v_mfma_f32_16x16x32_bf16 v[56:59], a[104:107], a[40:43], v[56:59]
  v_mul_f32 v208, v208, v120
  v_mul_f32 v209, v209, v120
  v_mfma_f32_16x16x32_bf16 v[60:63], a[88:91], a[56:59], v[60:63]
  v_cvt_pk_bf16_f32 v201, v202, v203
  v_cvt_pk_bf16_f32 v204, v204, v205
  v_mfma_f32_16x16x32_bf16 v[64:67], a[104:107], a[56:59], v[64:67]
  v_cmp_nle_f32 vcc, s94, v122
  v_mul_f32 v210, v210, v120
  v_mfma_f32_16x16x32_bf16 v[68:71], a[88:91], a[72:75], v[68:71]
  ds_write_b64 v15, v[196:197] offset:8736
  v_mfma_f32_16x16x32_bf16 v[72:75], a[104:107], a[72:75], v[72:75]
  v_mul_f32 v211, v211, v120
  v_mul_f32 v212, v212, v120
  v_mfma_f32_16x16x32_bf16 v[36:39], a[92:95], a[12:15], v[36:39]
  v_mul_f32 v213, v213, v120
  v_cvt_pk_bf16_f32 v205, v206, v207
  v_mfma_f32_16x16x32_bf16 v[40:43], a[108:111], a[12:15], v[40:43]
  v_cvt_pk_bf16_f32 v208, v208, v209
  v_rcp_f32 v122, v122
  v_mfma_f32_16x16x32_bf16 v[44:47], a[92:95], a[28:31], v[44:47]
  ds_write_b64 v15, v[200:201] offset:8768
  v_mfma_f32_16x16x32_bf16 v[48:51], a[108:111], a[28:31], v[48:51]
  v_mul_f32 v214, v214, v120
  v_mul_f32 v215, v215, v120
  v_mfma_f32_16x16x32_bf16 v[52:55], a[92:95], a[44:47], v[52:55]
  v_mul_f32 v216, v216, v120
  v_mul_f32 v217, v217, v120
  v_mfma_f32_16x16x32_bf16 v[56:59], a[108:111], a[44:47], v[56:59]
  v_cvt_pk_bf16_f32 v209, v210, v211
  v_cvt_pk_bf16_f32 v212, v212, v213
  v_mfma_f32_16x16x32_bf16 v[60:63], a[92:95], a[60:63], v[60:63]
  ds_write_b64 v15, v[204:205] offset:8800
  v_mfma_f32_16x16x32_bf16 v[64:67], a[108:111], a[60:63], v[64:67]
  v_mul_f32 v218, v218, v120
  v_mul_f32 v219, v219, v120
  v_mfma_f32_16x16x32_bf16 v[68:71], a[92:95], a[76:79], v[68:71]
  v_mul_f32 v220, v220, v120
  v_mul_f32 v221, v221, v120
  v_mfma_f32_16x16x32_bf16 v[72:75], a[108:111], a[76:79], v[72:75]
  v_cvt_pk_bf16_f32 v213, v214, v215
  v_cvt_pk_bf16_f32 v216, v216, v217
  v_mul_f32 v222, v222, v120
  v_mul_f32 v223, v223, v120
  v_mul_f32 v224, v224, v122
  v_mul_f32 v225, v225, v122
  v_cvt_pk_bf16_f32 v217, v218, v219
  v_cvt_pk_bf16_f32 v220, v220, v221
  v_mul_f32 v226, v226, v122
  v_mul_f32 v227, v227, v122
  v_mul_f32 v228, v228, v122
  v_mul_f32 v229, v229, v122
  v_cvt_pk_bf16_f32 v221, v222, v223
  v_cvt_pk_bf16_f32 v224, v224, v225
  v_mul_f32 v230, v230, v122
  v_mul_f32 v231, v231, v122
  v_mul_f32 v232, v232, v122
  v_mul_f32 v233, v233, v122
  v_cvt_pk_bf16_f32 v225, v226, v227
  v_cvt_pk_bf16_f32 v228, v228, v229
  v_mul_f32 v234, v234, v122
  v_mul_f32 v235, v235, v122
  v_mul_f32 v236, v236, v122
  v_mul_f32 v237, v237, v122
  v_cvt_pk_bf16_f32 v229, v230, v231
  v_cvt_pk_bf16_f32 v232, v232, v233
  v_mul_f32 v238, v238, v122
  v_mul_f32 v239, v239, v122
  v_mul_f32 v240, v240, v122
  v_mul_f32 v241, v241, v122
  v_cvt_pk_bf16_f32 v233, v234, v235
  v_cvt_pk_bf16_f32 v236, v236, v237
  v_mul_f32 v242, v242, v122
  v_mul_f32 v243, v243, v122
  v_mul_f32 v244, v244, v122
  v_mul_f32 v245, v245, v122
  v_cvt_pk_bf16_f32 v237, v238, v239
  v_cvt_pk_bf16_f32 v240, v240, v241
  v_mul_f32 v246, v246, v122
  v_mul_f32 v247, v247, v122
  v_mul_f32 v248, v248, v122
  v_mul_f32 v249, v249, v122
  v_cvt_pk_bf16_f32 v241, v242, v243
  v_cvt_pk_bf16_f32 v244, v244, v245
  v_mul_f32 v250, v250, v122
  v_mul_f32 v251, v251, v122
  v_mul_f32 v252, v252, v122
  v_mul_f32 v253, v253, v122
  v_cvt_pk_bf16_f32 v245, v246, v247
  v_cvt_pk_bf16_f32 v248, v248, v249
  v_mul_f32 v254, v254, v122
  v_mul_f32 v255, v255, v122
  s_mov_b32 m0, 152576
  ds_write_b64 v15, v[208:209] offset:8832
  ds_write_b64 v15, v[212:213] offset:8864
  ds_write_b64 v15, v[216:217] offset:8896
  ds_write_b64 v15, v[220:221] offset:8928
  ds_write_b64 v15, v[224:225] offset:13056
  ds_write_b64 v15, v[228:229] offset:13088
  ds_write_b64 v15, v[232:233] offset:13120
  ds_write_b64 v15, v[236:237] offset:13152
  ds_write_b64 v15, v[240:241] offset:13184
  v_exp_f32 v36, v36
  v_exp_f32 v37, v37
  v_exp_f32 v38, v38
  v_exp_f32 v39, v39
  v_exp_f32 v40, v40
  v_exp_f32 v41, v41
  v_exp_f32 v42, v42
  v_exp_f32 v43, v43
  v_exp_f32 v44, v44
  v_exp_f32 v45, v45
  v_exp_f32 v46, v46
  v_exp_f32 v47, v47
  v_exp_f32 v48, v48
  v_exp_f32 v49, v49
  v_exp_f32 v50, v50
  v_exp_f32 v51, v51
  v_exp_f32 v52, v52
  v_exp_f32 v53, v53
  v_exp_f32 v54, v54
  v_exp_f32 v55, v55
  v_exp_f32 v56, v56
  v_exp_f32 v57, v57
  v_exp_f32 v58, v58
  v_exp_f32 v59, v59
  v_exp_f32 v60, v60
  v_exp_f32 v61, v61
  v_exp_f32 v62, v62
  v_exp_f32 v63, v63
  v_exp_f32 v64, v64
  v_exp_f32 v65, v65
  v_exp_f32 v66, v66
  v_exp_f32 v67, v67
  v_exp_f32 v68, v68
  v_exp_f32 v69, v69
  v_exp_f32 v70, v70
  v_exp_f32 v71, v71
  v_cvt_pk_bf16_f32 v249, v250, v251
  v_cvt_pk_bf16_f32 v252, v252, v253
  v_cvt_pk_bf16_f32 v253, v254, v255
  s_mov_b32 s34, s30
  ds_write_b64 v15, v[244:245] offset:13216
  buffer_load_dwordx4 v14, s[12:15], s83 offen lds
  ds_write_b64 v15, v[248:249] offset:13248
  ds_read_b128 a[80:83], v4 offset:8192
  ds_read_b128 a[84:87], v5 offset:8192
  ds_read_b128 a[88:91], v4 offset:9216
  ds_read_b128 a[92:95], v5 offset:9216
  ds_read_b128 a[96:99], v4 offset:12288
  ds_read_b128 a[100:103], v5 offset:12288
  ds_read_b128 a[104:107], v4 offset:13312
  ds_read_b128 a[108:111], v5 offset:13312
  s_mov_b32 s95, s30
  v_exp_f32 v72, v72
  s_add_u32 s25, s25, 8192
  s_mov_b32 m0, s32
  v_cvt_pk_bf16_f32 v76, v36, v37
  v_cvt_pk_bf16_f32 v77, v38, v39
  v_cvt_pk_bf16_f32 v78, v40, v41
  v_cvt_pk_bf16_f32 v79, v42, v43
  v_cvt_pk_bf16_f32 v84, v44, v45
  v_cvt_pk_bf16_f32 v85, v46, v47
  v_cvt_pk_bf16_f32 v86, v48, v49
  v_cvt_pk_bf16_f32 v87, v50, v51
  v_cvt_pk_bf16_f32 v92, v52, v53
  v_cvt_pk_bf16_f32 v93, v54, v55
  v_cvt_pk_bf16_f32 v94, v56, v57
  v_cvt_pk_bf16_f32 v95, v58, v59
  v_cvt_pk_bf16_f32 v100, v60, v61
  v_cvt_pk_bf16_f32 v101, v62, v63
  v_cvt_pk_bf16_f32 v102, v64, v65
  v_cvt_pk_bf16_f32 v103, v66, v67
  v_cvt_pk_bf16_f32 v108, v68, v69
  v_cvt_pk_bf16_f32 v109, v70, v71
  s_or_b64 s[96:97], s[96:97], vcc
  ds_write_b64 v15, v[252:253] offset:13280
  v_accvgpr_write_b32 a144, 0
  v_accvgpr_write_b32 a145, 0
  v_accvgpr_write_b32 a146, 0
  v_accvgpr_write_b32 a147, 0
  v_accvgpr_write_b32 a148, 0
  v_accvgpr_write_b32 a149, 0
  v_accvgpr_write_b32 a150, 0
  v_accvgpr_write_b32 a151, 0
  v_accvgpr_write_b32 a152, 0
  v_accvgpr_write_b32 a153, 0
  v_accvgpr_write_b32 a154, 0
  v_accvgpr_write_b32 a155, 0
  v_accvgpr_write_b32 a156, 0
  v_accvgpr_write_b32 a157, 0
  v_accvgpr_write_b32 a158, 0
  v_accvgpr_write_b32 a159, 0
  v_accvgpr_write_b32 a160, 0
  v_accvgpr_write_b32 a161, 0
  v_accvgpr_write_b32 a162, 0
  v_accvgpr_write_b32 a163, 0
  v_xor_b32 v4, 0x4000, v4
  v_xor_b32 v5, 0x4000, v5
  s_mov_b32 s36, 2048
  s_mov_b32 s37, 2176
  s_mov_b32 s28, 1
  s_mov_b32 s29, s85
  s_mov_b32 s30, s31
  v_lshrrev_b32 v124, 4, v0
  v_mul_u32_u24 v124, 272, v124
  v_and_b32 v125, 15, v0
  v_lshl_add_u32 v124, v125, 4, v124
  v_add_u32 v120, s33, v124
  s_waitcnt lgkmcnt(0)
  s_add_u32 s26, s25, 139264
  s_add_u32 s27, s25, 253952
  v_mfma_f32_16x16x32_bf16 v[36:39], a[80:83], a[0:3], v[16:19]
  ds_read_b64_tr_b16 a[112:113], v6 offset:8192
  v_mfma_f32_16x16x32_bf16 v[36:39], a[84:87], a[4:7], v[36:39]
  v_exp_f32 v73, v73
  v_mfma_f32_16x16x32_bf16 v[36:39], a[88:91], a[8:11], v[36:39]
  ds_read_b64_tr_b16 a[114:115], v6 offset:12288
  v_cvt_pk_bf16_f32 v110, v72, v73
  v_mfma_f32_16x16x32_bf16 v[36:39], a[92:95], a[12:15], v[36:39]
  v_exp_f32 v74, v74
  v_mfma_f32_16x16x32_bf16 v[40:43], a[96:99], a[0:3], v[16:19]
  ds_read_b64_tr_b16 a[116:117], v7 offset:8192
  ds_read_b64_tr_b16 a[118:119], v7 offset:12288
  v_mfma_f32_16x16x32_bf16 v[40:43], a[100:103], a[4:7], v[40:43]
  v_exp_f32 v75, v75
  v_mfma_f32_16x16x32_bf16 v[40:43], a[104:107], a[8:11], v[40:43]
  ds_read_b64_tr_b16 a[120:121], v8 offset:8192
  v_cvt_pk_bf16_f32 v111, v74, v75
  v_mfma_f32_16x16x32_bf16 v[40:43], a[108:111], a[12:15], v[40:43]
  v_exp_f32 v36, v36
  v_mfma_f32_16x16x32_bf16 v[44:47], a[80:83], a[16:19], v[20:23]
  ds_read_b64_tr_b16 a[122:123], v8 offset:12288
  ds_read_b64_tr_b16 a[124:125], v9 offset:8192
  v_mfma_f32_16x16x32_bf16 v[44:47], a[84:87], a[20:23], v[44:47]
  v_exp_f32 v37, v37
  v_mfma_f32_16x16x32_bf16 v[44:47], a[88:91], a[24:27], v[44:47]
  ds_read_b64_tr_b16 a[126:127], v9 offset:12288
  v_cvt_pk_bf16_f32 v80, v36, v37
  v_mfma_f32_16x16x32_bf16 v[44:47], a[92:95], a[28:31], v[44:47]
  v_exp_f32 v38, v38
  v_mfma_f32_16x16x32_bf16 v[48:51], a[96:99], a[16:19], v[20:23]
  ds_read_b64_tr_b16 a[128:129], v6 offset:9216
  ds_read_b64_tr_b16 a[130:131], v6 offset:13312
  v_mfma_f32_16x16x32_bf16 v[48:51], a[100:103], a[20:23], v[48:51]
  ds_read_b64_tr_b16 a[132:133], v7 offset:9216
  ds_read_b64_tr_b16 a[134:135], v7 offset:13312
  v_mfma_f32_16x16x32_bf16 v[48:51], a[104:107], a[24:27], v[48:51]
  v_exp_f32 v39, v39
  v_mfma_f32_16x16x32_bf16 v[48:51], a[108:111], a[28:31], v[48:51]
  ds_read_b64_tr_b16 a[136:137], v8 offset:9216
  v_cvt_pk_bf16_f32 v81, v38, v39
  v_mfma_f32_16x16x32_bf16 v[52:55], a[80:83], a[32:35], v[24:27]
  v_exp_f32 v40, v40
  v_mfma_f32_16x16x32_bf16 v[52:55], a[84:87], a[36:39], v[52:55]
  ds_read_b64_tr_b16 a[138:139], v8 offset:13312
  ds_read_b64_tr_b16 a[140:141], v9 offset:9216
  v_mfma_f32_16x16x32_bf16 v[52:55], a[88:91], a[40:43], v[52:55]
  v_exp_f32 v41, v41
  v_mfma_f32_16x16x32_bf16 v[52:55], a[92:95], a[44:47], v[52:55]
  ds_read_b64_tr_b16 a[142:143], v9 offset:13312
  v_cvt_pk_bf16_f32 v82, v40, v41
  v_mfma_f32_16x16x32_bf16 v[56:59], a[96:99], a[32:35], v[24:27]
  v_exp_f32 v42, v42
  v_mfma_f32_16x16x32_bf16 v[56:59], a[100:103], a[36:39], v[56:59]
  v_xor_b32 v6, 0x4000, v6
  v_mfma_f32_16x16x32_bf16 v[56:59], a[104:107], a[40:43], v[56:59]
  v_exp_f32 v43, v43
  v_mfma_f32_16x16x32_bf16 v[56:59], a[108:111], a[44:47], v[56:59]
  v_cvt_pk_bf16_f32 v83, v42, v43
  v_xor_b32 v7, 0x4000, v7
  v_mfma_f32_16x16x32_bf16 v[60:63], a[80:83], a[48:51], v[28:31]
  v_exp_f32 v44, v44
  v_mfma_f32_16x16x32_bf16 v[60:63], a[84:87], a[52:55], v[60:63]
  v_xor_b32 v8, 0x4000, v8
  v_xor_b32 v9, 0x4000, v9
  v_mfma_f32_16x16x32_bf16 v[60:63], a[88:91], a[56:59], v[60:63]
  v_exp_f32 v45, v45
  v_mfma_f32_16x16x32_bf16 v[60:63], a[92:95], a[60:63], v[60:63]
  v_cvt_pk_bf16_f32 v88, v44, v45
  v_mfma_f32_16x16x32_bf16 v[64:67], a[96:99], a[48:51], v[28:31]
  v_exp_f32 v46, v46
  v_mfma_f32_16x16x32_bf16 v[64:67], a[100:103], a[52:55], v[64:67]
  v_mfma_f32_16x16x32_bf16 v[64:67], a[104:107], a[56:59], v[64:67]
  v_exp_f32 v47, v47
  v_mfma_f32_16x16x32_bf16 v[64:67], a[108:111], a[60:63], v[64:67]
  v_cvt_pk_bf16_f32 v89, v46, v47
  v_mfma_f32_16x16x32_bf16 v[68:71], a[80:83], a[64:67], v[32:35]
  v_exp_f32 v48, v48
  v_mfma_f32_16x16x32_bf16 v[68:71], a[84:87], a[68:71], v[68:71]
  v_mfma_f32_16x16x32_bf16 v[68:71], a[88:91], a[72:75], v[68:71]
  v_exp_f32 v49, v49
  v_mfma_f32_16x16x32_bf16 v[68:71], a[92:95], a[76:79], v[68:71]
  v_cvt_pk_bf16_f32 v90, v48, v49
  s_waitcnt vmcnt(10) lgkmcnt(0)
  v_mfma_f32_16x16x32_bf16 v[72:75], a[96:99], a[64:67], v[32:35]
  v_exp_f32 v50, v50
  v_mfma_f32_16x16x32_bf16 v[72:75], a[100:103], a[68:71], v[72:75]
  s_barrier
  v_mfma_f32_16x16x32_bf16 v[72:75], a[104:107], a[72:75], v[72:75]
  v_exp_f32 v51, v51
  v_mfma_f32_16x16x32_bf16 v[72:75], a[108:111], a[76:79], v[72:75]
  s_xor_b32 m0, m0, 0x2000
  v_cvt_pk_bf16_f32 v91, v50, v51
  v_mfma_f32_16x16x32_bf16 v[128:131], a[112:115], v[76:79], 0
  v_exp_f32 v52, v52
  v_mfma_f32_16x16x32_bf16 v[160:163], a[112:115], v[84:87], 0
  buffer_load_dwordx4 v10, s[16:19], s25 offen offset:0  lds
  v_mfma_f32_16x16x32_bf16 v[192:195], a[112:115], v[92:95], 0
  v_exp_f32 v53, v53
  v_mfma_f32_16x16x32_bf16 v[224:227], a[112:115], v[100:103], 0
  ds_read_b128 a[80:83], v4 offset:0
  v_cvt_pk_bf16_f32 v96, v52, v53
  v_mfma_f32_16x16x32_bf16 a[168:171], a[112:115], v[108:111], 0
  v_exp_f32 v54, v54
  v_mfma_f32_16x16x32_bf16 v[132:135], a[116:119], v[76:79], 0
  ds_read_b128 a[84:87], v5 offset:0
  ds_read_b128 a[88:91], v4 offset:1024
  v_mfma_f32_16x16x32_bf16 v[164:167], a[116:119], v[84:87], 0
  buffer_load_dwordx4 v11, s[16:19], s25 offen offset:1024  lds
  v_mfma_f32_16x16x32_bf16 v[196:199], a[116:119], v[92:95], 0
  v_exp_f32 v55, v55
  v_mfma_f32_16x16x32_bf16 v[228:231], a[116:119], v[100:103], 0
  ds_read_b128 a[92:95], v5 offset:1024
  v_cvt_pk_bf16_f32 v97, v54, v55
  v_mfma_f32_16x16x32_bf16 a[172:175], a[116:119], v[108:111], 0
  v_exp_f32 v56, v56
  v_mfma_f32_16x16x32_bf16 v[136:139], a[120:123], v[76:79], 0
  buffer_load_dwordx4 v12, s[16:19], s25 offen offset:2048  lds
  v_mfma_f32_16x16x32_bf16 v[168:171], a[120:123], v[84:87], 0
  v_exp_f32 v57, v57
  v_mfma_f32_16x16x32_bf16 v[200:203], a[120:123], v[92:95], 0
  ds_read_b128 a[96:99], v4 offset:4096
  v_cvt_pk_bf16_f32 v98, v56, v57
  v_mfma_f32_16x16x32_bf16 v[232:235], a[120:123], v[100:103], 0
  v_exp_f32 v58, v58
  v_mfma_f32_16x16x32_bf16 a[176:179], a[120:123], v[108:111], 0
  ds_read_b128 a[100:103], v5 offset:4096
  ds_read_b128 a[104:107], v4 offset:5120
  v_mfma_f32_16x16x32_bf16 v[140:143], a[124:127], v[76:79], 0
  v_exp_f32 v59, v59
  v_mfma_f32_16x16x32_bf16 v[172:175], a[124:127], v[84:87], 0
  ds_read_b128 a[108:111], v5 offset:5120
  v_cvt_pk_bf16_f32 v99, v58, v59
  v_mfma_f32_16x16x32_bf16 v[204:207], a[124:127], v[92:95], 0
  v_exp_f32 v60, v60
  v_mfma_f32_16x16x32_bf16 v[236:239], a[124:127], v[100:103], 0
  buffer_load_dwordx4 v13, s[16:19], s25 offen offset:3072  lds
  v_mfma_f32_16x16x32_bf16 a[180:183], a[124:127], v[108:111], 0
  v_exp_f32 v61, v61
  v_mfma_f32_16x16x32_bf16 v[144:147], a[128:131], v[76:79], 0
  s_add_u32 s25, s25, 8192
  v_cvt_pk_bf16_f32 v104, v60, v61
  v_mfma_f32_16x16x32_bf16 v[176:179], a[128:131], v[84:87], 0
  v_exp_f32 v62, v62
  v_mfma_f32_16x16x32_bf16 v[208:211], a[128:131], v[92:95], 0
  buffer_store_dwordx4 v[116:119], v14, s[20:23], s83 offen offset:1024 sc1
  v_mfma_f32_16x16x32_bf16 v[240:243], a[128:131], v[100:103], 0
  v_exp_f32 v63, v63
  v_mfma_f32_16x16x32_bf16 a[184:187], a[128:131], v[108:111], 0
  v_cvt_pk_bf16_f32 v105, v62, v63
  v_mfma_f32_16x16x32_bf16 v[148:151], a[132:135], v[76:79], 0
  v_exp_f32 v64, v64
  v_mfma_f32_16x16x32_bf16 v[180:183], a[132:135], v[84:87], 0
  v_mfma_f32_16x16x32_bf16 v[212:215], a[132:135], v[92:95], 0
  v_exp_f32 v65, v65
  v_mfma_f32_16x16x32_bf16 v[244:247], a[132:135], v[100:103], 0
  v_cvt_pk_bf16_f32 v106, v64, v65
  v_mfma_f32_16x16x32_bf16 a[188:191], a[132:135], v[108:111], 0
  v_exp_f32 v66, v66
  v_mfma_f32_16x16x32_bf16 v[152:155], a[136:139], v[76:79], 0
  v_mfma_f32_16x16x32_bf16 v[184:187], a[136:139], v[84:87], 0
  v_exp_f32 v67, v67
  v_mfma_f32_16x16x32_bf16 v[216:219], a[136:139], v[92:95], 0
  v_cvt_pk_bf16_f32 v107, v66, v67
  v_mfma_f32_16x16x32_bf16 v[248:251], a[136:139], v[100:103], 0
  v_exp_f32 v68, v68
  v_mfma_f32_16x16x32_bf16 a[192:195], a[136:139], v[108:111], 0
  v_mfma_f32_16x16x32_bf16 v[156:159], a[140:143], v[76:79], 0
  v_exp_f32 v69, v69
  v_mfma_f32_16x16x32_bf16 v[188:191], a[140:143], v[84:87], 0
  v_cvt_pk_bf16_f32 v112, v68, v69
  v_mfma_f32_16x16x32_bf16 v[220:223], a[140:143], v[92:95], 0
  v_exp_f32 v70, v70
  v_mfma_f32_16x16x32_bf16 v[252:255], a[140:143], v[100:103], 0
  s_waitcnt lgkmcnt(0)
  v_mfma_f32_16x16x32_bf16 a[196:199], a[140:143], v[108:111], 0
L_odd_r1b:
  v_smfmac_f32_16x16x64_bf16 a[144:147], a[164:167], v[76:83], v1
  v_exp_f32 v71, v71
  v_mfma_f32_16x16x32_bf16 v[36:39], a[80:83], a[0:3], v[16:19]
  ds_read_b128 v[116:119], v120 offset:0
  v_cvt_pk_bf16_f32 v113, v70, v71
  v_mfma_f32_16x16x32_bf16 v[36:39], a[84:87], a[4:7], v[36:39]
  v_exp_f32 v72, v72
  v_mfma_f32_16x16x32_bf16 v[36:39], a[88:91], a[8:11], v[36:39]
  ds_read_b64_tr_b16 a[112:113], v6 offset:0
  ds_read_b64_tr_b16 a[114:115], v6 offset:4096
  v_mfma_f32_16x16x32_bf16 v[36:39], a[92:95], a[12:15], v[36:39]
  v_exp_f32 v73, v73
  v_mfma_f32_16x16x32_bf16 v[40:43], a[96:99], a[0:3], v[16:19]
  ds_read_b64_tr_b16 a[116:117], v7 offset:0
  v_cvt_pk_bf16_f32 v114, v72, v73
  v_mfma_f32_16x16x32_bf16 v[40:43], a[100:103], a[4:7], v[40:43]
  v_exp_f32 v74, v74
  v_mfma_f32_16x16x32_bf16 v[40:43], a[104:107], a[8:11], v[40:43]
  ds_read_b64_tr_b16 a[118:119], v7 offset:4096
  ds_read_b64_tr_b16 a[120:121], v8 offset:0
  v_mfma_f32_16x16x32_bf16 v[40:43], a[108:111], a[12:15], v[40:43]
  v_exp_f32 v75, v75
  v_smfmac_f32_16x16x64_bf16 a[148:151], a[164:167], v[84:91], v1
  ds_read_b64_tr_b16 a[122:123], v8 offset:4096
  v_cvt_pk_bf16_f32 v115, v74, v75
  v_mfma_f32_16x16x32_bf16 v[44:47], a[80:83], a[16:19], v[20:23]
  v_exp_f32 v36, v36
  v_mfma_f32_16x16x32_bf16 v[44:47], a[84:87], a[20:23], v[44:47]
  ds_read_b64_tr_b16 a[124:125], v9 offset:0
  ds_read_b64_tr_b16 a[126:127], v9 offset:4096
  v_mfma_f32_16x16x32_bf16 v[44:47], a[88:91], a[24:27], v[44:47]
  v_exp_f32 v37, v37
  v_mfma_f32_16x16x32_bf16 v[44:47], a[92:95], a[28:31], v[44:47]
  ds_read_b64_tr_b16 a[128:129], v6 offset:1024
  v_cvt_pk_bf16_f32 v76, v36, v37
  v_mfma_f32_16x16x32_bf16 v[48:51], a[96:99], a[16:19], v[20:23]
  v_exp_f32 v38, v38
  v_mfma_f32_16x16x32_bf16 v[48:51], a[100:103], a[20:23], v[48:51]
  ds_read_b64_tr_b16 a[130:131], v6 offset:5120
  ds_read_b64_tr_b16 a[132:133], v7 offset:1024
  v_mfma_f32_16x16x32_bf16 v[48:51], a[104:107], a[24:27], v[48:51]
  v_exp_f32 v39, v39
  v_mfma_f32_16x16x32_bf16 v[48:51], a[108:111], a[28:31], v[48:51]
  ds_read_b64_tr_b16 a[134:135], v7 offset:5120
  v_cvt_pk_bf16_f32 v77, v38, v39
  v_smfmac_f32_16x16x64_bf16 a[152:155], a[164:167], v[92:99], v1
  v_exp_f32 v40, v40
  v_mfma_f32_16x16x32_bf16 v[52:55], a[80:83], a[32:35], v[24:27]
  ds_read_b64_tr_b16 a[136:137], v8 offset:1024
  ds_read_b64_tr_b16 a[138:139], v8 offset:5120
  v_mfma_f32_16x16x32_bf16 v[52:55], a[84:87], a[36:39], v[52:55]
  v_exp_f32 v41, v41
  v_mfma_f32_16x16x32_bf16 v[52:55], a[88:91], a[40:43], v[52:55]
  ds_read_b64_tr_b16 a[140:141], v9 offset:1024
  v_cvt_pk_bf16_f32 v78, v40, v41
  v_mfma_f32_16x16x32_bf16 v[52:55], a[92:95], a[44:47], v[52:55]
  v_exp_f32 v42, v42
  v_mfma_f32_16x16x32_bf16 v[56:59], a[96:99], a[32:35], v[24:27]
  ds_read_b64_tr_b16 a[142:143], v9 offset:5120
  v_mfma_f32_16x16x32_bf16 v[56:59], a[100:103], a[36:39], v[56:59]
  v_exp_f32 v43, v43
  v_mfma_f32_16x16x32_bf16 v[56:59], a[104:107], a[40:43], v[56:59]
  v_cvt_pk_bf16_f32 v79, v42, v43
  v_mfma_f32_16x16x32_bf16 v[56:59], a[108:111], a[44:47], v[56:59]
  v_exp_f32 v44, v44
  v_smfmac_f32_16x16x64_bf16 a[156:159], a[164:167], v[100:107], v1
  v_mfma_f32_16x16x32_bf16 v[60:63], a[80:83], a[48:51], v[28:31]
  v_exp_f32 v45, v45
  v_mfma_f32_16x16x32_bf16 v[60:63], a[84:87], a[52:55], v[60:63]
  v_cvt_pk_bf16_f32 v84, v44, v45
  v_mfma_f32_16x16x32_bf16 v[60:63], a[88:91], a[56:59], v[60:63]
  v_exp_f32 v46, v46
  v_mfma_f32_16x16x32_bf16 v[60:63], a[92:95], a[60:63], v[60:63]
  v_mfma_f32_16x16x32_bf16 v[64:67], a[96:99], a[48:51], v[28:31]
  v_mfma_f32_16x16x32_bf16 v[64:67], a[100:103], a[52:55], v[64:67]
  v_exp_f32 v47, v47
  v_mfma_f32_16x16x32_bf16 v[64:67], a[104:107], a[56:59], v[64:67]
  v_cvt_pk_bf16_f32 v85, v46, v47
  v_mfma_f32_16x16x32_bf16 v[64:67], a[108:111], a[60:63], v[64:67]
  v_exp_f32 v48, v48
  v_smfmac_f32_16x16x64_bf16 a[160:163], a[164:167], v[108:115], v1
  v_mfma_f32_16x16x32_bf16 v[68:71], a[80:83], a[64:67], v[32:35]
  v_exp_f32 v49, v49
  v_mfma_f32_16x16x32_bf16 v[68:71], a[84:87], a[68:71], v[68:71]
  v_cvt_pk_bf16_f32 v86, v48, v49
  v_mfma_f32_16x16x32_bf16 v[68:71], a[88:91], a[72:75], v[68:71]
  v_exp_f32 v50, v50
  v_mfma_f32_16x16x32_bf16 v[68:71], a[92:95], a[76:79], v[68:71]
  v_mfma_f32_16x16x32_bf16 v[72:75], a[96:99], a[64:67], v[32:35]
  v_exp_f32 v51, v51
  v_mfma_f32_16x16x32_bf16 v[72:75], a[100:103], a[68:71], v[72:75]
  v_cvt_pk_bf16_f32 v87, v50, v51
  s_waitcnt vmcnt(10) lgkmcnt(0)
  v_mfma_f32_16x16x32_bf16 v[72:75], a[104:107], a[72:75], v[72:75]
  v_exp_f32 v52, v52
  v_mfma_f32_16x16x32_bf16 v[72:75], a[108:111], a[76:79], v[72:75]
  s_barrier
  v_mfma_f32_16x16x32_bf16 v[128:131], a[112:115], v[80:83], v[128:131]
  v_exp_f32 v53, v53
  v_mfma_f32_16x16x32_bf16 v[160:163], a[112:115], v[88:91], v[160:163]
  s_xor_b32 m0, m0, 0x6000
  v_cvt_pk_bf16_f32 v92, v52, v53
  v_mfma_f32_16x16x32_bf16 v[192:195], a[112:115], v[96:99], v[192:195]
  v_exp_f32 v54, v54
  v_mfma_f32_16x16x32_bf16 v[224:227], a[112:115], v[104:107], v[224:227]
  buffer_load_dwordx4 v10, s[16:19], s25 offen offset:0  lds
  v_mfma_f32_16x16x32_bf16 a[168:171], a[112:115], v[112:115], a[168:171]
  v_exp_f32 v55, v55
  v_mfma_f32_16x16x32_bf16 v[132:135], a[116:119], v[80:83], v[132:135]
  ds_read_b128 a[80:83], v4 offset:8192
  v_cvt_pk_bf16_f32 v93, v54, v55
  v_mfma_f32_16x16x32_bf16 v[164:167], a[116:119], v[88:91], v[164:167]
  v_exp_f32 v56, v56
  v_mfma_f32_16x16x32_bf16 v[196:199], a[116:119], v[96:99], v[196:199]
  ds_read_b128 a[84:87], v5 offset:8192
  ds_read_b128 a[88:91], v4 offset:9216
  v_mfma_f32_16x16x32_bf16 v[228:231], a[116:119], v[104:107], v[228:231]
  v_exp_f32 v57, v57
  v_mfma_f32_16x16x32_bf16 a[172:175], a[116:119], v[112:115], a[172:175]
  ds_read_b128 a[92:95], v5 offset:9216
  v_cvt_pk_bf16_f32 v94, v56, v57
  v_mfma_f32_16x16x32_bf16 v[136:139], a[120:123], v[80:83], v[136:139]
  v_exp_f32 v58, v58
  v_mfma_f32_16x16x32_bf16 v[168:171], a[120:123], v[88:91], v[168:171]
  buffer_load_dwordx4 v11, s[16:19], s25 offen offset:1024  lds
  v_mfma_f32_16x16x32_bf16 v[200:203], a[120:123], v[96:99], v[200:203]
  v_exp_f32 v59, v59
  v_mfma_f32_16x16x32_bf16 v[232:235], a[120:123], v[104:107], v[232:235]
  ds_read_b128 a[96:99], v4 offset:12288
  v_cvt_pk_bf16_f32 v95, v58, v59
  v_mfma_f32_16x16x32_bf16 a[176:179], a[120:123], v[112:115], a[176:179]
  v_exp_f32 v60, v60
  v_mfma_f32_16x16x32_bf16 v[140:143], a[124:127], v[80:83], v[140:143]
  buffer_load_dwordx4 v12, s[16:19], s25 offen offset:2048  lds
  v_mfma_f32_16x16x32_bf16 v[172:175], a[124:127], v[88:91], v[172:175]
  v_exp_f32 v61, v61
  v_mfma_f32_16x16x32_bf16 v[204:207], a[124:127], v[96:99], v[204:207]
  ds_read_b128 a[100:103], v5 offset:12288
  v_cvt_pk_bf16_f32 v100, v60, v61
  v_mfma_f32_16x16x32_bf16 v[236:239], a[124:127], v[104:107], v[236:239]
  v_exp_f32 v62, v62
  v_mfma_f32_16x16x32_bf16 a[180:183], a[124:127], v[112:115], a[180:183]
  buffer_load_dwordx4 v13, s[16:19], s25 offen offset:3072  lds
  v_mfma_f32_16x16x32_bf16 v[144:147], a[128:131], v[80:83], v[144:147]
  ds_read_b128 a[104:107], v4 offset:13312
  ds_read_b128 a[108:111], v5 offset:13312
  v_mfma_f32_16x16x32_bf16 v[176:179], a[128:131], v[88:91], v[176:179]
  v_exp_f32 v63, v63
  v_mfma_f32_16x16x32_bf16 v[208:211], a[128:131], v[96:99], v[208:211]
  s_add_u32 s25, s25, 8192
  v_cvt_pk_bf16_f32 v101, v62, v63
  v_mfma_f32_16x16x32_bf16 v[240:243], a[128:131], v[104:107], v[240:243]
  v_exp_f32 v64, v64
  v_mfma_f32_16x16x32_bf16 a[184:187], a[128:131], v[112:115], a[184:187]
  buffer_store_dwordx4 v[116:119], v14, s[20:23], s34 offen offset:0 sc1
  v_mfma_f32_16x16x32_bf16 v[148:151], a[132:135], v[80:83], v[148:151]
  v_exp_f32 v65, v65
  v_mfma_f32_16x16x32_bf16 v[180:183], a[132:135], v[88:91], v[180:183]
  v_cvt_pk_bf16_f32 v102, v64, v65
  v_xor_b32 v4, 0x4000, v4
  v_mfma_f32_16x16x32_bf16 v[212:215], a[132:135], v[96:99], v[212:215]
  v_exp_f32 v66, v66
  v_mfma_f32_16x16x32_bf16 v[244:247], a[132:135], v[104:107], v[244:247]
  v_xor_b32 v5, 0x4000, v5
  v_mfma_f32_16x16x32_bf16 a[188:191], a[132:135], v[112:115], a[188:191]
  v_exp_f32 v67, v67
  v_mfma_f32_16x16x32_bf16 v[152:155], a[136:139], v[80:83], v[152:155]
  v_cvt_pk_bf16_f32 v103, v66, v67
  v_mfma_f32_16x16x32_bf16 v[184:187], a[136:139], v[88:91], v[184:187]
  v_exp_f32 v68, v68
  v_mfma_f32_16x16x32_bf16 v[216:219], a[136:139], v[96:99], v[216:219]
  v_mfma_f32_16x16x32_bf16 v[248:251], a[136:139], v[104:107], v[248:251]
  v_exp_f32 v69, v69
  v_mfma_f32_16x16x32_bf16 a[192:195], a[136:139], v[112:115], a[192:195]
  v_cvt_pk_bf16_f32 v108, v68, v69
  v_mfma_f32_16x16x32_bf16 v[156:159], a[140:143], v[80:83], v[156:159]
  v_exp_f32 v70, v70
  v_mfma_f32_16x16x32_bf16 v[188:191], a[140:143], v[88:91], v[188:191]
  v_mfma_f32_16x16x32_bf16 v[220:223], a[140:143], v[96:99], v[220:223]
  v_exp_f32 v71, v71
  v_mfma_f32_16x16x32_bf16 v[252:255], a[140:143], v[104:107], v[252:255]
  v_cvt_pk_bf16_f32 v109, v70, v71
  s_waitcnt lgkmcnt(0)
  v_mfma_f32_16x16x32_bf16 a[196:199], a[140:143], v[112:115], a[196:199]
  v_exp_f32 v72, v72
  v_mfma_f32_16x16x32_bf16 v[36:39], a[80:83], a[0:3], v[16:19]
  ds_read_b128 v[116:119], v120 offset:1088
  ds_read_b64_tr_b16 a[112:113], v6 offset:8192
  v_mfma_f32_16x16x32_bf16 v[36:39], a[84:87], a[4:7], v[36:39]
  v_exp_f32 v73, v73
  v_mfma_f32_16x16x32_bf16 v[36:39], a[88:91], a[8:11], v[36:39]
  ds_read_b64_tr_b16 a[114:115], v6 offset:12288
  v_cvt_pk_bf16_f32 v110, v72, v73
  v_mfma_f32_16x16x32_bf16 v[36:39], a[92:95], a[12:15], v[36:39]
  v_exp_f32 v74, v74
  v_mfma_f32_16x16x32_bf16 v[40:43], a[96:99], a[0:3], v[16:19]
  ds_read_b64_tr_b16 a[116:117], v7 offset:8192
  ds_read_b64_tr_b16 a[118:119], v7 offset:12288
  v_mfma_f32_16x16x32_bf16 v[40:43], a[100:103], a[4:7], v[40:43]
  v_exp_f32 v75, v75
  v_mfma_f32_16x16x32_bf16 v[40:43], a[104:107], a[8:11], v[40:43]
  ds_read_b64_tr_b16 a[120:121], v8 offset:8192
  v_cvt_pk_bf16_f32 v111, v74, v75
  v_mfma_f32_16x16x32_bf16 v[40:43], a[108:111], a[12:15], v[40:43]
  v_exp_f32 v36, v36
  v_mfma_f32_16x16x32_bf16 v[44:47], a[80:83], a[16:19], v[20:23]
  ds_read_b64_tr_b16 a[122:123], v8 offset:12288
  ds_read_b64_tr_b16 a[124:125], v9 offset:8192
  v_mfma_f32_16x16x32_bf16 v[44:47], a[84:87], a[20:23], v[44:47]
  v_exp_f32 v37, v37
  v_mfma_f32_16x16x32_bf16 v[44:47], a[88:91], a[24:27], v[44:47]
  ds_read_b64_tr_b16 a[126:127], v9 offset:12288
  v_cvt_pk_bf16_f32 v80, v36, v37
  v_mfma_f32_16x16x32_bf16 v[44:47], a[92:95], a[28:31], v[44:47]
  v_exp_f32 v38, v38
  v_mfma_f32_16x16x32_bf16 v[48:51], a[96:99], a[16:19], v[20:23]
  ds_read_b64_tr_b16 a[128:129], v6 offset:9216
  ds_read_b64_tr_b16 a[130:131], v6 offset:13312
  v_mfma_f32_16x16x32_bf16 v[48:51], a[100:103], a[20:23], v[48:51]
  ds_read_b64_tr_b16 a[132:133], v7 offset:9216
  ds_read_b64_tr_b16 a[134:135], v7 offset:13312
  v_mfma_f32_16x16x32_bf16 v[48:51], a[104:107], a[24:27], v[48:51]
  v_exp_f32 v39, v39
  v_mfma_f32_16x16x32_bf16 v[48:51], a[108:111], a[28:31], v[48:51]
  ds_read_b64_tr_b16 a[136:137], v8 offset:9216
  v_cvt_pk_bf16_f32 v81, v38, v39
  v_mfma_f32_16x16x32_bf16 v[52:55], a[80:83], a[32:35], v[24:27]
  v_exp_f32 v40, v40
  v_mfma_f32_16x16x32_bf16 v[52:55], a[84:87], a[36:39], v[52:55]
  ds_read_b64_tr_b16 a[138:139], v8 offset:13312
  ds_read_b64_tr_b16 a[140:141], v9 offset:9216
  v_mfma_f32_16x16x32_bf16 v[52:55], a[88:91], a[40:43], v[52:55]
  v_exp_f32 v41, v41
  v_mfma_f32_16x16x32_bf16 v[52:55], a[92:95], a[44:47], v[52:55]
  ds_read_b64_tr_b16 a[142:143], v9 offset:13312
  v_cvt_pk_bf16_f32 v82, v40, v41
  v_mfma_f32_16x16x32_bf16 v[56:59], a[96:99], a[32:35], v[24:27]
  v_exp_f32 v42, v42
  v_mfma_f32_16x16x32_bf16 v[56:59], a[100:103], a[36:39], v[56:59]
  v_add_u32 v120, s37, v120
  v_xor_b32 v6, 0x4000, v6
  v_mfma_f32_16x16x32_bf16 v[56:59], a[104:107], a[40:43], v[56:59]
  v_exp_f32 v43, v43
  v_mfma_f32_16x16x32_bf16 v[56:59], a[108:111], a[44:47], v[56:59]
  v_cvt_pk_bf16_f32 v83, v42, v43
  v_xor_b32 v7, 0x4000, v7
  v_mfma_f32_16x16x32_bf16 v[60:63], a[80:83], a[48:51], v[28:31]
  v_exp_f32 v44, v44
  v_mfma_f32_16x16x32_bf16 v[60:63], a[84:87], a[52:55], v[60:63]
  v_xor_b32 v8, 0x4000, v8
  v_xor_b32 v9, 0x4000, v9
  v_mfma_f32_16x16x32_bf16 v[60:63], a[88:91], a[56:59], v[60:63]
  v_exp_f32 v45, v45
  v_mfma_f32_16x16x32_bf16 v[60:63], a[92:95], a[60:63], v[60:63]
  v_cvt_pk_bf16_f32 v88, v44, v45
  v_mfma_f32_16x16x32_bf16 v[64:67], a[96:99], a[48:51], v[28:31]
  v_exp_f32 v46, v46
  v_mfma_f32_16x16x32_bf16 v[64:67], a[100:103], a[52:55], v[64:67]
  v_mfma_f32_16x16x32_bf16 v[64:67], a[104:107], a[56:59], v[64:67]
  v_exp_f32 v47, v47
  v_mfma_f32_16x16x32_bf16 v[64:67], a[108:111], a[60:63], v[64:67]
  v_cvt_pk_bf16_f32 v89, v46, v47
  v_mfma_f32_16x16x32_bf16 v[68:71], a[80:83], a[64:67], v[32:35]
  v_exp_f32 v48, v48
  v_mfma_f32_16x16x32_bf16 v[68:71], a[84:87], a[68:71], v[68:71]
  v_mfma_f32_16x16x32_bf16 v[68:71], a[88:91], a[72:75], v[68:71]
  v_exp_f32 v49, v49
  v_mfma_f32_16x16x32_bf16 v[68:71], a[92:95], a[76:79], v[68:71]
  v_cvt_pk_bf16_f32 v90, v48, v49
  s_waitcnt vmcnt(10) lgkmcnt(0)
  v_mfma_f32_16x16x32_bf16 v[72:75], a[96:99], a[64:67], v[32:35]
  v_exp_f32 v50, v50
  v_mfma_f32_16x16x32_bf16 v[72:75], a[100:103], a[68:71], v[72:75]
  s_barrier
  v_mfma_f32_16x16x32_bf16 v[72:75], a[104:107], a[72:75], v[72:75]
  v_exp_f32 v51, v51
  v_mfma_f32_16x16x32_bf16 v[72:75], a[108:111], a[76:79], v[72:75]
  s_xor_b32 m0, m0, 0x2000
  v_cvt_pk_bf16_f32 v91, v50, v51
  v_mfma_f32_16x16x32_bf16 v[128:131], a[112:115], v[76:79], v[128:131]
  v_exp_f32 v52, v52
  v_mfma_f32_16x16x32_bf16 v[160:163], a[112:115], v[84:87], v[160:163]
  buffer_load_dwordx4 v10, s[16:19], s25 offen offset:0  lds
  v_mfma_f32_16x16x32_bf16 v[192:195], a[112:115], v[92:95], v[192:195]
  v_exp_f32 v53, v53
  v_mfma_f32_16x16x32_bf16 v[224:227], a[112:115], v[100:103], v[224:227]
  ds_read_b128 a[80:83], v4 offset:0
  v_cvt_pk_bf16_f32 v96, v52, v53
  v_mfma_f32_16x16x32_bf16 a[168:171], a[112:115], v[108:111], a[168:171]
  v_exp_f32 v54, v54
  v_mfma_f32_16x16x32_bf16 v[132:135], a[116:119], v[76:79], v[132:135]
  ds_read_b128 a[84:87], v5 offset:0
  ds_read_b128 a[88:91], v4 offset:1024
  v_mfma_f32_16x16x32_bf16 v[164:167], a[116:119], v[84:87], v[164:167]
  buffer_load_dwordx4 v11, s[16:19], s25 offen offset:1024  lds
  v_mfma_f32_16x16x32_bf16 v[196:199], a[116:119], v[92:95], v[196:199]
  v_exp_f32 v55, v55
  v_mfma_f32_16x16x32_bf16 v[228:231], a[116:119], v[100:103], v[228:231]
  ds_read_b128 a[92:95], v5 offset:1024
  v_cvt_pk_bf16_f32 v97, v54, v55
  v_mfma_f32_16x16x32_bf16 a[172:175], a[116:119], v[108:111], a[172:175]
  v_exp_f32 v56, v56
  v_mfma_f32_16x16x32_bf16 v[136:139], a[120:123], v[76:79], v[136:139]
  buffer_load_dwordx4 v12, s[16:19], s25 offen offset:2048  lds
  v_mfma_f32_16x16x32_bf16 v[168:171], a[120:123], v[84:87], v[168:171]
  v_exp_f32 v57, v57
  v_mfma_f32_16x16x32_bf16 v[200:203], a[120:123], v[92:95], v[200:203]
  ds_read_b128 a[96:99], v4 offset:4096
  v_cvt_pk_bf16_f32 v98, v56, v57
  v_mfma_f32_16x16x32_bf16 v[232:235], a[120:123], v[100:103], v[232:235]
  v_exp_f32 v58, v58
  v_mfma_f32_16x16x32_bf16 a[176:179], a[120:123], v[108:111], a[176:179]
  ds_read_b128 a[100:103], v5 offset:4096
  ds_read_b128 a[104:107], v4 offset:5120
  v_mfma_f32_16x16x32_bf16 v[140:143], a[124:127], v[76:79], v[140:143]
  v_exp_f32 v59, v59
  v_mfma_f32_16x16x32_bf16 v[172:175], a[124:127], v[84:87], v[172:175]
  ds_read_b128 a[108:111], v5 offset:5120
  v_cvt_pk_bf16_f32 v99, v58, v59
  v_mfma_f32_16x16x32_bf16 v[204:207], a[124:127], v[92:95], v[204:207]
  v_exp_f32 v60, v60
  v_mfma_f32_16x16x32_bf16 v[236:239], a[124:127], v[100:103], v[236:239]
  buffer_load_dwordx4 v13, s[16:19], s25 offen offset:3072  lds
  v_mfma_f32_16x16x32_bf16 a[180:183], a[124:127], v[108:111], a[180:183]
  v_exp_f32 v61, v61
  v_mfma_f32_16x16x32_bf16 v[144:147], a[128:131], v[76:79], v[144:147]
  s_add_u32 s25, s25, 8192
  v_cvt_pk_bf16_f32 v104, v60, v61
  v_mfma_f32_16x16x32_bf16 v[176:179], a[128:131], v[84:87], v[176:179]
  v_exp_f32 v62, v62
  v_mfma_f32_16x16x32_bf16 v[208:211], a[128:131], v[92:95], v[208:211]
  buffer_store_dwordx4 v[116:119], v14, s[20:23], s34 offen offset:1024 sc1
  v_mfma_f32_16x16x32_bf16 v[240:243], a[128:131], v[100:103], v[240:243]
  v_exp_f32 v63, v63
  v_mfma_f32_16x16x32_bf16 a[184:187], a[128:131], v[108:111], a[184:187]
  s_add_u32 s34, s34, s36
  v_cvt_pk_bf16_f32 v105, v62, v63
  v_mfma_f32_16x16x32_bf16 v[148:151], a[132:135], v[76:79], v[148:151]
  v_exp_f32 v64, v64
  v_mfma_f32_16x16x32_bf16 v[180:183], a[132:135], v[84:87], v[180:183]
  v_mfma_f32_16x16x32_bf16 v[212:215], a[132:135], v[92:95], v[212:215]
  v_exp_f32 v65, v65
  v_mfma_f32_16x16x32_bf16 v[244:247], a[132:135], v[100:103], v[244:247]
  v_cvt_pk_bf16_f32 v106, v64, v65
  v_mfma_f32_16x16x32_bf16 a[188:191], a[132:135], v[108:111], a[188:191]
  v_exp_f32 v66, v66
  v_mfma_f32_16x16x32_bf16 v[152:155], a[136:139], v[76:79], v[152:155]
  v_mfma_f32_16x16x32_bf16 v[184:187], a[136:139], v[84:87], v[184:187]
  v_exp_f32 v67, v67
  v_mfma_f32_16x16x32_bf16 v[216:219], a[136:139], v[92:95], v[216:219]
  v_cvt_pk_bf16_f32 v107, v66, v67
  v_mfma_f32_16x16x32_bf16 v[248:251], a[136:139], v[100:103], v[248:251]
  v_exp_f32 v68, v68
  v_mfma_f32_16x16x32_bf16 a[192:195], a[136:139], v[108:111], a[192:195]
  v_mfma_f32_16x16x32_bf16 v[156:159], a[140:143], v[76:79], v[156:159]
  v_exp_f32 v69, v69
  v_mfma_f32_16x16x32_bf16 v[188:191], a[140:143], v[84:87], v[188:191]
  v_cvt_pk_bf16_f32 v112, v68, v69
  v_mfma_f32_16x16x32_bf16 v[220:223], a[140:143], v[92:95], v[220:223]
  v_exp_f32 v70, v70
  v_mfma_f32_16x16x32_bf16 v[252:255], a[140:143], v[100:103], v[252:255]
  s_waitcnt lgkmcnt(0)
  v_mfma_f32_16x16x32_bf16 a[196:199], a[140:143], v[108:111], a[196:199]
  s_cmp_eq_u32 s25, s26
  s_cbranch_scc0 L_odd_r1b
  s_cmp_eq_u32 s26, s27
  s_cbranch_scc1 L_exit_r1b
  s_mov_b32 s26, s27
  s_mov_b32 s34, s83
  s_mov_b32 s36, 0
  s_mov_b32 s37, 0
  s_branch L_odd_r1b
L_exit_r1b:
  v_smfmac_f32_16x16x64_bf16 a[144:147], a[164:167], v[76:83], v1
  s_add_u32 s40, s30, 0
  s_add_u32 s41, s30, 4096
  v_smfmac_f32_16x16x64_bf16 a[148:151], a[164:167], v[84:91], v1
  v_lshrrev_b32 v2, 4, v0
  v_mul_u32_u24 v2, 272, v2
  v_smfmac_f32_16x16x64_bf16 a[152:155], a[164:167], v[92:99], v1
  v_and_b32 v3, 15, v0
  v_accvgpr_read_b32 v116, a144
  v_smfmac_f32_16x16x64_bf16 a[156:159], a[164:167], v[100:107], v1
  v_accvgpr_read_b32 v126, a145
  v_add_f32 v116, v116, v126
  v_cmp_nge_f32 vcc, s84, v116
  v_accvgpr_read_b32 v118, a148
  v_accvgpr_read_b32 v127, a149
  s_or_b64 s[98:99], s[98:99], vcc
  v_cmp_nle_f32 vcc, s94, v116
  v_rcp_f32 v116, v116
  v_add_f32 v118, v118, v127
  s_or_b64 s[98:99], s[98:99], vcc
  v_cmp_nge_f32 vcc, s84, v118
  v_accvgpr_read_b32 v120, a152
  v_accvgpr_read_b32 v126, a153
  s_or_b64 s[98:99], s[98:99], vcc
  v_cmp_nle_f32 vcc, s94, v118
  v_rcp_f32 v118, v118
  v_add_f32 v120, v120, v126
  s_or_b64 s[98:99], s[98:99], vcc
  v_mov_b32 v119, v118
  v_cmp_nge_f32 vcc, s84, v120
  v_accvgpr_read_b32 v122, a156
  v_accvgpr_read_b32 v127, a157
  s_or_b64 s[98:99], s[98:99], vcc
  v_cmp_nle_f32 vcc, s94, v120
  v_rcp_f32 v120, v120
  v_add_f32 v122, v122, v127
  s_or_b64 s[98:99], s[98:99], vcc
  v_mov_b32 v121, v120
  v_cmp_nge_f32 vcc, s84, v122
  v_lshl_add_u32 v2, v3, 4, v2
  v_add_u32 v2, s33, v2
  s_or_b64 s[98:99], s[98:99], vcc
  v_cmp_nle_f32 vcc, s94, v122
  v_rcp_f32 v122, v122
  ds_read_b64_tr_b16 a[112:113], v6 offset:0
  s_or_b64 s[98:99], s[98:99], vcc
  v_mov_b32 v123, v122
  ds_read_b64_tr_b16 a[114:115], v6 offset:4096
  ds_read_b64_tr_b16 a[116:117], v7 offset:0
  ds_read_b64_tr_b16 a[118:119], v7 offset:4096
  ds_read_b64_tr_b16 a[120:121], v8 offset:0
  ds_read_b64_tr_b16 a[122:123], v8 offset:4096
  ds_read_b64_tr_b16 a[124:125], v9 offset:0
  ds_read_b64_tr_b16 a[126:127], v9 offset:4096
  ds_read_b64_tr_b16 a[128:129], v6 offset:1024
  ds_read_b64_tr_b16 a[130:131], v6 offset:5120
  ds_read_b64_tr_b16 a[132:133], v7 offset:1024
  ds_read_b64_tr_b16 a[134:135], v7 offset:5120
  ds_read_b64_tr_b16 a[136:137], v8 offset:1024
  ds_read_b64_tr_b16 a[138:139], v8 offset:5120
  ds_read_b64_tr_b16 a[140:141], v9 offset:1024
  ds_read_b64_tr_b16 a[142:143], v9 offset:5120
  v_exp_f32 v71, v71
  v_exp_f32 v72, v72
  v_exp_f32 v73, v73
  v_exp_f32 v74, v74
  v_exp_f32 v75, v75
  v_cvt_pk_bf16_f32 v113, v70, v71
  v_cvt_pk_bf16_f32 v114, v72, v73
  v_cvt_pk_bf16_f32 v115, v74, v75
  s_waitcnt lgkmcnt(14)
  v_mfma_f32_16x16x32_bf16 v[128:131], a[112:115], v[80:83], v[128:131]
  s_waitcnt lgkmcnt(12)
  v_mfma_f32_16x16x32_bf16 v[132:135], a[116:119], v[80:83], v[132:135]
  s_waitcnt lgkmcnt(10)
  v_mfma_f32_16x16x32_bf16 v[136:139], a[120:123], v[80:83], v[136:139]
  s_nop 0
  v_mul_f32 v128, v128, v116
  s_waitcnt lgkmcnt(8)
  v_mfma_f32_16x16x32_bf16 v[140:143], a[124:127], v[80:83], v[140:143]
  v_mul_f32 v129, v129, v116
  v_mul_f32 v130, v130, v116
  s_waitcnt lgkmcnt(6)
  v_mfma_f32_16x16x32_bf16 v[144:147], a[128:131], v[80:83], v[144:147]
  v_mul_f32 v131, v131, v116
  v_mul_f32 v132, v132, v116
  s_waitcnt lgkmcnt(4)
  v_mfma_f32_16x16x32_bf16 v[148:151], a[132:135], v[80:83], v[148:151]
  v_mul_f32 v133, v133, v116
  v_cvt_pk_bf16_f32 v128, v128, v129
  s_waitcnt lgkmcnt(2)
  v_mfma_f32_16x16x32_bf16 v[152:155], a[136:139], v[80:83], v[152:155]
  v_mul_f32 v134, v134, v116
  v_mul_f32 v135, v135, v116
  v_smfmac_f32_16x16x64_bf16 a[160:163], a[164:167], v[108:115], v1
  v_mul_f32 v136, v136, v116
  v_mul_f32 v137, v137, v116
  s_waitcnt lgkmcnt(0)
  v_mfma_f32_16x16x32_bf16 v[156:159], a[140:143], v[80:83], v[156:159]
  v_cvt_pk_bf16_f32 v129, v130, v131
  v_cvt_pk_bf16_f32 v132, v132, v133
  v_mfma_f32_16x16x32_bf16 v[160:163], a[112:115], v[88:91], v[160:163]
  v_mul_f32 v138, v138, v116
  v_mul_f32 v139, v139, v116
  v_mfma_f32_16x16x32_bf16 v[164:167], a[116:119], v[88:91], v[164:167]
  v_mul_f32 v140, v140, v116
  v_mul_f32 v141, v141, v116
  v_mfma_f32_16x16x32_bf16 v[168:171], a[120:123], v[88:91], v[168:171]
  v_cvt_pk_bf16_f32 v133, v134, v135
  v_cvt_pk_bf16_f32 v136, v136, v137
  v_mfma_f32_16x16x32_bf16 v[172:175], a[124:127], v[88:91], v[172:175]
  ds_write_b64 v15, v[128:129] offset:0
  v_mfma_f32_16x16x32_bf16 v[176:179], a[128:131], v[88:91], v[176:179]
  v_mul_f32 v142, v142, v116
  v_mul_f32 v143, v143, v116
  v_mfma_f32_16x16x32_bf16 v[180:183], a[132:135], v[88:91], v[180:183]
  v_mul_f32 v144, v144, v116
  v_mul_f32 v145, v145, v116
  v_mfma_f32_16x16x32_bf16 v[184:187], a[136:139], v[88:91], v[184:187]
  v_cvt_pk_bf16_f32 v137, v138, v139
  v_cvt_pk_bf16_f32 v140, v140, v141
  v_mfma_f32_16x16x32_bf16 v[192:195], a[112:115], v[96:99], v[192:195]
  ds_write_b64 v15, v[132:133] offset:32
  v_mfma_f32_16x16x32_bf16 a[168:171], a[112:115], v[112:115], a[168:171]
  v_mul_f32 v146, v146, v116
  v_mul_f32 v147, v147, v116
  v_mfma_f32_16x16x32_bf16 v[188:191], a[140:143], v[88:91], v[188:191]
  v_mul_f32 v148, v148, v116
  v_mul_f32 v149, v149, v116
  v_mfma_f32_16x16x32_bf16 v[196:199], a[116:119], v[96:99], v[196:199]
  v_cvt_pk_bf16_f32 v141, v142, v143
  v_cvt_pk_bf16_f32 v144, v144, v145
  v_mfma_f32_16x16x32_bf16 a[172:175], a[116:119], v[112:115], a[172:175]
  ds_write_b64 v15, v[136:137] offset:64
  v_mfma_f32_16x16x32_bf16 v[200:203], a[120:123], v[96:99], v[200:203]
  v_mul_f32 v150, v150, v116
  v_mul_f32 v151, v151, v116
  v_mfma_f32_16x16x32_bf16 v[204:207], a[124:127], v[96:99], v[204:207]
  v_mul_f32 v152, v152, v116
  v_mul_f32 v153, v153, v116
  v_mfma_f32_16x16x32_bf16 v[208:211], a[128:131], v[96:99], v[208:211]
  v_cvt_pk_bf16_f32 v145, v146, v147
  v_cvt_pk_bf16_f32 v148, v148, v149
  v_mfma_f32_16x16x32_bf16 v[212:215], a[132:135], v[96:99], v[212:215]
  ds_write_b64 v15, v[140:141] offset:96
  v_mfma_f32_16x16x32_bf16 v[216:219], a[136:139], v[96:99], v[216:219]
  v_mul_f32 v154, v154, v116
  v_mul_f32 v155, v155, v116
  v_mfma_f32_16x16x32_bf16 a[176:179], a[120:123], v[112:115], a[176:179]
  v_mul_f32 v156, v156, v116
  v_mul_f32 v157, v157, v116
  v_mfma_f32_16x16x32_bf16 a[180:183], a[124:127], v[112:115], a[180:183]
  v_cvt_pk_bf16_f32 v149, v150, v151
  v_cvt_pk_bf16_f32 v152, v152, v153
  v_mfma_f32_16x16x32_bf16 a[184:187], a[128:131], v[112:115], a[184:187]
  ds_write_b64 v15, v[144:145] offset:128
  v_mfma_f32_16x16x32_bf16 a[188:191], a[132:135], v[112:115], a[188:191]
  v_mul_f32 v158, v158, v116
  v_mul_f32 v159, v159, v116
  v_mfma_f32_16x16x32_bf16 a[192:195], a[136:139], v[112:115], a[192:195]
  v_cvt_pk_bf16_f32 v153, v154, v155
  v_cvt_pk_bf16_f32 v156, v156, v157
  v_mfma_f32_16x16x32_bf16 a[196:199], a[140:143], v[112:115], a[196:199]
  ds_write_b64 v15, v[148:149] offset:160
  v_mfma_f32_16x16x32_bf16 v[220:223], a[140:143], v[96:99], v[220:223]
  v_cvt_pk_bf16_f32 v157, v158, v159
  ds_write_b64 v15, v[152:153] offset:192
  v_mfma_f32_16x16x32_bf16 v[224:227], a[112:115], v[104:107], v[224:227]
  ds_write_b64 v15, v[156:157] offset:224
  v_mfma_f32_16x16x32_bf16 v[228:231], a[116:119], v[104:107], v[228:231]
  ds_read_b128 v[36:39], v2 offset:0
  ds_read_b128 v[40:43], v2 offset:1088
  v_mfma_f32_16x16x32_bf16 v[232:235], a[120:123], v[104:107], v[232:235]
  ds_read_b128 v[44:47], v2 offset:2176
  ds_read_b128 v[48:51], v2 offset:3264
  v_mfma_f32_16x16x32_bf16 v[236:239], a[124:127], v[104:107], v[236:239]
  v_accvgpr_read_b32 v124, a160
  v_accvgpr_read_b32 v126, a161
  v_mfma_f32_16x16x32_bf16 v[240:243], a[128:131], v[104:107], v[240:243]
  v_add_f32 v124, v124, v126
  v_cmp_nge_f32 vcc, s84, v124
  v_mfma_f32_16x16x32_bf16 v[244:247], a[132:135], v[104:107], v[244:247]
  v_accvgpr_read_b32 v108, a168
  s_or_b64 s[98:99], s[98:99], vcc
  v_mfma_f32_16x16x32_bf16 v[248:251], a[136:139], v[104:107], v[248:251]
  v_cmp_nle_f32 vcc, s94, v124
  v_rcp_f32 v124, v124
  v_mfma_f32_16x16x32_bf16 v[252:255], a[140:143], v[104:107], v[252:255]
  v_mov_b32 v125, v124
  v_accvgpr_read_b32 v109, a169
  v_accvgpr_read_b32 v110, a170
  s_waitcnt lgkmcnt(3)
  buffer_store_dwordx4 v[36:39], v14, s[20:23], s40 offen offset:0 sc1
  s_waitcnt lgkmcnt(2)
  buffer_store_dwordx4 v[40:43], v14, s[20:23], s40 offen offset:1024 sc1
  s_waitcnt lgkmcnt(1)
  buffer_store_dwordx4 v[44:47], v14, s[20:23], s40 offen offset:2048 sc1
  s_waitcnt lgkmcnt(0)
  buffer_store_dwordx4 v[48:51], v14, s[20:23], s40 offen offset:3072 sc1
  v_pk_mul_f32 v[160:161], v[160:161], v[118:119]
  v_pk_mul_f32 v[162:163], v[162:163], v[118:119]
  v_pk_mul_f32 v[164:165], v[164:165], v[118:119]
  v_cvt_pk_bf16_f32 v160, v160, v161
  v_pk_mul_f32 v[166:167], v[166:167], v[118:119]
  v_pk_mul_f32 v[168:169], v[168:169], v[118:119]
  v_cvt_pk_bf16_f32 v161, v162, v163
  v_cvt_pk_bf16_f32 v164, v164, v165
  v_pk_mul_f32 v[170:171], v[170:171], v[118:119]
  v_pk_mul_f32 v[172:173], v[172:173], v[118:119]
  v_cvt_pk_bf16_f32 v165, v166, v167
  v_cvt_pk_bf16_f32 v168, v168, v169
  v_pk_mul_f32 v[174:175], v[174:175], v[118:119]
  v_pk_mul_f32 v[176:177], v[176:177], v[118:119]
  v_cvt_pk_bf16_f32 v169, v170, v171
  v_cvt_pk_bf16_f32 v172, v172, v173
  v_pk_mul_f32 v[178:179], v[178:179], v[118:119]
  v_pk_mul_f32 v[180:181], v[180:181], v[118:119]
  v_cvt_pk_bf16_f32 v173, v174, v175
  v_cvt_pk_bf16_f32 v176, v176, v177
  v_pk_mul_f32 v[182:183], v[182:183], v[118:119]
  v_pk_mul_f32 v[184:185], v[184:185], v[118:119]
  v_cvt_pk_bf16_f32 v177, v178, v179
  v_cvt_pk_bf16_f32 v180, v180, v181
  v_pk_mul_f32 v[186:187], v[186:187], v[118:119]
  v_pk_mul_f32 v[188:189], v[188:189], v[118:119]
  v_cvt_pk_bf16_f32 v181, v182, v183
  v_cvt_pk_bf16_f32 v184, v184, v185
  v_pk_mul_f32 v[190:191], v[190:191], v[118:119]
  v_cvt_pk_bf16_f32 v185, v186, v187
  v_cvt_pk_bf16_f32 v188, v188, v189
  v_cvt_pk_bf16_f32 v189, v190, v191
  ds_write_b64 v15, v[160:161] offset:4352
  ds_write_b64 v15, v[164:165] offset:4384
  ds_write_b64 v15, v[168:169] offset:4416
  ds_write_b64 v15, v[172:173] offset:4448
  ds_write_b64 v15, v[176:177] offset:4480
  ds_write_b64 v15, v[180:181] offset:4512
  ds_write_b64 v15, v[184:185] offset:4544
  ds_write_b64 v15, v[188:189] offset:4576
  ds_read_b128 v[52:55], v2 offset:4352
  ds_read_b128 v[56:59], v2 offset:5440
  ds_read_b128 v[60:63], v2 offset:6528
  ds_read_b128 v[64:67], v2 offset:7616
  v_pk_mul_f32 v[192:193], v[192:193], v[120:121]
  v_pk_mul_f32 v[194:195], v[194:195], v[120:121]
  v_pk_mul_f32 v[196:197], v[196:197], v[120:121]
  v_cvt_pk_bf16_f32 v192, v192, v193
  v_pk_mul_f32 v[198:199], v[198:199], v[120:121]
  v_pk_mul_f32 v[200:201], v[200:201], v[120:121]
  v_cvt_pk_bf16_f32 v193, v194, v195
  v_cvt_pk_bf16_f32 v196, v196, v197
  v_pk_mul_f32 v[202:203], v[202:203], v[120:121]
  v_pk_mul_f32 v[204:205], v[204:205], v[120:121]
  v_cvt_pk_bf16_f32 v197, v198, v199
  v_cvt_pk_bf16_f32 v200, v200, v201
  v_pk_mul_f32 v[206:207], v[206:207], v[120:121]
  v_pk_mul_f32 v[208:209], v[208:209], v[120:121]
  v_cvt_pk_bf16_f32 v201, v202, v203
  v_cvt_pk_bf16_f32 v204, v204, v205
  v_pk_mul_f32 v[210:211], v[210:211], v[120:121]
  v_pk_mul_f32 v[212:213], v[212:213], v[120:121]
  v_cvt_pk_bf16_f32 v205, v206, v207
  v_cvt_pk_bf16_f32 v208, v208, v209
  v_pk_mul_f32 v[214:215], v[214:215], v[120:121]
  v_pk_mul_f32 v[216:217], v[216:217], v[120:121]
  v_cvt_pk_bf16_f32 v209, v210, v211
  v_cvt_pk_bf16_f32 v212, v212, v213
  s_waitcnt lgkmcnt(3)
  buffer_store_dwordx4 v[52:55], v14, s[20:23], s41 offen offset:0 sc1
  s_waitcnt lgkmcnt(2)
  buffer_store_dwordx4 v[56:59], v14, s[20:23], s41 offen offset:1024 sc1
  s_waitcnt lgkmcnt(1)
  buffer_store_dwordx4 v[60:63], v14, s[20:23], s41 offen offset:2048 sc1
  s_waitcnt lgkmcnt(0)
  buffer_store_dwordx4 v[64:67], v14, s[20:23], s41 offen offset:3072 sc1
  ds_write_b64 v15, v[192:193] offset:8704
  ds_write_b64 v15, v[196:197] offset:8736
  ds_write_b64 v15, v[200:201] offset:8768
  ds_write_b64 v15, v[204:205] offset:8800
  v_pk_mul_f32 v[218:219], v[218:219], v[120:121]
  v_pk_mul_f32 v[220:221], v[220:221], v[120:121]
  v_cvt_pk_bf16_f32 v213, v214, v215
  v_cvt_pk_bf16_f32 v216, v216, v217
  v_pk_mul_f32 v[222:223], v[222:223], v[120:121]
  v_cvt_pk_bf16_f32 v217, v218, v219
  v_cvt_pk_bf16_f32 v220, v220, v221
  v_cvt_pk_bf16_f32 v221, v222, v223
  s_add_u32 s40, s30, 8192
  ds_write_b64 v15, v[208:209] offset:8832
  ds_write_b64 v15, v[212:213] offset:8864
  ds_write_b64 v15, v[216:217] offset:8896
  ds_write_b64 v15, v[220:221] offset:8928
  ds_read_b128 v[36:39], v2 offset:8704
  ds_read_b128 v[40:43], v2 offset:9792
  ds_read_b128 v[44:47], v2 offset:10880
  ds_read_b128 v[48:51], v2 offset:11968
  v_pk_mul_f32 v[224:225], v[224:225], v[122:123]
  v_pk_mul_f32 v[226:227], v[226:227], v[122:123]
  v_pk_mul_f32 v[228:229], v[228:229], v[122:123]
  v_cvt_pk_bf16_f32 v224, v224, v225
  v_pk_mul_f32 v[230:231], v[230:231], v[122:123]
  v_pk_mul_f32 v[232:233], v[232:233], v[122:123]
  v_cvt_pk_bf16_f32 v225, v226, v227
  v_cvt_pk_bf16_f32 v228, v228, v229
  v_pk_mul_f32 v[234:235], v[234:235], v[122:123]
  v_pk_mul_f32 v[236:237], v[236:237], v[122:123]
  v_cvt_pk_bf16_f32 v229, v230, v231
  v_cvt_pk_bf16_f32 v232, v232, v233
  v_pk_mul_f32 v[238:239], v[238:239], v[122:123]
  v_pk_mul_f32 v[240:241], v[240:241], v[122:123]
  v_cvt_pk_bf16_f32 v233, v234, v235
  v_cvt_pk_bf16_f32 v236, v236, v237
  v_pk_mul_f32 v[242:243], v[242:243], v[122:123]
  v_pk_mul_f32 v[244:245], v[244:245], v[122:123]
  v_cvt_pk_bf16_f32 v237, v238, v239
  v_cvt_pk_bf16_f32 v240, v240, v241
  v_pk_mul_f32 v[246:247], v[246:247], v[122:123]
  v_pk_mul_f32 v[248:249], v[248:249], v[122:123]
  v_cvt_pk_bf16_f32 v241, v242, v243
  v_cvt_pk_bf16_f32 v244, v244, v245
  s_waitcnt lgkmcnt(3)
  buffer_store_dwordx4 v[36:39], v14, s[20:23], s40 offen offset:0 sc1
  s_waitcnt lgkmcnt(2)
  buffer_store_dwordx4 v[40:43], v14, s[20:23], s40 offen offset:1024 sc1
  s_waitcnt lgkmcnt(1)
  buffer_store_dwordx4 v[44:47], v14, s[20:23], s40 offen offset:2048 sc1
  s_waitcnt lgkmcnt(0)
  buffer_store_dwordx4 v[48:51], v14, s[20:23], s40 offen offset:3072 sc1
  ds_write_b64 v15, v[224:225] offset:13056
  ds_write_b64 v15, v[228:229] offset:13088
  ds_write_b64 v15, v[232:233] offset:13120
  ds_write_b64 v15, v[236:237] offset:13152
  v_pk_mul_f32 v[250:251], v[250:251], v[122:123]
  v_pk_mul_f32 v[252:253], v[252:253], v[122:123]
  v_cvt_pk_bf16_f32 v245, v246, v247
  v_cvt_pk_bf16_f32 v248, v248, v249
  v_pk_mul_f32 v[254:255], v[254:255], v[122:123]
  v_cvt_pk_bf16_f32 v249, v250, v251
  v_cvt_pk_bf16_f32 v252, v252, v253
  v_cvt_pk_bf16_f32 v253, v254, v255
  s_add_u32 s41, s30, 12288
  ds_write_b64 v15, v[240:241] offset:13184
  ds_write_b64 v15, v[244:245] offset:13216
  ds_write_b64 v15, v[248:249] offset:13248
  ds_write_b64 v15, v[252:253] offset:13280
  ds_read_b128 v[52:55], v2 offset:13056
  ds_read_b128 v[56:59], v2 offset:14144
  ds_read_b128 v[60:63], v2 offset:15232
  ds_read_b128 v[64:67], v2 offset:16320
  v_accvgpr_read_b32 v111, a171
  v_accvgpr_read_b32 v112, a172
  v_accvgpr_read_b32 v113, a173
  v_pk_mul_f32 v[108:109], v[108:109], v[124:125]
  v_accvgpr_read_b32 v114, a174
  v_accvgpr_read_b32 v115, a175
  v_pk_mul_f32 v[110:111], v[110:111], v[124:125]
  v_pk_mul_f32 v[112:113], v[112:113], v[124:125]
  v_cvt_pk_bf16_f32 v108, v108, v109
  v_pk_mul_f32 v[114:115], v[114:115], v[124:125]
  v_cvt_pk_bf16_f32 v109, v110, v111
  v_cvt_pk_bf16_f32 v112, v112, v113
  v_cvt_pk_bf16_f32 v113, v114, v115
  v_accvgpr_read_b32 v110, a178
  v_accvgpr_read_b32 v111, a179
  v_accvgpr_read_b32 v114, a182
  v_accvgpr_read_b32 v115, a183
  v_pk_mul_f32 v[110:111], v[110:111], v[124:125]
  v_pk_mul_f32 v[114:115], v[114:115], v[124:125]
  s_add_u32 s40, s30, 16384
  ds_write_b64 v15, v[108:109] offset:17408
  ds_write_b64 v15, v[112:113] offset:17440
  s_waitcnt lgkmcnt(5)
  buffer_store_dwordx4 v[52:55], v14, s[20:23], s41 offen offset:0 sc1
  s_waitcnt lgkmcnt(4)
  buffer_store_dwordx4 v[56:59], v14, s[20:23], s41 offen offset:1024 sc1
  s_waitcnt lgkmcnt(3)
  buffer_store_dwordx4 v[60:63], v14, s[20:23], s41 offen offset:2048 sc1
  s_waitcnt lgkmcnt(2)
  buffer_store_dwordx4 v[64:67], v14, s[20:23], s41 offen offset:3072 sc1
  v_accvgpr_read_b32 v108, a176
  v_accvgpr_read_b32 v109, a177
  v_accvgpr_read_b32 v112, a180
  v_accvgpr_read_b32 v113, a181
  v_pk_mul_f32 v[108:109], v[108:109], v[124:125]
  v_pk_mul_f32 v[112:113], v[112:113], v[124:125]
  v_cvt_pk_bf16_f32 v108, v108, v109
  v_cvt_pk_bf16_f32 v109, v110, v111
  v_cvt_pk_bf16_f32 v112, v112, v113
  v_cvt_pk_bf16_f32 v113, v114, v115
  v_accvgpr_read_b32 v110, a186
  v_accvgpr_read_b32 v111, a187
  v_accvgpr_read_b32 v114, a190
  v_accvgpr_read_b32 v115, a191
  v_pk_mul_f32 v[110:111], v[110:111], v[124:125]
  v_pk_mul_f32 v[114:115], v[114:115], v[124:125]
  s_or_b64 s[98:99], s[98:99], vcc
  ds_write_b64 v15, v[108:109] offset:17472
  ds_write_b64 v15, v[112:113] offset:17504
  v_accvgpr_read_b32 v108, a184
  v_accvgpr_read_b32 v109, a185
  v_accvgpr_read_b32 v112, a188
  v_accvgpr_read_b32 v113, a189
  v_pk_mul_f32 v[108:109], v[108:109], v[124:125]
  v_pk_mul_f32 v[112:113], v[112:113], v[124:125]
  v_cvt_pk_bf16_f32 v108, v108, v109
  v_cvt_pk_bf16_f32 v109, v110, v111
  v_cvt_pk_bf16_f32 v112, v112, v113
  v_cvt_pk_bf16_f32 v113, v114, v115
  v_accvgpr_read_b32 v110, a194
  v_accvgpr_read_b32 v111, a195
  v_accvgpr_read_b32 v114, a198
  v_accvgpr_read_b32 v115, a199
  v_pk_mul_f32 v[110:111], v[110:111], v[124:125]
  v_pk_mul_f32 v[114:115], v[114:115], v[124:125]
  ds_write_b64 v15, v[108:109] offset:17536
  ds_write_b64 v15, v[112:113] offset:17568
  v_accvgpr_read_b32 v108, a192
  v_accvgpr_read_b32 v109, a193
  v_accvgpr_read_b32 v112, a196
  v_accvgpr_read_b32 v113, a197
  v_pk_mul_f32 v[108:109], v[108:109], v[124:125]
  v_pk_mul_f32 v[112:113], v[112:113], v[124:125]
  v_cvt_pk_bf16_f32 v108, v108, v109
  v_cvt_pk_bf16_f32 v109, v110, v111
  v_cvt_pk_bf16_f32 v112, v112, v113
  v_cvt_pk_bf16_f32 v113, v114, v115
  ds_write_b64 v15, v[108:109] offset:17600
  ds_write_b64 v15, v[112:113] offset:17632
  ds_read_b128 v[36:39], v2 offset:17408
  ds_read_b128 v[40:43], v2 offset:18496
  ds_read_b128 v[44:47], v2 offset:19584
  ds_read_b128 v[48:51], v2 offset:20672
  s_waitcnt lgkmcnt(3)
  buffer_store_dwordx4 v[36:39], v14, s[20:23], s40 offen offset:0 sc1
  s_waitcnt lgkmcnt(2)
  buffer_store_dwordx4 v[40:43], v14, s[20:23], s40 offen offset:1024 sc1
  s_waitcnt lgkmcnt(1)
  buffer_store_dwordx4 v[44:47], v14, s[20:23], s40 offen offset:2048 sc1
  s_waitcnt lgkmcnt(0)
  buffer_store_dwordx4 v[48:51], v14, s[20:23], s40 offen offset:3072 sc1
  s_branch L_done
L_done:
  s_cmp_lg_u64 s[96:97], 0
  s_cbranch_scc0 L_slow_ret0
  s_sub_u32 s43, 5, s82
  s_mov_b32 s72, s95
  s_sub_u32 s73, s29, 1
  s_mov_b32 s77, 0
  s_branch L_slow
L_slow_ret0:
  s_cmp_lg_u64 s[98:99], 0
  s_cbranch_scc0 L_slow_ret1
  s_add_u32 s43, 4, s82
  s_mov_b32 s72, s30
  s_mov_b32 s73, s29
  s_mov_b32 s77, 1
  s_branch L_slow
L_slow_ret1:
L_exit:
  s_endpgm
L_slow:
  s_waitcnt vmcnt(0) lgkmcnt(0)
  s_mov_b32 s64, s6
  s_mov_b32 s65, s7
  s_mov_b32 s66, 67108864
  s_mov_b32 s67, 0x00020000
  s_mov_b32 s68, s8
  s_mov_b32 s69, s9
  s_mov_b32 s70, 67108864
  s_mov_b32 s71, 0x00020000
  s_mul_i32 s73, s73, 262144
  v_and_b32 v2, 15, v0
  v_lshrrev_b32 v3, 4, v0
  v_lshlrev_b32 v4, 8, v2
  v_lshl_add_u32 v4, v3, 4, v4
  v_lshlrev_b32 v5, 8, v2
  v_and_b32 v10, 1, v3
  v_lshl_add_u32 v5, v10, 5, v5
  v_lshrrev_b32 v10, 1, v3
  v_lshl_add_u32 v5, v10, 4, v5
  v_lshrrev_b32 v10, 3, v0
  v_and_b32 v11, 7, v0
  v_bfe_u32 v12, v10, 1, 2
  v_lshlrev_b32 v12, 1, v12
  v_xor_b32 v11, v11, v12
  v_lshlrev_b32 v11, 4, v11
  v_lshl_add_u32 v10, v10, 8, v11
  v_and_b32 v160, 0xfff, v6
  v_add_u32 v160, s33, v160
  v_and_b32 v161, 0xfff, v7
  v_add_u32 v161, s33, v161
  v_and_b32 v162, 0xfff, v8
  v_add_u32 v162, s33, v162
  v_and_b32 v163, 0xfff, v9
  v_add_u32 v163, s33, v163
  v_mov_b32 v116, 0x3f803f80
  v_mov_b32 v117, v116
  v_mov_b32 v118, v116
  v_mov_b32 v119, v116
L_slow_tile:
  buffer_load_dwordx4 v[16:19], v4, s[12:15], s72 offen offset:0
  buffer_load_dwordx4 v[20:23], v4, s[12:15], s72 offen offset:64
  buffer_load_dwordx4 v[24:27], v4, s[12:15], s72 offen offset:128
  buffer_load_dwordx4 v[28:31], v4, s[12:15], s72 offen offset:192
  s_waitcnt vmcnt(0)
  v_lshlrev_b32 v120, 16, v16
  v_and_b32 v121, 0xffff0000, v16
  v_mul_f32 v120, s44, v120
  v_mul_f32 v121, s44, v121
  v_cvt_pk_bf16_f32 v16, v120, v121
  v_lshlrev_b32 v120, 16, v17
  v_and_b32 v121, 0xffff0000, v17
  v_mul_f32 v120, s44, v120
  v_mul_f32 v121, s44, v121
  v_cvt_pk_bf16_f32 v17, v120, v121
  v_lshlrev_b32 v120, 16, v18
  v_and_b32 v121, 0xffff0000, v18
  v_mul_f32 v120, s44, v120
  v_mul_f32 v121, s44, v121
  v_cvt_pk_bf16_f32 v18, v120, v121
  v_lshlrev_b32 v120, 16, v19
  v_and_b32 v121, 0xffff0000, v19
  v_mul_f32 v120, s44, v120
  v_mul_f32 v121, s44, v121
  v_cvt_pk_bf16_f32 v19, v120, v121
  v_lshlrev_b32 v120, 16, v20
  v_and_b32 v121, 0xffff0000, v20
  v_mul_f32 v120, s44, v120
  v_mul_f32 v121, s44, v121
  v_cvt_pk_bf16_f32 v20, v120, v121
  v_lshlrev_b32 v120, 16, v21
  v_and_b32 v121, 0xffff0000, v21
  v_mul_f32 v120, s44, v120
  v_mul_f32 v121, s44, v121
  v_cvt_pk_bf16_f32 v21, v120, v121
  v_lshlrev_b32 v120, 16, v22
  v_and_b32 v121, 0xffff0000, v22
  v_mul_f32 v120, s44, v120
  v_mul_f32 v121, s44, v121
  v_cvt_pk_bf16_f32 v22, v120, v121
  v_lshlrev_b32 v120, 16, v23
  v_and_b32 v121, 0xffff0000, v23
  v_mul_f32 v120, s44, v120
  v_mul_f32 v121, s44, v121
  v_cvt_pk_bf16_f32 v23, v120, v121
  v_lshlrev_b32 v120, 16, v24
  v_and_b32 v121, 0xffff0000, v24
  v_mul_f32 v120, s44, v120
  v_mul_f32 v121, s44, v121
  v_cvt_pk_bf16_f32 v24, v120, v121
  v_lshlrev_b32 v120, 16, v25
  v_and_b32 v121, 0xffff0000, v25
  v_mul_f32 v120, s44, v120
  v_mul_f32 v121, s44, v121
  v_cvt_pk_bf16_f32 v25, v120, v121
  v_lshlrev_b32 v120, 16, v26
  v_and_b32 v121, 0xffff0000, v26
  v_mul_f32 v120, s44, v120
  v_mul_f32 v121, s44, v121
  v_cvt_pk_bf16_f32 v26, v120, v121
  v_lshlrev_b32 v120, 16, v27
  v_and_b32 v121, 0xffff0000, v27
  v_mul_f32 v120, s44, v120
  v_mul_f32 v121, s44, v121
  v_cvt_pk_bf16_f32 v27, v120, v121
  v_lshlrev_b32 v120, 16, v28
  v_and_b32 v121, 0xffff0000, v28
  v_mul_f32 v120, s44, v120
  v_mul_f32 v121, s44, v121
  v_cvt_pk_bf16_f32 v28, v120, v121
  v_lshlrev_b32 v120, 16, v29
  v_and_b32 v121, 0xffff0000, v29
  v_mul_f32 v120, s44, v120
  v_mul_f32 v121, s44, v121
  v_cvt_pk_bf16_f32 v29, v120, v121
  v_lshlrev_b32 v120, 16, v30
  v_and_b32 v121, 0xffff0000, v30
  v_mul_f32 v120, s44, v120
  v_mul_f32 v121, s44, v121
  v_cvt_pk_bf16_f32 v30, v120, v121
  v_lshlrev_b32 v120, 16, v31
  v_and_b32 v121, 0xffff0000, v31
  v_mul_f32 v120, s44, v120
  v_mul_f32 v121, s44, v121
  v_cvt_pk_bf16_f32 v31, v120, v121
  v_mov_b32 v76, 0xff800000
  s_mov_b32 s74, s73
  s_mov_b32 s75, 64
L_slow_max:
  buffer_load_dwordx4 v[32:35], v4, s[64:67], s74 offen offset:0
  buffer_load_dwordx4 v[36:39], v4, s[64:67], s74 offen offset:64
  buffer_load_dwordx4 v[40:43], v4, s[64:67], s74 offen offset:128
  buffer_load_dwordx4 v[44:47], v4, s[64:67], s74 offen offset:192
  s_waitcnt vmcnt(0)
  v_mfma_f32_16x16x32_bf16 v[64:67], v[32:35], v[16:19], 0
  v_mfma_f32_16x16x32_bf16 v[64:67], v[36:39], v[20:23], v[64:67]
  v_mfma_f32_16x16x32_bf16 v[64:67], v[40:43], v[24:27], v[64:67]
  v_mfma_f32_16x16x32_bf16 v[64:67], v[44:47], v[28:31], v[64:67]
  s_nop 7
  s_nop 3
  v_max3_f32 v76, v76, v64, v65
  v_max3_f32 v76, v76, v66, v67
  s_add_u32 s74, s74, 4096
  s_sub_u32 s75, s75, 1
  s_cmp_lg_u32 s75, 0
  s_cbranch_scc1 L_slow_max
  v_mov_b32 v77, v76
  s_nop 1
  v_permlane32_swap_b32 v76, v77
  s_nop 1
  v_max_f32 v76, v76, v77
  v_mov_b32 v77, v76
  s_nop 1
  v_permlane16_swap_b32 v76, v77
  s_nop 1
  v_max_f32 v76, v76, v77
  v_sub_f32 v79, 0, v76
  v_sub_f32 v78, 0, v76
  v_sub_f32 v77, 0, v76
  v_sub_f32 v76, 0, v76
  v_mov_b32 v128, 0
  v_mov_b32 v129, 0
  v_mov_b32 v130, 0
  v_mov_b32 v131, 0
  v_mov_b32 v132, 0
  v_mov_b32 v133, 0
  v_mov_b32 v134, 0
  v_mov_b32 v135, 0
  v_mov_b32 v136, 0
  v_mov_b32 v137, 0
  v_mov_b32 v138, 0
  v_mov_b32 v139, 0
  v_mov_b32 v140, 0
  v_mov_b32 v141, 0
  v_mov_b32 v142, 0
  v_mov_b32 v143, 0
  v_mov_b32 v144, 0
  v_mov_b32 v145, 0
  v_mov_b32 v146, 0
  v_mov_b32 v147, 0
  v_mov_b32 v148, 0
  v_mov_b32 v149, 0
  v_mov_b32 v150, 0
  v_mov_b32 v151, 0
  v_mov_b32 v152, 0
  v_mov_b32 v153, 0
  v_mov_b32 v154, 0
  v_mov_b32 v155, 0
  v_mov_b32 v156, 0
  v_mov_b32 v157, 0
  v_mov_b32 v158, 0
  v_mov_b32 v159, 0
  v_mov_b32 v112, 0
  v_mov_b32 v113, 0
  v_mov_b32 v114, 0
  v_mov_b32 v115, 0
  s_mov_b32 s74, s73
  s_mov_b32 s75, 32
L_slow_pv:
  s_add_u32 s76, s74, 0
  buffer_load_dwordx4 v[32:35], v4, s[64:67], s76 offen offset:0
  buffer_load_dwordx4 v[36:39], v4, s[64:67], s76 offen offset:64
  buffer_load_dwordx4 v[40:43], v4, s[64:67], s76 offen offset:128
  buffer_load_dwordx4 v[44:47], v4, s[64:67], s76 offen offset:192
  s_add_u32 s76, s74, 4096
  buffer_load_dwordx4 v[48:51], v4, s[64:67], s76 offen offset:0
  buffer_load_dwordx4 v[52:55], v4, s[64:67], s76 offen offset:64
  buffer_load_dwordx4 v[56:59], v4, s[64:67], s76 offen offset:128
  buffer_load_dwordx4 v[60:63], v4, s[64:67], s76 offen offset:192
  s_add_u32 m0, s33, 0
  s_add_u32 s76, s74, 0
  buffer_load_dwordx4 v10, s[68:71], s76 offen offset:0 lds
  buffer_load_dwordx4 v10, s[68:71], s76 offen offset:2048 lds
  s_add_u32 m0, s33, 1024
  s_add_u32 s76, s74, 128
  buffer_load_dwordx4 v10, s[68:71], s76 offen offset:0 lds
  buffer_load_dwordx4 v10, s[68:71], s76 offen offset:2048 lds
  s_add_u32 m0, s33, 4096
  s_add_u32 s76, s74, 4096
  buffer_load_dwordx4 v10, s[68:71], s76 offen offset:0 lds
  buffer_load_dwordx4 v10, s[68:71], s76 offen offset:2048 lds
  s_add_u32 m0, s33, 5120
  s_add_u32 s76, s74, 4224
  buffer_load_dwordx4 v10, s[68:71], s76 offen offset:0 lds
  buffer_load_dwordx4 v10, s[68:71], s76 offen offset:2048 lds
  s_waitcnt vmcnt(0)
  ds_read_b64_tr_b16 v[80:81], v160 offset:0
  ds_read_b64_tr_b16 v[82:83], v160 offset:4096
  ds_read_b64_tr_b16 v[84:85], v161 offset:0
  ds_read_b64_tr_b16 v[86:87], v161 offset:4096
  ds_read_b64_tr_b16 v[88:89], v162 offset:0
  ds_read_b64_tr_b16 v[90:91], v162 offset:4096
  ds_read_b64_tr_b16 v[92:93], v163 offset:0
  ds_read_b64_tr_b16 v[94:95], v163 offset:4096
  ds_read_b64_tr_b16 v[96:97], v160 offset:1024
  ds_read_b64_tr_b16 v[98:99], v160 offset:5120
  ds_read_b64_tr_b16 v[100:101], v161 offset:1024
  ds_read_b64_tr_b16 v[102:103], v161 offset:5120
  ds_read_b64_tr_b16 v[104:105], v162 offset:1024
  ds_read_b64_tr_b16 v[106:107], v162 offset:5120
  ds_read_b64_tr_b16 v[108:109], v163 offset:1024
  ds_read_b64_tr_b16 v[110:111], v163 offset:5120
  v_mfma_f32_16x16x32_bf16 v[64:67], v[32:35], v[16:19], v[76:79]
  v_mfma_f32_16x16x32_bf16 v[64:67], v[36:39], v[20:23], v[64:67]
  v_mfma_f32_16x16x32_bf16 v[64:67], v[40:43], v[24:27], v[64:67]
  v_mfma_f32_16x16x32_bf16 v[64:67], v[44:47], v[28:31], v[64:67]
  v_mfma_f32_16x16x32_bf16 v[68:71], v[48:51], v[16:19], v[76:79]
  v_mfma_f32_16x16x32_bf16 v[68:71], v[52:55], v[20:23], v[68:71]
  v_mfma_f32_16x16x32_bf16 v[68:71], v[56:59], v[24:27], v[68:71]
  v_mfma_f32_16x16x32_bf16 v[68:71], v[60:63], v[28:31], v[68:71]
  s_nop 7
  s_nop 3
  v_exp_f32 v64, v64
  v_exp_f32 v65, v65
  v_exp_f32 v66, v66
  v_exp_f32 v67, v67
  v_exp_f32 v68, v68
  v_exp_f32 v69, v69
  v_exp_f32 v70, v70
  v_exp_f32 v71, v71
  s_nop 1
  v_cvt_pk_bf16_f32 v72, v64, v65
  v_cvt_pk_bf16_f32 v73, v66, v67
  v_cvt_pk_bf16_f32 v74, v68, v69
  v_cvt_pk_bf16_f32 v75, v70, v71
  s_waitcnt lgkmcnt(0)
  s_nop 1
  v_mfma_f32_16x16x32_bf16 v[112:115], v[116:119], v[72:75], v[112:115]
  v_mfma_f32_16x16x32_bf16 v[128:131], v[80:83], v[72:75], v[128:131]
  v_mfma_f32_16x16x32_bf16 v[132:135], v[84:87], v[72:75], v[132:135]
  v_mfma_f32_16x16x32_bf16 v[136:139], v[88:91], v[72:75], v[136:139]
  v_mfma_f32_16x16x32_bf16 v[140:143], v[92:95], v[72:75], v[140:143]
  v_mfma_f32_16x16x32_bf16 v[144:147], v[96:99], v[72:75], v[144:147]
  v_mfma_f32_16x16x32_bf16 v[148:151], v[100:103], v[72:75], v[148:151]
  v_mfma_f32_16x16x32_bf16 v[152:155], v[104:107], v[72:75], v[152:155]
  v_mfma_f32_16x16x32_bf16 v[156:159], v[108:111], v[72:75], v[156:159]
  s_add_u32 s74, s74, 8192
  s_sub_u32 s75, s75, 1
  s_cmp_lg_u32 s75, 0
  s_nop 7
  s_cbranch_scc1 L_slow_pv
  s_nop 7
  s_nop 3
  v_rcp_f32 v120, v112
  s_nop 1
  v_mul_f32 v128, v128, v120
  v_mul_f32 v129, v129, v120
  v_mul_f32 v130, v130, v120
  v_mul_f32 v131, v131, v120
  v_cvt_pk_bf16_f32 v124, v128, v129
  v_cvt_pk_bf16_f32 v125, v130, v131
  v_mul_f32 v132, v132, v120
  v_mul_f32 v133, v133, v120
  v_mul_f32 v134, v134, v120
  v_mul_f32 v135, v135, v120
  v_cvt_pk_bf16_f32 v126, v132, v133
  v_cvt_pk_bf16_f32 v127, v134, v135
  s_nop 1
  v_permlane16_swap_b32 v124, v126
  v_permlane16_swap_b32 v125, v127
  buffer_store_dwordx4 v[124:127], v5, s[20:23], s72 offen offset:0
  s_nop 1
  v_mul_f32 v136, v136, v120
  v_mul_f32 v137, v137, v120
  v_mul_f32 v138, v138, v120
  v_mul_f32 v139, v139, v120
  v_cvt_pk_bf16_f32 v124, v136, v137
  v_cvt_pk_bf16_f32 v125, v138, v139
  v_mul_f32 v140, v140, v120
  v_mul_f32 v141, v141, v120
  v_mul_f32 v142, v142, v120
  v_mul_f32 v143, v143, v120
  v_cvt_pk_bf16_f32 v126, v140, v141
  v_cvt_pk_bf16_f32 v127, v142, v143
  s_nop 1
  v_permlane16_swap_b32 v124, v126
  v_permlane16_swap_b32 v125, v127
  buffer_store_dwordx4 v[124:127], v5, s[20:23], s72 offen offset:64
  s_nop 1
  v_mul_f32 v144, v144, v120
  v_mul_f32 v145, v145, v120
  v_mul_f32 v146, v146, v120
  v_mul_f32 v147, v147, v120
  v_cvt_pk_bf16_f32 v124, v144, v145
  v_cvt_pk_bf16_f32 v125, v146, v147
  v_mul_f32 v148, v148, v120
  v_mul_f32 v149, v149, v120
  v_mul_f32 v150, v150, v120
  v_mul_f32 v151, v151, v120
  v_cvt_pk_bf16_f32 v126, v148, v149
  v_cvt_pk_bf16_f32 v127, v150, v151
  s_nop 1
  v_permlane16_swap_b32 v124, v126
  v_permlane16_swap_b32 v125, v127
  buffer_store_dwordx4 v[124:127], v5, s[20:23], s72 offen offset:128
  s_nop 1
  v_mul_f32 v152, v152, v120
  v_mul_f32 v153, v153, v120
  v_mul_f32 v154, v154, v120
  v_mul_f32 v155, v155, v120
  v_cvt_pk_bf16_f32 v124, v152, v153
  v_cvt_pk_bf16_f32 v125, v154, v155
  v_mul_f32 v156, v156, v120
  v_mul_f32 v157, v157, v120
  v_mul_f32 v158, v158, v120
  v_mul_f32 v159, v159, v120
  v_cvt_pk_bf16_f32 v126, v156, v157
  v_cvt_pk_bf16_f32 v127, v158, v159
  s_nop 1
  v_permlane16_swap_b32 v124, v126
  v_permlane16_swap_b32 v125, v127
  buffer_store_dwordx4 v[124:127], v5, s[20:23], s72 offen offset:192
  s_nop 1
  s_add_u32 s72, s72, 4096
  s_sub_u32 s43, s43, 1
  s_cmp_lg_u32 s43, 0
  s_cbranch_scc1 L_slow_tile
  s_waitcnt vmcnt(0)
  s_cmp_eq_u32 s77, 0
  s_cbranch_scc1 L_slow_ret0
  s_branch L_slow_ret1
L_code_end:
.section .rodata,"a"
.p2align 6
.amdhsa_kernel standalone__mha_softmax__near_ridge_kernel
  .amdhsa_next_free_vgpr 512
  .amdhsa_next_free_sgpr 102
  .amdhsa_accum_offset 256
  .amdhsa_group_segment_fixed_size 0
  .amdhsa_kernarg_size 48
  .amdhsa_user_sgpr_count 2
  .amdhsa_user_sgpr_kernarg_segment_ptr 1
  .amdhsa_system_sgpr_workgroup_id_x 1
.end_amdhsa_kernel
```
